```python
import torch

def _softmax(x, axis=-1):
    return torch.softmax(x, dim=axis)
def _gelu(x):
    return torch.nn.functional.gelu(x, approximate="tanh")
def _silu(x):
    return torch.nn.functional.silu(x)
def _sigmoid(x):
    return torch.sigmoid(x)
def _layernorm(x, axis=-1, eps=1e-5):
    m = x.mean(dim=axis, keepdim=True)
    v = x.var(dim=axis, keepdim=True, unbiased=False)
    return (x - m) / torch.sqrt(v + eps)
def _scatter_add(tgt, idx, src, axis=0):
    return tgt.clone().index_add_(axis, idx, src)
def _segment_sum(src, seg, n):
    out = torch.zeros((n,) + src.shape[1:], dtype=src.dtype)
    return out.index_add_(0, seg, src)
def _pad(x, pw):
    flat = tuple(v for pair in reversed(pw) for v in pair)
    return torch.nn.functional.pad(x, flat)

kernel_name = 'standalone__mha_block_cached__near_ridge'

def setup_inputs():

    _w = (lambda a: (lambda t: t.to(torch.bfloat16) if t.is_floating_point() else t)(torch.as_tensor(a)))
    B, Sq, D = 8, 288, 576
    H, Sk, Dh = 32, 2048, 128
    return {
        "x": _w((lambda *s: torch.randn(*s, dtype=torch.bfloat16) * 0.8)(B, Sq, D)),
        "k_cache": _w((lambda *s: torch.randn(*s, dtype=torch.bfloat16) * 0.8)(B, H, Sk, Dh)),
        "v_cache": _w((lambda *s: torch.randn(*s, dtype=torch.bfloat16) * 0.05)(B, H, Sk, Dh)),
        "wq": _w((lambda *s: torch.randn(*s, dtype=torch.bfloat16) * 0.8)(D, H * Dh) * (D ** -0.5)),
        "wo": _w((lambda *s: torch.randn(*s, dtype=torch.bfloat16) * 0.05)(H * Dh, D) * ((H * Dh) ** -0.5)),
    }

def reference(x, k_cache, v_cache, wq, wo):
    B, Sq, D = x.shape
    H, Dh = 32, 128
    q = (lambda x, *d: x.permute(*d))((x @ wq).reshape(B, Sq, H, Dh), 0, 2, 1, 3)
    scores = torch.einsum("bhqd,bhkd->bhqk", q, k_cache) * (Dh ** -0.5)
    p = _softmax(scores, axis=-1)
    o = torch.einsum("bhqk,bhkd->bhqd", p, v_cache)
    return (lambda x, *d: x.permute(*d))(o, 0, 2, 1, 3).reshape(B, Sq, H * Dh) @ wo
```

```asm
; @launch grid=(256,1,1) block=(256,1,1) lds=163840
.amdgcn_target "amdgcn-amd-amdhsa--gfx950"
.text
.globl standalone__mha_block_cached__near_ridge_kernel
.p2align 8
.type standalone__mha_block_cached__near_ridge_kernel,@function
standalone__mha_block_cached__near_ridge_kernel:
    s_cmp_ge_u32 s2, 256
    s_cbranch_scc1 L1_end
    s_load_dwordx8 s[32:39], s[0:1], 0
    s_load_dwordx2 s[40:41], s[0:1], 56
    s_load_dwordx2 s[30:31], s[0:1], 32
    s_getpc_b64 s[98:99]
L1_pc:
    s_lshr_b32 s3, s2, 3
    s_lshl_b32 s46, s3, 11
    v_lshl_add_u32 v1, v0, 7, s46
    v_min_u32 v1, L_code_end-L1_pc-4, v1
    v_cmp_gt_u32 vcc, 16, v0
    s_and_saveexec_b64 s[46:47], vcc
    s_cbranch_execz L1_nocpf
    global_load_dword v252, v1, s[98:99]
L1_nocpf:
    s_mov_b64 exec, s[46:47]
    v_lshrrev_b32 v1, 6, v0
    v_and_b32 v0, 63, v0
    v_readfirstlane_b32 s24, v1
    s_and_b32 s27, s2, 1
    s_lshl_b32 s27, s27, 2
    s_and_b32 s46, s3, 3
    s_add_u32 s27, s27, s46
    s_and_b32 s28, s2, 6
    s_lshl_b32 s28, s28, 2
    s_lshr_b32 s46, s3, 2
    s_add_u32 s28, s28, s46
    s_and_b32 s25, s24, 1
    s_add_u32 s100, s27, s28
    s_and_b32 s100, s100, 3
    s_mul_i32 s100, s100, 9
    s_add_u32 s100, s100, 2
    s_lshr_b32 s100, s100, 2
    s_lshl_b32 s100, s100, 7
    s_mov_b32 s89, s100
    v_lshrrev_b32 v12, 4, v0
    v_and_b32 v13, 15, v0
    v_lshrrev_b32 v9, 5, v0
    v_lshlrev_b32 v5, 18, v9
    v_and_b32 v9, 1, v12
    v_lshl_add_u32 v5, v9, 15, v5
    v_lshl_add_u32 v5, v13, 4, v5
    v_lshrrev_b32 v9, 3, v0
    v_mul_u32_u24 v2, 1152, v9
    v_and_b32 v9, 7, v0
    v_xor_b32 v9, v9, v12
    v_lshl_add_u32 v2, v9, 4, v2
    v_xor_b32 v3, 64, v2
    s_lshl_b32 s46, s25, 6
    v_xor_b32 v4, s46, v2
    s_lshl_b32 s42, s24, 13
    s_add_u32 s42, s42, 21504
    s_mul_i32 s43, s24, 73728
    s_lshl_b32 s48, s24, 10
    s_add_u32 s48, s48, 17408
    s_mul_i32 s55, s24, 9216
    s_add_u32 s55, s55, 294912
    s_lshr_b32 s46, s24, 1
    s_mul_i32 s44, s46, 8720
    s_mul_i32 s46, s25, 4360
    s_add_u32 s44, s44, s46
    s_lshl_b32 s45, s24, 16
    s_mul_i32 s47, s27, 331776
    s_lshl_b32 s46, s28, 8
    s_mov_b32 s6, 331776
    s_mov_b32 s7, 0x20000
    s_sub_u32 s10, 4718592, s46
    s_mov_b32 s11, 0x20000
    s_waitcnt lgkmcnt(0)
    s_add_u32 s8, s38, s46
    s_addc_u32 s9, s39, 0
    s_add_u32 s4, s32, s47
    s_addc_u32 s5, s33, 0
    s_lshl_b32 s26, s100, 12
    s_add_u32 s26, s26, s45
    s_add_u32 s101, s55, s100
    s_add_u32 s100, s100, 128
    s_sub_u32 s57, s100, 1152
    s_min_u32 s100, s100, s57
    s_add_u32 m0, s44, 0
    s_nop 0
    buffer_load_dwordx4 v5, s[8:11], s26 offen sc1 lds
    s_add_u32 m0, s44, 1088
    s_add_u32 s46, s26, 8192
    buffer_load_dwordx4 v5, s[8:11], s46 offen sc1 lds
    s_add_u32 m0, s44, 2176
    s_add_u32 s46, s26, 16384
    buffer_load_dwordx4 v5, s[8:11], s46 offen sc1 lds
    s_add_u32 m0, s44, 3264
    s_add_u32 s46, s26, 24576
    buffer_load_dwordx4 v5, s[8:11], s46 offen sc1 lds
    s_add_u32 m0, s48, 0
    s_nop 0
    buffer_load_dwordx4 v4, s[4:7], s101 offen sc1 lds
    s_add_u32 s29, s43, s89
    s_add_u32 s89, s89, 128
    s_sub_u32 s57, s89, 1152
    s_min_u32 s89, s89, s57
    s_add_u32 m0, s42, 0
    s_nop 0
    buffer_load_dwordx4 v2, s[4:7], s29 offen sc1 lds
    s_add_u32 m0, s42, 1024
    s_add_u32 s46, s29, 9216
    buffer_load_dwordx4 v3, s[4:7], s46 offen sc1 lds
    s_add_u32 m0, s42, 2048
    s_add_u32 s46, s29, 18432
    buffer_load_dwordx4 v2, s[4:7], s46 offen sc1 lds
    s_add_u32 m0, s42, 3072
    s_add_u32 s46, s29, 27648
    buffer_load_dwordx4 v3, s[4:7], s46 offen sc1 lds
    s_add_u32 m0, s42, 4096
    s_add_u32 s46, s29, 36864
    buffer_load_dwordx4 v2, s[4:7], s46 offen sc1 lds
    s_add_u32 m0, s42, 5120
    s_add_u32 s46, s29, 46080
    buffer_load_dwordx4 v3, s[4:7], s46 offen sc1 lds
    s_add_u32 m0, s42, 6144
    s_add_u32 s46, s29, 55296
    buffer_load_dwordx4 v2, s[4:7], s46 offen sc1 lds
    s_add_u32 m0, s42, 7168
    s_add_u32 s46, s29, 64512
    buffer_load_dwordx4 v3, s[4:7], s46 offen sc1 lds
    s_lshl_b32 s47, s27, 5
    s_add_u32 s47, s47, s28
    s_lshl_b32 s47, s47, 19
    s_add_u32 s12, s34, s47
    s_addc_u32 s13, s35, 0
    s_mov_b32 s14, 524288
    s_mov_b32 s15, 0x20000
    s_add_u32 s16, s36, s47
    s_addc_u32 s17, s37, 0
    s_mov_b32 s18, 524288
    s_mov_b32 s19, 0x20000
    s_add_u32 s20, s40, 0
    s_addc_u32 s21, s41, 0
    s_mov_b32 s22, 20164608
    s_mov_b32 s23, 0x20000
    s_mov_b32 s84, s30
    s_mov_b32 s85, s31
    s_mov_b32 s86, 4718592
    s_mov_b32 s87, 0x20000
    v_bfe_u32 v14, v0, 2, 2
    v_and_b32 v15, 3, v0
    v_lshlrev_b32 v162, 7, v13
    v_lshrrev_b32 v9, 1, v13
    v_xor_b32 v9, v9, v12
    v_lshl_add_u32 v162, v9, 4, v162
    s_lshl_b32 s26, s100, 12
    s_add_u32 s26, s26, s45
    s_add_u32 s101, s55, s100
    s_add_u32 s100, s100, 128
    s_sub_u32 s57, s100, 1152
    s_min_u32 s100, s100, s57
    s_add_u32 m0, s44, 108544
    s_nop 0
    buffer_load_dwordx4 v5, s[8:11], s26 offen sc1 lds
    v_add_u32 v160, s42, v162
    s_lshr_b32 s47, s24, 1
    s_lshl_b32 s47, s47, 11
    s_add_u32 s47, s47, 17408
    v_add_u32 v162, s47, v162
    v_xor_b32 v161, 64, v160
    v_xor_b32 v163, 64, v162
    v_lshrrev_b32 v9, 1, v12
    v_mul_u32_u24 v164, 8720, v9
    v_and_b32 v9, 1, v12
    v_mul_u32_u24 v9, 4360, v9
    v_add_u32 v164, v164, v9
    v_mul_u32_u24 v9, 1088, v14
    v_add_u32 v164, v164, v9
    v_lshl_add_u32 v164, v15, 4, v164
    s_lshl_b32 s47, s25, 7
    s_xor_b32 s58, s47, 128
    v_add_u32 v165, s58, v164
    v_add_u32 v164, s47, v164
    v_add_u32 v166, 108544, v160
    v_add_u32 v167, 108544, v161
    v_add_u32 v168, 108544, v162
    s_add_u32 m0, s44, 109632
    s_add_u32 s46, s26, 8192
    buffer_load_dwordx4 v5, s[8:11], s46 offen sc1 lds
    v_add_u32 v169, 108544, v163
    v_add_u32 v170, 108544, v164
    v_add_u32 v171, 108544, v165
    s_lshl_b32 s47, s24, 12
    v_lshl_add_u32 v8, v0, 4, s47
    s_mul_i32 s88, s24, 4224
    v_add_u32 v246, 0, v8
    v_add_u32 v247, 1024, v8
    v_add_u32 v248, 2048, v8
    v_add_u32 v249, 3072, v8
    v_mul_u32_u24 v9, 1056, v13
    v_lshl_add_u32 v9, v12, 4, v9
    v_lshl_add_u32 v10, v12, 2, v14
    v_mul_u32_u24 v10, 1056, v10
    v_lshl_add_u32 v10, v15, 3, v10
    s_xor_b32 s47, s25, 0
    s_lshl_b32 s47, s47, 9
    v_add_u32 v244, s47, v10
    s_lshl_b32 s58, s25, 7
    s_add_u32 s47, s47, s58
    v_add_u32 v240, s47, v9
    s_xor_b32 s47, s47, 128
    s_add_u32 m0, s44, 110720
    s_add_u32 s46, s26, 16384
    buffer_load_dwordx4 v5, s[8:11], s46 offen sc1 lds
    v_add_u32 v241, s47, v9
    s_xor_b32 s47, s25, 1
    s_lshl_b32 s47, s47, 9
    v_add_u32 v245, s47, v10
    s_lshl_b32 s58, s25, 7
    s_add_u32 s47, s47, s58
    v_add_u32 v242, s47, v9
    s_xor_b32 s47, s47, 128
    v_add_u32 v243, s47, v9
    s_lshl_b32 s30, s2, 2
    s_add_u32 s30, s30, s24
    s_mul_i32 s30, s30, 4608
    v_min_u32 v7, 1, v0
    v_lshlrev_b32 v7, 7, v7
    s_lshl_b32 s3, s25, 10
    s_sub_u32 s3, 512, s3
    v_min_u32 v6, 1, v0
    s_lshr_b32 s47, s2, 3
    s_lshl_b32 s47, s47, 2
    s_add_u32 s47, s47, s24
    s_lshl_b32 s47, s47, 8
    v_lshl_add_u32 v6, v6, 7, s47
    s_add_u32 m0, s44, 111808
    s_add_u32 s46, s26, 24576
    buffer_load_dwordx4 v5, s[8:11], s46 offen sc1 lds
    v_min_u32 v6, L1_redo-L1_tail, v6
    v_add_u32 v6, L1_tail-L1_pc, v6
    v_mov_b32 v9, 0x3f803f80
    v_cmp_gt_u32 vcc, 2, v15
    s_mov_b32 s56, 0x3e0293ee
    s_mov_b32 s59, 0
    v_cndmask_b32 v9, 0, v9, vcc
    v_accvgpr_write_b32 a180, v9
    v_accvgpr_write_b32 a181, v9
    v_accvgpr_write_b32 a182, v9
    v_accvgpr_write_b32 a183, v9
    v_cmp_eq_u32 vcc, 1, v15
    v_mov_b32 v255, 0x44444444
    v_mov_b32 v9, 0xeeeeeeee
    v_cndmask_b32 v255, v255, v9, vcc
    s_add_u32 s47, s42, 114688
    v_lshl_add_u32 v9, v0, 4, s47
    s_xor_b32 s47, s24, 1
    s_lshl_b32 s47, s47, 13
    s_add_u32 s47, s47, 136192
    v_lshl_add_u32 v10, v0, 4, s47
    s_mov_b32 s52, 49152
    s_add_u32 m0, s48, 108544
    s_nop 0
    buffer_load_dwordx4 v4, s[4:7], s101 offen sc1 lds
    s_add_u32 s50, s88, 101376
    s_mov_b32 s51, s88
    s_mov_b32 s53, 33792
    s_mov_b32 s54, 16896
    s_mov_b32 s49, 14
    s_mov_b32 s38, 0
    s_mov_b32 s60, 16384
    s_mov_b32 s61, 160
    s_mov_b32 s62, 0x7ffff
    v_accvgpr_write_b32 a0, 0
    v_accvgpr_write_b32 a1, 0
    v_accvgpr_write_b32 a2, 0
    v_accvgpr_write_b32 a3, 0
    v_accvgpr_write_b32 a4, 0
    v_accvgpr_write_b32 a5, 0
    v_accvgpr_write_b32 a6, 0
    v_accvgpr_write_b32 a7, 0
    v_accvgpr_write_b32 a8, 0
    v_accvgpr_write_b32 a9, 0
    v_accvgpr_write_b32 a10, 0
    v_accvgpr_write_b32 a11, 0
    v_accvgpr_write_b32 a12, 0
    s_add_u32 s29, s43, s89
    s_add_u32 s89, s89, 128
    s_sub_u32 s57, s89, 1152
    s_min_u32 s89, s89, s57
    s_add_u32 m0, s42, 108544
    s_nop 0
    buffer_load_dwordx4 v2, s[4:7], s29 offen sc1 lds
    v_accvgpr_write_b32 a13, 0
    v_accvgpr_write_b32 a14, 0
    v_accvgpr_write_b32 a15, 0
    v_accvgpr_write_b32 a16, 0
    v_accvgpr_write_b32 a17, 0
    v_accvgpr_write_b32 a18, 0
    v_accvgpr_write_b32 a19, 0
    v_accvgpr_write_b32 a20, 0
    v_accvgpr_write_b32 a21, 0
    v_accvgpr_write_b32 a22, 0
    v_accvgpr_write_b32 a23, 0
    v_accvgpr_write_b32 a24, 0
    v_accvgpr_write_b32 a25, 0
    v_accvgpr_write_b32 a26, 0
    v_accvgpr_write_b32 a27, 0
    v_accvgpr_write_b32 a28, 0
    v_accvgpr_write_b32 a29, 0
    v_accvgpr_write_b32 a30, 0
    v_accvgpr_write_b32 a31, 0
    v_accvgpr_write_b32 a32, 0
    v_accvgpr_write_b32 a33, 0
    v_accvgpr_write_b32 a34, 0
    s_add_u32 m0, s42, 109568
    s_add_u32 s46, s29, 9216
    buffer_load_dwordx4 v3, s[4:7], s46 offen sc1 lds
    v_accvgpr_write_b32 a35, 0
    v_accvgpr_write_b32 a36, 0
    v_accvgpr_write_b32 a37, 0
    v_accvgpr_write_b32 a38, 0
    v_accvgpr_write_b32 a39, 0
    v_accvgpr_write_b32 a40, 0
    v_accvgpr_write_b32 a41, 0
    v_accvgpr_write_b32 a42, 0
    v_accvgpr_write_b32 a43, 0
    v_accvgpr_write_b32 a44, 0
    v_accvgpr_write_b32 a45, 0
    v_accvgpr_write_b32 a46, 0
    v_accvgpr_write_b32 a47, 0
    v_accvgpr_write_b32 a48, 0
    v_accvgpr_write_b32 a49, 0
    v_accvgpr_write_b32 a50, 0
    v_accvgpr_write_b32 a51, 0
    v_accvgpr_write_b32 a52, 0
    v_accvgpr_write_b32 a53, 0
    v_accvgpr_write_b32 a54, 0
    v_accvgpr_write_b32 a55, 0
    v_accvgpr_write_b32 a56, 0
    s_add_u32 m0, s42, 110592
    s_add_u32 s46, s29, 18432
    buffer_load_dwordx4 v2, s[4:7], s46 offen sc1 lds
    v_accvgpr_write_b32 a57, 0
    v_accvgpr_write_b32 a58, 0
    v_accvgpr_write_b32 a59, 0
    v_accvgpr_write_b32 a60, 0
    v_accvgpr_write_b32 a61, 0
    v_accvgpr_write_b32 a62, 0
    v_accvgpr_write_b32 a63, 0
    v_accvgpr_write_b32 a64, 0
    v_accvgpr_write_b32 a65, 0
    v_accvgpr_write_b32 a66, 0
    v_accvgpr_write_b32 a67, 0
    v_accvgpr_write_b32 a68, 0
    v_accvgpr_write_b32 a69, 0
    v_accvgpr_write_b32 a70, 0
    v_accvgpr_write_b32 a71, 0
    v_accvgpr_write_b32 a72, 0
    v_accvgpr_write_b32 a73, 0
    v_accvgpr_write_b32 a74, 0
    v_accvgpr_write_b32 a75, 0
    v_accvgpr_write_b32 a76, 0
    v_accvgpr_write_b32 a77, 0
    v_accvgpr_write_b32 a78, 0
    s_add_u32 m0, s42, 111616
    s_add_u32 s46, s29, 27648
    buffer_load_dwordx4 v3, s[4:7], s46 offen sc1 lds
    v_accvgpr_write_b32 a79, 0
    v_accvgpr_write_b32 a80, 0
    v_accvgpr_write_b32 a81, 0
    v_accvgpr_write_b32 a82, 0
    v_accvgpr_write_b32 a83, 0
    v_accvgpr_write_b32 a84, 0
    v_accvgpr_write_b32 a85, 0
    v_accvgpr_write_b32 a86, 0
    v_accvgpr_write_b32 a87, 0
    v_accvgpr_write_b32 a88, 0
    v_accvgpr_write_b32 a89, 0
    v_accvgpr_write_b32 a90, 0
    v_accvgpr_write_b32 a91, 0
    v_accvgpr_write_b32 a92, 0
    v_accvgpr_write_b32 a93, 0
    v_accvgpr_write_b32 a94, 0
    v_accvgpr_write_b32 a95, 0
    v_accvgpr_write_b32 a96, 0
    v_accvgpr_write_b32 a97, 0
    v_accvgpr_write_b32 a98, 0
    v_accvgpr_write_b32 a99, 0
    v_accvgpr_write_b32 a100, 0
    s_add_u32 m0, s42, 112640
    s_add_u32 s46, s29, 36864
    buffer_load_dwordx4 v2, s[4:7], s46 offen sc1 lds
    v_accvgpr_write_b32 a101, 0
    v_accvgpr_write_b32 a102, 0
    v_accvgpr_write_b32 a103, 0
    v_accvgpr_write_b32 a104, 0
    v_accvgpr_write_b32 a105, 0
    v_accvgpr_write_b32 a106, 0
    v_accvgpr_write_b32 a107, 0
    v_accvgpr_write_b32 a108, 0
    v_accvgpr_write_b32 a109, 0
    v_accvgpr_write_b32 a110, 0
    v_accvgpr_write_b32 a111, 0
    v_accvgpr_write_b32 a112, 0
    v_accvgpr_write_b32 a113, 0
    v_accvgpr_write_b32 a114, 0
    v_accvgpr_write_b32 a115, 0
    v_accvgpr_write_b32 a116, 0
    v_accvgpr_write_b32 a117, 0
    v_accvgpr_write_b32 a118, 0
    v_accvgpr_write_b32 a119, 0
    v_accvgpr_write_b32 a120, 0
    v_accvgpr_write_b32 a121, 0
    v_accvgpr_write_b32 a122, 0
    s_add_u32 m0, s42, 113664
    s_add_u32 s46, s29, 46080
    buffer_load_dwordx4 v3, s[4:7], s46 offen sc1 lds
    v_accvgpr_write_b32 a123, 0
    v_accvgpr_write_b32 a124, 0
    v_accvgpr_write_b32 a125, 0
    v_accvgpr_write_b32 a126, 0
    v_accvgpr_write_b32 a127, 0
    v_accvgpr_write_b32 a128, 0
    v_accvgpr_write_b32 a129, 0
    v_accvgpr_write_b32 a130, 0
    v_accvgpr_write_b32 a131, 0
    v_accvgpr_write_b32 a132, 0
    v_accvgpr_write_b32 a133, 0
    v_accvgpr_write_b32 a134, 0
    v_accvgpr_write_b32 a135, 0
    v_accvgpr_write_b32 a136, 0
    v_accvgpr_write_b32 a137, 0
    v_accvgpr_write_b32 a138, 0
    v_accvgpr_write_b32 a139, 0
    v_accvgpr_write_b32 a140, 0
    v_accvgpr_write_b32 a141, 0
    v_accvgpr_write_b32 a142, 0
    v_accvgpr_write_b32 a143, 0
    v_accvgpr_write_b32 a144, 0
    s_add_u32 m0, s42, 114688
    s_add_u32 s46, s29, 55296
    buffer_load_dwordx4 v2, s[4:7], s46 offen sc1 lds
    v_accvgpr_write_b32 a145, 0
    v_accvgpr_write_b32 a146, 0
    v_accvgpr_write_b32 a147, 0
    v_accvgpr_write_b32 a148, 0
    v_accvgpr_write_b32 a149, 0
    v_accvgpr_write_b32 a150, 0
    v_accvgpr_write_b32 a151, 0
    v_accvgpr_write_b32 a152, 0
    v_accvgpr_write_b32 a153, 0
    v_accvgpr_write_b32 a154, 0
    v_accvgpr_write_b32 a155, 0
    v_accvgpr_write_b32 a156, 0
    v_accvgpr_write_b32 a157, 0
    v_accvgpr_write_b32 a158, 0
    v_accvgpr_write_b32 a159, 0
    v_accvgpr_write_b32 a160, 0
    v_accvgpr_write_b32 a161, 0
    v_accvgpr_write_b32 a162, 0
    v_accvgpr_write_b32 a163, 0
    v_accvgpr_write_b32 a164, 0
    v_accvgpr_write_b32 a165, 0
    v_accvgpr_write_b32 a166, 0
    s_add_u32 m0, s42, 115712
    s_add_u32 s46, s29, 64512
    buffer_load_dwordx4 v3, s[4:7], s46 offen sc1 lds
    v_accvgpr_write_b32 a167, 0
    v_accvgpr_write_b32 a168, 0
    v_accvgpr_write_b32 a169, 0
    v_accvgpr_write_b32 a170, 0
    v_accvgpr_write_b32 a171, 0
    v_accvgpr_write_b32 a172, 0
    v_accvgpr_write_b32 a173, 0
    v_accvgpr_write_b32 a174, 0
    v_accvgpr_write_b32 a175, 0
    v_accvgpr_write_b32 a176, 0
    v_accvgpr_write_b32 a177, 0
    v_accvgpr_write_b32 a178, 0
    v_accvgpr_write_b32 a179, 0
    s_waitcnt vmcnt(13)
    s_barrier
    ds_read_b128 a[184:187], v160 offset:0
    ds_read_b128 a[188:191], v160 offset:2048
    ds_read_b128 a[192:195], v160 offset:4096
    ds_read_b128 a[196:199], v160 offset:6144
    ds_read_b128 a[200:203], v162 offset:0
    ds_read_b64_tr_b16 a[224:225], v164 offset:0
    ds_read_b64_tr_b16 a[226:227], v164 offset:256
    ds_read_b64_tr_b16 a[228:229], v164 offset:8
    ds_read_b64_tr_b16 a[230:231], v164 offset:264
    s_waitcnt lgkmcnt(2)
    v_mfma_f32_16x16x32_bf16 v[16:19], a[224:227], a[184:187], 0
    s_lshl_b32 s26, s100, 12
    ds_read_b64_tr_b16 a[232:233], v164 offset:64
    ds_read_b64_tr_b16 a[234:235], v164 offset:320
    v_mfma_f32_16x16x32_bf16 v[48:51], a[224:227], a[188:191], 0
    s_add_u32 s26, s26, s45
    ds_read_b64_tr_b16 a[236:237], v164 offset:72
    ds_read_b64_tr_b16 a[238:239], v164 offset:328
    v_mfma_f32_16x16x32_bf16 v[80:83], a[224:227], a[192:195], 0
    s_add_u32 s101, s55, s100
    ds_read_b64_tr_b16 a[240:241], v165 offset:0
    ds_read_b64_tr_b16 a[242:243], v165 offset:256
    v_mfma_f32_16x16x32_bf16 v[112:115], a[224:227], a[196:199], 0
    s_add_u32 s100, s100, 128
    ds_read_b64_tr_b16 a[244:245], v165 offset:8
    ds_read_b64_tr_b16 a[246:247], v165 offset:264
    v_mfma_f32_16x16x32_bf16 v[144:147], a[224:227], a[200:203], 0
    s_waitcnt lgkmcnt(8)
    s_sub_u32 s57, s100, 1152
    ds_read_b64_tr_b16 a[248:249], v165 offset:64
    ds_read_b64_tr_b16 a[250:251], v165 offset:320
    v_mfma_f32_16x16x32_bf16 v[20:23], a[228:231], a[184:187], 0
    s_min_u32 s100, s100, s57
    ds_read_b128 a[204:207], v161 offset:0
    v_mfma_f32_16x16x32_bf16 v[52:55], a[228:231], a[188:191], 0
    s_add_u32 m0, s44, 54272
    ds_read_b128 a[208:211], v161 offset:2048
    v_mfma_f32_16x16x32_bf16 v[84:87], a[228:231], a[192:195], 0
    ds_read_b128 a[212:215], v161 offset:4096
    v_mfma_f32_16x16x32_bf16 v[116:119], a[228:231], a[196:199], 0
    ds_read_b128 a[216:219], v161 offset:6144
    v_mfma_f32_16x16x32_bf16 v[148:151], a[228:231], a[200:203], 0
    s_waitcnt lgkmcnt(12)
    ds_read_b128 a[220:223], v163 offset:0
    v_mfma_f32_16x16x32_bf16 v[24:27], a[232:235], a[184:187], 0
    ds_read_b64_tr_b16 a[252:253], v165 offset:72
    ds_read_b64_tr_b16 a[254:255], v165 offset:328
    v_mfma_f32_16x16x32_bf16 v[56:59], a[232:235], a[188:191], 0
    ds_read_b64_tr_b16 a[224:225], v164 offset:512
    ds_read_b64_tr_b16 a[226:227], v164 offset:768
    v_mfma_f32_16x16x32_bf16 v[88:91], a[232:235], a[192:195], 0
    ds_read_b64_tr_b16 a[228:229], v164 offset:520
    ds_read_b64_tr_b16 a[230:231], v164 offset:776
    v_mfma_f32_16x16x32_bf16 v[120:123], a[232:235], a[196:199], 0
    buffer_load_dwordx4 v5, s[8:11], s26 offen sc1 lds
    v_mfma_f32_16x16x32_bf16 v[152:155], a[232:235], a[200:203], 0
    s_waitcnt lgkmcnt(15)
    s_add_u32 m0, s44, 55360
    s_add_u32 s46, s26, 8192
    v_mfma_f32_16x16x32_bf16 v[28:31], a[236:239], a[184:187], 0
    ds_read_b64_tr_b16 a[232:233], v164 offset:576
    ds_read_b64_tr_b16 a[234:235], v164 offset:832
    v_mfma_f32_16x16x32_bf16 v[60:63], a[236:239], a[188:191], 0
    buffer_load_dwordx4 v5, s[8:11], s46 offen sc1 lds
    v_mfma_f32_16x16x32_bf16 v[92:95], a[236:239], a[192:195], 0
    v_mfma_f32_16x16x32_bf16 v[124:127], a[236:239], a[196:199], 0
    v_mfma_f32_16x16x32_bf16 v[156:159], a[236:239], a[200:203], 0
    s_add_u32 m0, s44, 56448
    s_add_u32 s46, s26, 16384
    v_mfma_f32_16x16x32_bf16 v[32:35], a[240:243], a[184:187], 0
    ds_read_b64_tr_b16 a[236:237], v164 offset:584
    ds_read_b64_tr_b16 a[238:239], v164 offset:840
    v_mfma_f32_16x16x32_bf16 v[64:67], a[240:243], a[188:191], 0
    buffer_load_dwordx4 v5, s[8:11], s46 offen sc1 lds
    v_mfma_f32_16x16x32_bf16 v[96:99], a[240:243], a[192:195], 0
    v_mfma_f32_16x16x32_bf16 v[128:131], a[240:243], a[196:199], 0
    s_waitcnt lgkmcnt(15)
    v_mfma_f32_16x16x32_bf16 v[36:39], a[244:247], a[184:187], 0
    s_add_u32 m0, s44, 57536
    ds_read_b64_tr_b16 a[240:241], v165 offset:512
    ds_read_b64_tr_b16 a[242:243], v165 offset:768
    v_mfma_f32_16x16x32_bf16 v[68:71], a[244:247], a[188:191], 0
    s_add_u32 s46, s26, 24576
    v_mfma_f32_16x16x32_bf16 v[100:103], a[244:247], a[192:195], 0
    buffer_load_dwordx4 v5, s[8:11], s46 offen sc1 lds
    v_mfma_f32_16x16x32_bf16 v[132:135], a[244:247], a[196:199], 0
    v_mfma_f32_16x16x32_bf16 v[40:43], a[248:251], a[184:187], 0
    ds_read_b64_tr_b16 a[244:245], v165 offset:520
    ds_read_b64_tr_b16 a[246:247], v165 offset:776
    v_mfma_f32_16x16x32_bf16 v[72:75], a[248:251], a[188:191], 0
    s_add_u32 m0, s48, 54272
    v_mfma_f32_16x16x32_bf16 v[104:107], a[248:251], a[192:195], 0
    buffer_load_dwordx4 v4, s[4:7], s101 offen sc1 lds
    v_mfma_f32_16x16x32_bf16 v[136:139], a[248:251], a[196:199], 0
    s_waitcnt lgkmcnt(12)
    s_add_u32 s29, s43, s89
    s_add_u32 s89, s89, 128
    v_mfma_f32_16x16x32_bf16 v[44:47], a[252:255], a[184:187], 0
    s_sub_u32 s57, s89, 1152
    ds_read_b64_tr_b16 a[248:249], v165 offset:576
    ds_read_b64_tr_b16 a[250:251], v165 offset:832
    v_mfma_f32_16x16x32_bf16 v[76:79], a[252:255], a[188:191], 0
    s_min_u32 s89, s89, s57
    s_add_u32 m0, s42, 54272
    v_mfma_f32_16x16x32_bf16 v[108:111], a[252:255], a[192:195], 0
    buffer_load_dwordx4 v2, s[4:7], s29 offen sc1 lds
    v_mfma_f32_16x16x32_bf16 v[140:143], a[252:255], a[196:199], 0
    s_waitcnt lgkmcnt(12)
    s_add_u32 m0, s42, 55296
    s_add_u32 s46, s29, 9216
    v_mfma_f32_16x16x32_bf16 v[16:19], a[224:227], a[204:207], v[16:19]
    ds_read_b64_tr_b16 a[252:253], v165 offset:584
    ds_read_b64_tr_b16 a[254:255], v165 offset:840
    v_mfma_f32_16x16x32_bf16 v[48:51], a[224:227], a[208:211], v[48:51]
    buffer_load_dwordx4 v3, s[4:7], s46 offen sc1 lds
    v_mfma_f32_16x16x32_bf16 v[80:83], a[224:227], a[212:215], v[80:83]
    s_add_u32 m0, s42, 56320
    s_add_u32 s46, s29, 18432
    v_mfma_f32_16x16x32_bf16 v[112:115], a[224:227], a[216:219], v[112:115]
    buffer_load_dwordx4 v2, s[4:7], s46 offen sc1 lds
    v_mfma_f32_16x16x32_bf16 v[144:147], a[224:227], a[220:223], v[144:147]
    s_waitcnt lgkmcnt(12)
    s_add_u32 m0, s42, 57344
    s_add_u32 s46, s29, 27648
    v_mfma_f32_16x16x32_bf16 v[20:23], a[228:231], a[204:207], v[20:23]
    buffer_load_dwordx4 v3, s[4:7], s46 offen sc1 lds
    v_mfma_f32_16x16x32_bf16 v[52:55], a[228:231], a[208:211], v[52:55]
    s_add_u32 m0, s42, 58368
    s_add_u32 s46, s29, 36864
    v_mfma_f32_16x16x32_bf16 v[84:87], a[228:231], a[212:215], v[84:87]
    buffer_load_dwordx4 v2, s[4:7], s46 offen sc1 lds
    v_mfma_f32_16x16x32_bf16 v[116:119], a[228:231], a[216:219], v[116:119]
    s_add_u32 m0, s42, 59392
    s_add_u32 s46, s29, 46080
    v_mfma_f32_16x16x32_bf16 v[148:151], a[228:231], a[220:223], v[148:151]
    s_waitcnt lgkmcnt(10)
    buffer_load_dwordx4 v3, s[4:7], s46 offen sc1 lds
    v_mfma_f32_16x16x32_bf16 v[24:27], a[232:235], a[204:207], v[24:27]
    s_add_u32 m0, s42, 60416
    s_add_u32 s46, s29, 55296
    v_mfma_f32_16x16x32_bf16 v[56:59], a[232:235], a[208:211], v[56:59]
    buffer_load_dwordx4 v2, s[4:7], s46 offen sc1 lds
    v_mfma_f32_16x16x32_bf16 v[88:91], a[232:235], a[212:215], v[88:91]
    s_add_u32 m0, s42, 61440
    s_add_u32 s46, s29, 64512
    v_mfma_f32_16x16x32_bf16 v[120:123], a[232:235], a[216:219], v[120:123]
    buffer_load_dwordx4 v3, s[4:7], s46 offen sc1 lds
    v_mfma_f32_16x16x32_bf16 v[152:155], a[232:235], a[220:223], v[152:155]
    s_waitcnt vmcnt(13) lgkmcnt(0)
    s_barrier
    ds_read_b128 a[184:187], v166 offset:0
    v_mfma_f32_16x16x32_bf16 v[28:31], a[236:239], a[204:207], v[28:31]
    ds_read_b128 a[188:191], v166 offset:2048
    v_mfma_f32_16x16x32_bf16 v[60:63], a[236:239], a[208:211], v[60:63]
    ds_read_b128 a[192:195], v166 offset:4096
    v_mfma_f32_16x16x32_bf16 v[92:95], a[236:239], a[212:215], v[92:95]
    ds_read_b128 a[196:199], v166 offset:6144
    v_mfma_f32_16x16x32_bf16 v[124:127], a[236:239], a[216:219], v[124:127]
    ds_read_b128 a[200:203], v168 offset:0
    v_mfma_f32_16x16x32_bf16 v[156:159], a[236:239], a[220:223], v[156:159]
    ds_read_b64_tr_b16 a[224:225], v170 offset:0
    ds_read_b64_tr_b16 a[226:227], v170 offset:256
    v_mfma_f32_16x16x32_bf16 v[32:35], a[240:243], a[204:207], v[32:35]
    ds_read_b64_tr_b16 a[228:229], v170 offset:8
    ds_read_b64_tr_b16 a[230:231], v170 offset:264
    v_mfma_f32_16x16x32_bf16 v[64:67], a[240:243], a[208:211], v[64:67]
    ds_read_b64_tr_b16 a[232:233], v170 offset:64
    ds_read_b64_tr_b16 a[234:235], v170 offset:320
    v_mfma_f32_16x16x32_bf16 v[96:99], a[240:243], a[212:215], v[96:99]
    ds_read_b64_tr_b16 a[236:237], v170 offset:72
    ds_read_b64_tr_b16 a[238:239], v170 offset:328
    v_mfma_f32_16x16x32_bf16 v[128:131], a[240:243], a[216:219], v[128:131]
    s_add_u32 s29, s43, s89
    s_nop 0
    v_mfma_f32_16x16x32_bf16 v[36:39], a[244:247], a[204:207], v[36:39]
    s_add_u32 s89, s89, 128
    ds_read_b64_tr_b16 a[240:241], v171 offset:0
    ds_read_b64_tr_b16 a[242:243], v171 offset:256
    v_mfma_f32_16x16x32_bf16 v[68:71], a[244:247], a[208:211], v[68:71]
    s_sub_u32 s57, s89, 1152
    s_min_u32 s89, s89, s57
    v_mfma_f32_16x16x32_bf16 v[100:103], a[244:247], a[212:215], v[100:103]
    s_add_u32 m0, s42, 0
    v_mfma_f32_16x16x32_bf16 v[132:135], a[244:247], a[216:219], v[132:135]
    buffer_load_dwordx4 v2, s[4:7], s29 offen sc1 lds
    v_mfma_f32_16x16x32_bf16 v[40:43], a[248:251], a[204:207], v[40:43]
    s_add_u32 m0, s42, 1024
    ds_read_b64_tr_b16 a[244:245], v171 offset:8
    ds_read_b64_tr_b16 a[246:247], v171 offset:264
    v_mfma_f32_16x16x32_bf16 v[72:75], a[248:251], a[208:211], v[72:75]
    s_add_u32 s46, s29, 9216
    v_mfma_f32_16x16x32_bf16 v[104:107], a[248:251], a[212:215], v[104:107]
    buffer_load_dwordx4 v3, s[4:7], s46 offen sc1 lds
    v_mfma_f32_16x16x32_bf16 v[136:139], a[248:251], a[216:219], v[136:139]
    s_add_u32 m0, s42, 2048
    s_add_u32 s46, s29, 18432
    v_mfma_f32_16x16x32_bf16 v[44:47], a[252:255], a[204:207], v[44:47]
    ds_read_b128 a[204:207], v167 offset:0
    v_mfma_f32_16x16x32_bf16 v[76:79], a[252:255], a[208:211], v[76:79]
    ds_read_b64_tr_b16 a[248:249], v171 offset:64
    ds_read_b64_tr_b16 a[250:251], v171 offset:320
    v_mfma_f32_16x16x32_bf16 v[108:111], a[252:255], a[212:215], v[108:111]
    ds_read_b128 a[208:211], v167 offset:2048
    v_mfma_f32_16x16x32_bf16 v[140:143], a[252:255], a[216:219], v[140:143]
    s_waitcnt lgkmcnt(14)
    ds_read_b128 a[212:215], v167 offset:4096
    v_mfma_f32_16x16x32_bf16 v[16:19], a[224:227], a[184:187], v[16:19]
    ds_read_b128 a[216:219], v167 offset:6144
    v_mfma_f32_16x16x32_bf16 v[48:51], a[224:227], a[188:191], v[48:51]
    ds_read_b128 a[220:223], v169 offset:0
    v_mfma_f32_16x16x32_bf16 v[80:83], a[224:227], a[192:195], v[80:83]
    ds_read_b64_tr_b16 a[252:253], v171 offset:72
    ds_read_b64_tr_b16 a[254:255], v171 offset:328
    v_mfma_f32_16x16x32_bf16 v[112:115], a[224:227], a[196:199], v[112:115]
    buffer_load_dwordx4 v2, s[4:7], s46 offen sc1 lds
    v_mfma_f32_16x16x32_bf16 v[144:147], a[224:227], a[200:203], v[144:147]
    s_waitcnt lgkmcnt(15)
    s_add_u32 m0, s42, 3072
    s_add_u32 s46, s29, 27648
    v_mfma_f32_16x16x32_bf16 v[20:23], a[228:231], a[184:187], v[20:23]
    ds_read_b64_tr_b16 a[224:225], v170 offset:512
    ds_read_b64_tr_b16 a[226:227], v170 offset:768
    v_mfma_f32_16x16x32_bf16 v[52:55], a[228:231], a[188:191], v[52:55]
    buffer_load_dwordx4 v3, s[4:7], s46 offen sc1 lds
    v_mfma_f32_16x16x32_bf16 v[84:87], a[228:231], a[192:195], v[84:87]
    s_add_u32 m0, s42, 4096
    s_add_u32 s46, s29, 36864
    v_mfma_f32_16x16x32_bf16 v[116:119], a[228:231], a[196:199], v[116:119]
    buffer_load_dwordx4 v2, s[4:7], s46 offen sc1 lds
    v_mfma_f32_16x16x32_bf16 v[148:151], a[228:231], a[200:203], v[148:151]
    s_add_u32 m0, s42, 5120
    s_add_u32 s46, s29, 46080
    v_mfma_f32_16x16x32_bf16 v[24:27], a[232:235], a[184:187], v[24:27]
    ds_read_b64_tr_b16 a[228:229], v170 offset:520
    ds_read_b64_tr_b16 a[230:231], v170 offset:776
    v_mfma_f32_16x16x32_bf16 v[56:59], a[232:235], a[188:191], v[56:59]
    buffer_load_dwordx4 v3, s[4:7], s46 offen sc1 lds
    v_mfma_f32_16x16x32_bf16 v[88:91], a[232:235], a[192:195], v[88:91]
    s_add_u32 m0, s42, 6144
    s_add_u32 s46, s29, 55296
    v_mfma_f32_16x16x32_bf16 v[120:123], a[232:235], a[196:199], v[120:123]
    buffer_load_dwordx4 v2, s[4:7], s46 offen sc1 lds
    v_mfma_f32_16x16x32_bf16 v[152:155], a[232:235], a[200:203], v[152:155]
    s_waitcnt lgkmcnt(15)
    s_add_u32 m0, s42, 7168
    s_add_u32 s46, s29, 64512
    v_mfma_f32_16x16x32_bf16 v[28:31], a[236:239], a[184:187], v[28:31]
    ds_read_b64_tr_b16 a[232:233], v170 offset:576
    ds_read_b64_tr_b16 a[234:235], v170 offset:832
    v_mfma_f32_16x16x32_bf16 v[60:63], a[236:239], a[188:191], v[60:63]
    buffer_load_dwordx4 v3, s[4:7], s46 offen sc1 lds
    v_mfma_f32_16x16x32_bf16 v[92:95], a[236:239], a[192:195], v[92:95]
    s_lshl_b32 s26, s100, 12
    s_add_u32 s26, s26, s45
    v_mfma_f32_16x16x32_bf16 v[124:127], a[236:239], a[196:199], v[124:127]
    s_add_u32 s101, s55, s100
    s_add_u32 s100, s100, 128
    v_mfma_f32_16x16x32_bf16 v[156:159], a[236:239], a[200:203], v[156:159]
    s_sub_u32 s57, s100, 1152
    s_min_u32 s100, s100, s57
    v_mfma_f32_16x16x32_bf16 v[32:35], a[240:243], a[184:187], v[32:35]
    s_add_u32 m0, s44, 0
    ds_read_b64_tr_b16 a[236:237], v170 offset:584
    ds_read_b64_tr_b16 a[238:239], v170 offset:840
    v_mfma_f32_16x16x32_bf16 v[64:67], a[240:243], a[188:191], v[64:67]
    buffer_load_dwordx4 v5, s[8:11], s26 offen sc1 lds
    v_mfma_f32_16x16x32_bf16 v[96:99], a[240:243], a[192:195], v[96:99]
    s_add_u32 m0, s44, 1088
    s_add_u32 s46, s26, 8192
    v_mfma_f32_16x16x32_bf16 v[128:131], a[240:243], a[196:199], v[128:131]
    s_waitcnt lgkmcnt(15)
    buffer_load_dwordx4 v5, s[8:11], s46 offen sc1 lds
    v_mfma_f32_16x16x32_bf16 v[36:39], a[244:247], a[184:187], v[36:39]
    s_add_u32 m0, s44, 2176
    ds_read_b64_tr_b16 a[240:241], v171 offset:512
    ds_read_b64_tr_b16 a[242:243], v171 offset:768
    v_mfma_f32_16x16x32_bf16 v[68:71], a[244:247], a[188:191], v[68:71]
    s_add_u32 s46, s26, 16384
    v_mfma_f32_16x16x32_bf16 v[100:103], a[244:247], a[192:195], v[100:103]
    buffer_load_dwordx4 v5, s[8:11], s46 offen sc1 lds
    v_mfma_f32_16x16x32_bf16 v[132:135], a[244:247], a[196:199], v[132:135]
    s_waitcnt lgkmcnt(15)
    s_add_u32 m0, s44, 3264
    s_add_u32 s46, s26, 24576
    v_mfma_f32_16x16x32_bf16 v[40:43], a[248:251], a[184:187], v[40:43]
    ds_read_b64_tr_b16 a[244:245], v171 offset:520
    ds_read_b64_tr_b16 a[246:247], v171 offset:776
    v_mfma_f32_16x16x32_bf16 v[72:75], a[248:251], a[188:191], v[72:75]
    buffer_load_dwordx4 v5, s[8:11], s46 offen sc1 lds
    v_mfma_f32_16x16x32_bf16 v[104:107], a[248:251], a[192:195], v[104:107]
    s_add_u32 m0, s48, 0
    v_mfma_f32_16x16x32_bf16 v[136:139], a[248:251], a[196:199], v[136:139]
    s_waitcnt lgkmcnt(12)
    buffer_load_dwordx4 v4, s[4:7], s101 offen sc1 lds
    v_mfma_f32_16x16x32_bf16 v[44:47], a[252:255], a[184:187], v[44:47]
    ds_read_b64_tr_b16 a[248:249], v171 offset:576
    ds_read_b64_tr_b16 a[250:251], v171 offset:832
    v_mfma_f32_16x16x32_bf16 v[76:79], a[252:255], a[188:191], v[76:79]
    s_add_u32 s29, s43, s89
    s_nop 0
    v_mfma_f32_16x16x32_bf16 v[108:111], a[252:255], a[192:195], v[108:111]
    s_add_u32 s89, s89, 128
    s_sub_u32 s57, s89, 1152
    v_mfma_f32_16x16x32_bf16 v[140:143], a[252:255], a[196:199], v[140:143]
    s_waitcnt lgkmcnt(12)
    s_min_u32 s89, s89, s57
    s_add_u32 m0, s42, 108544
    v_mfma_f32_16x16x32_bf16 v[16:19], a[224:227], a[204:207], v[16:19]
    ds_read_b64_tr_b16 a[252:253], v171 offset:584
    ds_read_b64_tr_b16 a[254:255], v171 offset:840
    v_mfma_f32_16x16x32_bf16 v[48:51], a[224:227], a[208:211], v[48:51]
    buffer_load_dwordx4 v2, s[4:7], s29 offen sc1 lds
    v_mfma_f32_16x16x32_bf16 v[80:83], a[224:227], a[212:215], v[80:83]
    s_add_u32 m0, s42, 109568
    s_add_u32 s46, s29, 9216
    v_mfma_f32_16x16x32_bf16 v[112:115], a[224:227], a[216:219], v[112:115]
    buffer_load_dwordx4 v3, s[4:7], s46 offen sc1 lds
    v_mfma_f32_16x16x32_bf16 v[144:147], a[224:227], a[220:223], v[144:147]
    s_waitcnt lgkmcnt(12)
    v_mfma_f32_16x16x32_bf16 v[20:23], a[228:231], a[204:207], v[20:23]
    v_mfma_f32_16x16x32_bf16 v[52:55], a[228:231], a[208:211], v[52:55]
    v_mfma_f32_16x16x32_bf16 v[84:87], a[228:231], a[212:215], v[84:87]
    s_add_u32 m0, s42, 110592
    s_add_u32 s46, s29, 18432
    v_mfma_f32_16x16x32_bf16 v[116:119], a[228:231], a[216:219], v[116:119]
    buffer_load_dwordx4 v2, s[4:7], s46 offen sc1 lds
    v_mfma_f32_16x16x32_bf16 v[148:151], a[228:231], a[220:223], v[148:151]
    s_waitcnt lgkmcnt(10)
    s_add_u32 m0, s42, 111616
    s_add_u32 s46, s29, 27648
    v_mfma_f32_16x16x32_bf16 v[24:27], a[232:235], a[204:207], v[24:27]
    buffer_load_dwordx4 v3, s[4:7], s46 offen sc1 lds
    v_mfma_f32_16x16x32_bf16 v[56:59], a[232:235], a[208:211], v[56:59]
    s_add_u32 m0, s42, 112640
    s_add_u32 s46, s29, 36864
    v_mfma_f32_16x16x32_bf16 v[88:91], a[232:235], a[212:215], v[88:91]
    buffer_load_dwordx4 v2, s[4:7], s46 offen sc1 lds
    v_mfma_f32_16x16x32_bf16 v[120:123], a[232:235], a[216:219], v[120:123]
    s_add_u32 m0, s42, 113664
    s_add_u32 s46, s29, 46080
    v_mfma_f32_16x16x32_bf16 v[152:155], a[232:235], a[220:223], v[152:155]
    s_waitcnt vmcnt(18) lgkmcnt(0)
    s_barrier
    ds_read_b128 a[184:187], v160 offset:54272
    v_mfma_f32_16x16x32_bf16 v[28:31], a[236:239], a[204:207], v[28:31]
    ds_read_b128 a[188:191], v160 offset:56320
    v_mfma_f32_16x16x32_bf16 v[60:63], a[236:239], a[208:211], v[60:63]
    ds_read_b128 a[192:195], v160 offset:58368
    v_mfma_f32_16x16x32_bf16 v[92:95], a[236:239], a[212:215], v[92:95]
    ds_read_b128 a[196:199], v160 offset:60416
    v_mfma_f32_16x16x32_bf16 v[124:127], a[236:239], a[216:219], v[124:127]
    ds_read_b128 a[200:203], v162 offset:54272
    v_mfma_f32_16x16x32_bf16 v[156:159], a[236:239], a[220:223], v[156:159]
    ds_read_b64_tr_b16 a[224:225], v164 offset:54272
    ds_read_b64_tr_b16 a[226:227], v164 offset:54528
    v_mfma_f32_16x16x32_bf16 v[32:35], a[240:243], a[204:207], v[32:35]
    ds_read_b64_tr_b16 a[228:229], v164 offset:54280
    ds_read_b64_tr_b16 a[230:231], v164 offset:54536
    v_mfma_f32_16x16x32_bf16 v[64:67], a[240:243], a[208:211], v[64:67]
    ds_read_b64_tr_b16 a[232:233], v164 offset:54336
    ds_read_b64_tr_b16 a[234:235], v164 offset:54592
    v_mfma_f32_16x16x32_bf16 v[96:99], a[240:243], a[212:215], v[96:99]
    ds_read_b64_tr_b16 a[236:237], v164 offset:54344
    ds_read_b64_tr_b16 a[238:239], v164 offset:54600
    v_mfma_f32_16x16x32_bf16 v[128:131], a[240:243], a[216:219], v[128:131]
    buffer_load_dwordx4 v3, s[4:7], s46 offen sc1 lds
    v_mfma_f32_16x16x32_bf16 v[36:39], a[244:247], a[204:207], v[36:39]
    s_add_u32 m0, s42, 114688
    ds_read_b64_tr_b16 a[240:241], v165 offset:54272
    ds_read_b64_tr_b16 a[242:243], v165 offset:54528
    v_mfma_f32_16x16x32_bf16 v[68:71], a[244:247], a[208:211], v[68:71]
    s_add_u32 s46, s29, 55296
    v_mfma_f32_16x16x32_bf16 v[100:103], a[244:247], a[212:215], v[100:103]
    buffer_load_dwordx4 v2, s[4:7], s46 offen sc1 lds
    v_mfma_f32_16x16x32_bf16 v[132:135], a[244:247], a[216:219], v[132:135]
    s_add_u32 m0, s42, 115712
    s_add_u32 s46, s29, 64512
    v_mfma_f32_16x16x32_bf16 v[40:43], a[248:251], a[204:207], v[40:43]
    ds_read_b64_tr_b16 a[244:245], v165 offset:54280
    ds_read_b64_tr_b16 a[246:247], v165 offset:54536
    v_mfma_f32_16x16x32_bf16 v[72:75], a[248:251], a[208:211], v[72:75]
    buffer_load_dwordx4 v3, s[4:7], s46 offen sc1 lds
    v_mfma_f32_16x16x32_bf16 v[104:107], a[248:251], a[212:215], v[104:107]
    s_lshl_b32 s26, s100, 12
    s_add_u32 s26, s26, s45
    v_mfma_f32_16x16x32_bf16 v[136:139], a[248:251], a[216:219], v[136:139]
    s_add_u32 s101, s55, s100
    s_add_u32 s100, s100, 128
    v_mfma_f32_16x16x32_bf16 v[44:47], a[252:255], a[204:207], v[44:47]
    s_sub_u32 s57, s100, 1152
    ds_read_b128 a[204:207], v161 offset:54272
    v_mfma_f32_16x16x32_bf16 v[76:79], a[252:255], a[208:211], v[76:79]
    s_min_u32 s100, s100, s57
    ds_read_b64_tr_b16 a[248:249], v165 offset:54336
    ds_read_b64_tr_b16 a[250:251], v165 offset:54592
    v_mfma_f32_16x16x32_bf16 v[108:111], a[252:255], a[212:215], v[108:111]
    s_add_u32 m0, s44, 108544
    ds_read_b128 a[208:211], v161 offset:56320
    v_mfma_f32_16x16x32_bf16 v[140:143], a[252:255], a[216:219], v[140:143]
    s_waitcnt lgkmcnt(14)
    ds_read_b128 a[212:215], v161 offset:58368
    v_mfma_f32_16x16x32_bf16 v[16:19], a[224:227], a[184:187], v[16:19]
    ds_read_b128 a[216:219], v161 offset:60416
    v_mfma_f32_16x16x32_bf16 v[48:51], a[224:227], a[188:191], v[48:51]
    ds_read_b128 a[220:223], v163 offset:54272
    v_mfma_f32_16x16x32_bf16 v[80:83], a[224:227], a[192:195], v[80:83]
    ds_read_b64_tr_b16 a[252:253], v165 offset:54344
    ds_read_b64_tr_b16 a[254:255], v165 offset:54600
    v_mfma_f32_16x16x32_bf16 v[112:115], a[224:227], a[196:199], v[112:115]
    buffer_load_dwordx4 v5, s[8:11], s26 offen sc1 lds
    v_mfma_f32_16x16x32_bf16 v[144:147], a[224:227], a[200:203], v[144:147]
    s_waitcnt lgkmcnt(15)
    s_add_u32 m0, s44, 109632
    s_add_u32 s46, s26, 8192
    v_mfma_f32_16x16x32_bf16 v[20:23], a[228:231], a[184:187], v[20:23]
    ds_read_b64_tr_b16 a[224:225], v164 offset:54784
    ds_read_b64_tr_b16 a[226:227], v164 offset:55040
    v_mfma_f32_16x16x32_bf16 v[52:55], a[228:231], a[188:191], v[52:55]
    buffer_load_dwordx4 v5, s[8:11], s46 offen sc1 lds
    v_mfma_f32_16x16x32_bf16 v[84:87], a[228:231], a[192:195], v[84:87]
    v_mfma_f32_16x16x32_bf16 v[116:119], a[228:231], a[196:199], v[116:119]
    v_mfma_f32_16x16x32_bf16 v[148:151], a[228:231], a[200:203], v[148:151]
    s_add_u32 m0, s44, 110720
    s_add_u32 s46, s26, 16384
    v_mfma_f32_16x16x32_bf16 v[24:27], a[232:235], a[184:187], v[24:27]
    ds_read_b64_tr_b16 a[228:229], v164 offset:54792
    ds_read_b64_tr_b16 a[230:231], v164 offset:55048
    v_mfma_f32_16x16x32_bf16 v[56:59], a[232:235], a[188:191], v[56:59]
    buffer_load_dwordx4 v5, s[8:11], s46 offen sc1 lds
    v_mfma_f32_16x16x32_bf16 v[88:91], a[232:235], a[192:195], v[88:91]
    s_add_u32 m0, s44, 111808
    s_add_u32 s46, s26, 24576
    v_mfma_f32_16x16x32_bf16 v[120:123], a[232:235], a[196:199], v[120:123]
    buffer_load_dwordx4 v5, s[8:11], s46 offen sc1 lds
    v_mfma_f32_16x16x32_bf16 v[152:155], a[232:235], a[200:203], v[152:155]
    s_waitcnt lgkmcnt(15)
    s_add_u32 m0, s48, 108544
    v_mfma_f32_16x16x32_bf16 v[28:31], a[236:239], a[184:187], v[28:31]
    ds_read_b64_tr_b16 a[232:233], v164 offset:54848
    ds_read_b64_tr_b16 a[234:235], v164 offset:55104
    v_mfma_f32_16x16x32_bf16 v[60:63], a[236:239], a[188:191], v[60:63]
    buffer_load_dwordx4 v4, s[4:7], s101 offen sc1 lds
    v_mfma_f32_16x16x32_bf16 v[92:95], a[236:239], a[192:195], v[92:95]
    s_add_u32 s29, s43, s89
    s_waitcnt lgkmcnt(8)
    s_nop 0
    v_mfma_f32_16x16x32_bf16 v[124:127], a[236:239], a[196:199], v[124:127]
    s_add_u32 s89, s89, 128
    s_sub_u32 s57, s89, 1152
    v_mfma_f32_16x16x32_bf16 v[156:159], a[236:239], a[200:203], v[156:159]
    s_min_u32 s89, s89, s57
    s_add_u32 m0, s42, 54272
    v_mfma_f32_16x16x32_bf16 v[32:35], a[240:243], a[184:187], v[32:35]
    ds_read_b64_tr_b16 a[236:237], v164 offset:54856
    ds_read_b64_tr_b16 a[238:239], v164 offset:55112
    v_mfma_f32_16x16x32_bf16 v[64:67], a[240:243], a[188:191], v[64:67]
    buffer_load_dwordx4 v2, s[4:7], s29 offen sc1 lds
    v_mfma_f32_16x16x32_bf16 v[96:99], a[240:243], a[192:195], v[96:99]
    s_add_u32 m0, s42, 55296
    s_add_u32 s46, s29, 9216
    v_mfma_f32_16x16x32_bf16 v[128:131], a[240:243], a[196:199], v[128:131]
    buffer_load_dwordx4 v3, s[4:7], s46 offen sc1 lds
    v_mfma_f32_16x16x32_bf16 v[36:39], a[244:247], a[184:187], v[36:39]
    ds_read_b64_tr_b16 a[240:241], v165 offset:54784
    ds_read_b64_tr_b16 a[242:243], v165 offset:55040
    v_mfma_f32_16x16x32_bf16 v[68:71], a[244:247], a[188:191], v[68:71]
    v_mfma_f32_16x16x32_bf16 v[100:103], a[244:247], a[192:195], v[100:103]
    v_mfma_f32_16x16x32_bf16 v[132:135], a[244:247], a[196:199], v[132:135]
    s_add_u32 m0, s42, 56320
    s_add_u32 s46, s29, 18432
    v_mfma_f32_16x16x32_bf16 v[40:43], a[248:251], a[184:187], v[40:43]
    ds_read_b64_tr_b16 a[244:245], v165 offset:54792
    ds_read_b64_tr_b16 a[246:247], v165 offset:55048
    v_mfma_f32_16x16x32_bf16 v[72:75], a[248:251], a[188:191], v[72:75]
    buffer_load_dwordx4 v2, s[4:7], s46 offen sc1 lds
    v_mfma_f32_16x16x32_bf16 v[104:107], a[248:251], a[192:195], v[104:107]
    v_mfma_f32_16x16x32_bf16 v[136:139], a[248:251], a[196:199], v[136:139]
    s_waitcnt lgkmcnt(12)
    v_mfma_f32_16x16x32_bf16 v[44:47], a[252:255], a[184:187], v[44:47]
    s_add_u32 m0, s42, 57344
    ds_read_b64_tr_b16 a[248:249], v165 offset:54848
    ds_read_b64_tr_b16 a[250:251], v165 offset:55104
    v_mfma_f32_16x16x32_bf16 v[76:79], a[252:255], a[188:191], v[76:79]
    s_add_u32 s46, s29, 27648
    v_mfma_f32_16x16x32_bf16 v[108:111], a[252:255], a[192:195], v[108:111]
    buffer_load_dwordx4 v3, s[4:7], s46 offen sc1 lds
    v_mfma_f32_16x16x32_bf16 v[140:143], a[252:255], a[196:199], v[140:143]
    s_waitcnt lgkmcnt(12)
    v_mfma_f32_16x16x32_bf16 v[16:19], a[224:227], a[204:207], v[16:19]
    ds_read_b64_tr_b16 a[252:253], v165 offset:54856
    ds_read_b64_tr_b16 a[254:255], v165 offset:55112
    v_mfma_f32_16x16x32_bf16 v[48:51], a[224:227], a[208:211], v[48:51]
    s_add_u32 m0, s42, 58368
    s_add_u32 s46, s29, 36864
    v_mfma_f32_16x16x32_bf16 v[80:83], a[224:227], a[212:215], v[80:83]
    buffer_load_dwordx4 v2, s[4:7], s46 offen sc1 lds
    v_mfma_f32_16x16x32_bf16 v[112:115], a[224:227], a[216:219], v[112:115]
    v_mfma_f32_16x16x32_bf16 v[144:147], a[224:227], a[220:223], v[144:147]
    s_waitcnt lgkmcnt(12)
    v_mfma_f32_16x16x32_bf16 v[20:23], a[228:231], a[204:207], v[20:23]
    v_mfma_f32_16x16x32_bf16 v[52:55], a[228:231], a[208:211], v[52:55]
    s_add_u32 m0, s42, 59392
    s_add_u32 s46, s29, 46080
    v_mfma_f32_16x16x32_bf16 v[84:87], a[228:231], a[212:215], v[84:87]
    buffer_load_dwordx4 v3, s[4:7], s46 offen sc1 lds
    v_mfma_f32_16x16x32_bf16 v[116:119], a[228:231], a[216:219], v[116:119]
    s_add_u32 m0, s42, 60416
    s_add_u32 s46, s29, 55296
    v_mfma_f32_16x16x32_bf16 v[148:151], a[228:231], a[220:223], v[148:151]
    s_waitcnt lgkmcnt(10)
    buffer_load_dwordx4 v2, s[4:7], s46 offen sc1 lds
    v_mfma_f32_16x16x32_bf16 v[24:27], a[232:235], a[204:207], v[24:27]
    s_add_u32 m0, s42, 61440
    s_add_u32 s46, s29, 64512
    v_mfma_f32_16x16x32_bf16 v[56:59], a[232:235], a[208:211], v[56:59]
    buffer_load_dwordx4 v3, s[4:7], s46 offen sc1 lds
    v_mfma_f32_16x16x32_bf16 v[88:91], a[232:235], a[212:215], v[88:91]
    v_mfma_f32_16x16x32_bf16 v[120:123], a[232:235], a[216:219], v[120:123]
    v_mfma_f32_16x16x32_bf16 v[152:155], a[232:235], a[220:223], v[152:155]
    s_waitcnt vmcnt(21) lgkmcnt(0)
    s_barrier
    s_lshl_b32 s26, s100, 12
    ds_read_b128 a[184:187], v160 offset:0
    v_mfma_f32_16x16x32_bf16 v[28:31], a[236:239], a[204:207], v[28:31]
    s_add_u32 s26, s26, s45
    ds_read_b128 a[188:191], v160 offset:2048
    v_mfma_f32_16x16x32_bf16 v[60:63], a[236:239], a[208:211], v[60:63]
    s_add_u32 s101, s55, s100
    ds_read_b128 a[192:195], v160 offset:4096
    v_mfma_f32_16x16x32_bf16 v[92:95], a[236:239], a[212:215], v[92:95]
    s_add_u32 s100, s100, 128
    ds_read_b128 a[196:199], v160 offset:6144
    v_mfma_f32_16x16x32_bf16 v[124:127], a[236:239], a[216:219], v[124:127]
    s_sub_u32 s57, s100, 1152
    ds_read_b128 a[200:203], v162 offset:0
    v_mfma_f32_16x16x32_bf16 v[156:159], a[236:239], a[220:223], v[156:159]
    s_min_u32 s100, s100, s57
    ds_read_b64_tr_b16 a[224:225], v164 offset:0
    ds_read_b64_tr_b16 a[226:227], v164 offset:256
    v_mfma_f32_16x16x32_bf16 v[32:35], a[240:243], a[204:207], v[32:35]
    s_add_u32 m0, s44, 54272
    ds_read_b64_tr_b16 a[228:229], v164 offset:8
    ds_read_b64_tr_b16 a[230:231], v164 offset:264
    v_mfma_f32_16x16x32_bf16 v[64:67], a[240:243], a[208:211], v[64:67]
    ds_read_b64_tr_b16 a[232:233], v164 offset:64
    ds_read_b64_tr_b16 a[234:235], v164 offset:320
    v_mfma_f32_16x16x32_bf16 v[96:99], a[240:243], a[212:215], v[96:99]
    ds_read_b64_tr_b16 a[236:237], v164 offset:72
    ds_read_b64_tr_b16 a[238:239], v164 offset:328
    v_mfma_f32_16x16x32_bf16 v[128:131], a[240:243], a[216:219], v[128:131]
    buffer_load_dwordx4 v5, s[8:11], s26 offen sc1 lds
    v_mfma_f32_16x16x32_bf16 v[36:39], a[244:247], a[204:207], v[36:39]
    s_add_u32 m0, s44, 55360
    ds_read_b64_tr_b16 a[240:241], v165 offset:0
    ds_read_b64_tr_b16 a[242:243], v165 offset:256
    v_mfma_f32_16x16x32_bf16 v[68:71], a[244:247], a[208:211], v[68:71]
    s_add_u32 s46, s26, 8192
    v_mfma_f32_16x16x32_bf16 v[100:103], a[244:247], a[212:215], v[100:103]
    buffer_load_dwordx4 v5, s[8:11], s46 offen sc1 lds
    v_mfma_f32_16x16x32_bf16 v[132:135], a[244:247], a[216:219], v[132:135]
    v_mfma_f32_16x16x32_bf16 v[40:43], a[248:251], a[204:207], v[40:43]
    ds_read_b64_tr_b16 a[244:245], v165 offset:8
    ds_read_b64_tr_b16 a[246:247], v165 offset:264
    v_mfma_f32_16x16x32_bf16 v[72:75], a[248:251], a[208:211], v[72:75]
    s_add_u32 m0, s44, 56448
    s_add_u32 s46, s26, 16384
    v_mfma_f32_16x16x32_bf16 v[104:107], a[248:251], a[212:215], v[104:107]
    buffer_load_dwordx4 v5, s[8:11], s46 offen sc1 lds
    v_mfma_f32_16x16x32_bf16 v[136:139], a[248:251], a[216:219], v[136:139]
    v_mfma_f32_16x16x32_bf16 v[44:47], a[252:255], a[204:207], v[44:47]
    ds_read_b128 a[204:207], v161 offset:0
    v_mfma_f32_16x16x32_bf16 v[76:79], a[252:255], a[208:211], v[76:79]
    ds_read_b64_tr_b16 a[248:249], v165 offset:64
    ds_read_b64_tr_b16 a[250:251], v165 offset:320
    v_mfma_f32_16x16x32_bf16 v[108:111], a[252:255], a[212:215], v[108:111]
    s_add_u32 m0, s44, 57536
    ds_read_b128 a[208:211], v161 offset:2048
    v_mfma_f32_16x16x32_bf16 v[140:143], a[252:255], a[216:219], v[140:143]
    s_waitcnt lgkmcnt(14)
    s_add_u32 s46, s26, 24576
    ds_read_b128 a[212:215], v161 offset:4096
    v_mfma_f32_16x16x32_bf16 v[16:19], a[224:227], a[184:187], v[16:19]
    ds_read_b128 a[216:219], v161 offset:6144
    v_mfma_f32_16x16x32_bf16 v[48:51], a[224:227], a[188:191], v[48:51]
    ds_read_b128 a[220:223], v163 offset:0
    v_mfma_f32_16x16x32_bf16 v[80:83], a[224:227], a[192:195], v[80:83]
    ds_read_b64_tr_b16 a[252:253], v165 offset:72
    ds_read_b64_tr_b16 a[254:255], v165 offset:328
    v_mfma_f32_16x16x32_bf16 v[112:115], a[224:227], a[196:199], v[112:115]
    buffer_load_dwordx4 v5, s[8:11], s46 offen sc1 lds
    v_mfma_f32_16x16x32_bf16 v[144:147], a[224:227], a[200:203], v[144:147]
    s_waitcnt lgkmcnt(15)
    s_add_u32 m0, s48, 54272
    v_mfma_f32_16x16x32_bf16 v[20:23], a[228:231], a[184:187], v[20:23]
    ds_read_b64_tr_b16 a[224:225], v164 offset:512
    ds_read_b64_tr_b16 a[226:227], v164 offset:768
    v_mfma_f32_16x16x32_bf16 v[52:55], a[228:231], a[188:191], v[52:55]
    buffer_load_dwordx4 v4, s[4:7], s101 offen sc1 lds
    v_mfma_f32_16x16x32_bf16 v[84:87], a[228:231], a[192:195], v[84:87]
    v_mfma_f32_16x16x32_bf16 v[116:119], a[228:231], a[196:199], v[116:119]
    v_mfma_f32_16x16x32_bf16 v[148:151], a[228:231], a[200:203], v[148:151]
    v_mfma_f32_16x16x32_bf16 v[24:27], a[232:235], a[184:187], v[24:27]
    ds_read_b64_tr_b16 a[228:229], v164 offset:520
    ds_read_b64_tr_b16 a[230:231], v164 offset:776
    v_mfma_f32_16x16x32_bf16 v[56:59], a[232:235], a[188:191], v[56:59]
    v_mfma_f32_16x16x32_bf16 v[88:91], a[232:235], a[192:195], v[88:91]
    v_mfma_f32_16x16x32_bf16 v[120:123], a[232:235], a[196:199], v[120:123]
    v_mfma_f32_16x16x32_bf16 v[152:155], a[232:235], a[200:203], v[152:155]
    s_waitcnt lgkmcnt(15)
    v_mfma_f32_16x16x32_bf16 v[28:31], a[236:239], a[184:187], v[28:31]
    ds_read_b64_tr_b16 a[232:233], v164 offset:576
    ds_read_b64_tr_b16 a[234:235], v164 offset:832
    v_mfma_f32_16x16x32_bf16 v[60:63], a[236:239], a[188:191], v[60:63]
    v_mfma_f32_16x16x32_bf16 v[92:95], a[236:239], a[192:195], v[92:95]
    v_mfma_f32_16x16x32_bf16 v[124:127], a[236:239], a[196:199], v[124:127]
    v_mfma_f32_16x16x32_bf16 v[156:159], a[236:239], a[200:203], v[156:159]
    v_mfma_f32_16x16x32_bf16 v[32:35], a[240:243], a[184:187], v[32:35]
    ds_read_b64_tr_b16 a[236:237], v164 offset:584
    ds_read_b64_tr_b16 a[238:239], v164 offset:840
    v_mfma_f32_16x16x32_bf16 v[64:67], a[240:243], a[188:191], v[64:67]
    v_mfma_f32_16x16x32_bf16 v[96:99], a[240:243], a[192:195], v[96:99]
    v_mfma_f32_16x16x32_bf16 v[128:131], a[240:243], a[196:199], v[128:131]
    s_waitcnt lgkmcnt(15)
    v_mfma_f32_16x16x32_bf16 v[36:39], a[244:247], a[184:187], v[36:39]
    ds_read_b64_tr_b16 a[240:241], v165 offset:512
    ds_read_b64_tr_b16 a[242:243], v165 offset:768
    v_mfma_f32_16x16x32_bf16 v[68:71], a[244:247], a[188:191], v[68:71]
    v_mfma_f32_16x16x32_bf16 v[100:103], a[244:247], a[192:195], v[100:103]
    v_mfma_f32_16x16x32_bf16 v[132:135], a[244:247], a[196:199], v[132:135]
    s_waitcnt lgkmcnt(15)
    v_mfma_f32_16x16x32_bf16 v[40:43], a[248:251], a[184:187], v[40:43]
    ds_read_b64_tr_b16 a[244:245], v165 offset:520
    ds_read_b64_tr_b16 a[246:247], v165 offset:776
    v_mfma_f32_16x16x32_bf16 v[72:75], a[248:251], a[188:191], v[72:75]
    v_mfma_f32_16x16x32_bf16 v[104:107], a[248:251], a[192:195], v[104:107]
    v_mfma_f32_16x16x32_bf16 v[136:139], a[248:251], a[196:199], v[136:139]
    s_waitcnt lgkmcnt(12)
    v_mfma_f32_16x16x32_bf16 v[44:47], a[252:255], a[184:187], v[44:47]
    ds_read_b64_tr_b16 a[248:249], v165 offset:576
    ds_read_b64_tr_b16 a[250:251], v165 offset:832
    v_mfma_f32_16x16x32_bf16 v[76:79], a[252:255], a[188:191], v[76:79]
    v_mfma_f32_16x16x32_bf16 v[108:111], a[252:255], a[192:195], v[108:111]
    v_mfma_f32_16x16x32_bf16 v[140:143], a[252:255], a[196:199], v[140:143]
    s_waitcnt lgkmcnt(12)
    v_mfma_f32_16x16x32_bf16 v[16:19], a[224:227], a[204:207], v[16:19]
    ds_read_b64_tr_b16 a[252:253], v165 offset:584
    ds_read_b64_tr_b16 a[254:255], v165 offset:840
    v_mfma_f32_16x16x32_bf16 v[48:51], a[224:227], a[208:211], v[48:51]
    v_mfma_f32_16x16x32_bf16 v[80:83], a[224:227], a[212:215], v[80:83]
    v_mfma_f32_16x16x32_bf16 v[112:115], a[224:227], a[216:219], v[112:115]
    v_mfma_f32_16x16x32_bf16 v[144:147], a[224:227], a[220:223], v[144:147]
    s_waitcnt lgkmcnt(12)
    v_mfma_f32_16x16x32_bf16 v[20:23], a[228:231], a[204:207], v[20:23]
    v_mfma_f32_16x16x32_bf16 v[52:55], a[228:231], a[208:211], v[52:55]
    v_mfma_f32_16x16x32_bf16 v[84:87], a[228:231], a[212:215], v[84:87]
    v_mfma_f32_16x16x32_bf16 v[116:119], a[228:231], a[216:219], v[116:119]
    v_mfma_f32_16x16x32_bf16 v[148:151], a[228:231], a[220:223], v[148:151]
    s_waitcnt lgkmcnt(10)
    v_mfma_f32_16x16x32_bf16 v[24:27], a[232:235], a[204:207], v[24:27]
    v_mfma_f32_16x16x32_bf16 v[56:59], a[232:235], a[208:211], v[56:59]
    v_mfma_f32_16x16x32_bf16 v[88:91], a[232:235], a[212:215], v[88:91]
    v_mfma_f32_16x16x32_bf16 v[120:123], a[232:235], a[216:219], v[120:123]
    v_mfma_f32_16x16x32_bf16 v[152:155], a[232:235], a[220:223], v[152:155]
    s_waitcnt vmcnt(13) lgkmcnt(0)
    s_barrier
    s_add_u32 m0, s88, 0
    ds_read_b128 a[184:187], v166 offset:0
    v_mfma_f32_16x16x32_bf16 v[28:31], a[236:239], a[204:207], v[28:31]
    s_mov_b32 s46, 0
    ds_read_b128 a[188:191], v166 offset:2048
    v_mfma_f32_16x16x32_bf16 v[60:63], a[236:239], a[208:211], v[60:63]
    ds_read_b128 a[192:195], v166 offset:4096
    v_mfma_f32_16x16x32_bf16 v[92:95], a[236:239], a[212:215], v[92:95]
    ds_read_b128 a[196:199], v166 offset:6144
    v_mfma_f32_16x16x32_bf16 v[124:127], a[236:239], a[216:219], v[124:127]
    ds_read_b128 a[200:203], v168 offset:0
    v_mfma_f32_16x16x32_bf16 v[156:159], a[236:239], a[220:223], v[156:159]
    ds_read_b64_tr_b16 a[224:225], v170 offset:0
    ds_read_b64_tr_b16 a[226:227], v170 offset:256
    v_mfma_f32_16x16x32_bf16 v[32:35], a[240:243], a[204:207], v[32:35]
    ds_read_b64_tr_b16 a[228:229], v170 offset:8
    ds_read_b64_tr_b16 a[230:231], v170 offset:264
    v_mfma_f32_16x16x32_bf16 v[64:67], a[240:243], a[208:211], v[64:67]
    ds_read_b64_tr_b16 a[232:233], v170 offset:64
    ds_read_b64_tr_b16 a[234:235], v170 offset:320
    v_mfma_f32_16x16x32_bf16 v[96:99], a[240:243], a[212:215], v[96:99]
    ds_read_b64_tr_b16 a[236:237], v170 offset:72
    ds_read_b64_tr_b16 a[238:239], v170 offset:328
    v_mfma_f32_16x16x32_bf16 v[128:131], a[240:243], a[216:219], v[128:131]
    buffer_load_dwordx4 v246, s[12:15], s46 offen nt lds
    v_mfma_f32_16x16x32_bf16 v[36:39], a[244:247], a[204:207], v[36:39]
    s_add_u32 m0, s88, 1056
    ds_read_b64_tr_b16 a[240:241], v171 offset:0
    ds_read_b64_tr_b16 a[242:243], v171 offset:256
    v_mfma_f32_16x16x32_bf16 v[68:71], a[244:247], a[208:211], v[68:71]
    s_mov_b32 s46, 0
    v_mfma_f32_16x16x32_bf16 v[100:103], a[244:247], a[212:215], v[100:103]
    buffer_load_dwordx4 v247, s[12:15], s46 offen nt lds
    v_mfma_f32_16x16x32_bf16 v[132:135], a[244:247], a[216:219], v[132:135]
    v_mfma_f32_16x16x32_bf16 v[40:43], a[248:251], a[204:207], v[40:43]
    ds_read_b64_tr_b16 a[244:245], v171 offset:8
    ds_read_b64_tr_b16 a[246:247], v171 offset:264
    v_mfma_f32_16x16x32_bf16 v[72:75], a[248:251], a[208:211], v[72:75]
    s_add_u32 m0, s88, 2112
    s_mov_b32 s46, 0
    v_mfma_f32_16x16x32_bf16 v[104:107], a[248:251], a[212:215], v[104:107]
    buffer_load_dwordx4 v248, s[12:15], s46 offen nt lds
    v_mfma_f32_16x16x32_bf16 v[136:139], a[248:251], a[216:219], v[136:139]
    v_mfma_f32_16x16x32_bf16 v[44:47], a[252:255], a[204:207], v[44:47]
    ds_read_b128 a[204:207], v167 offset:0
    v_mfma_f32_16x16x32_bf16 v[76:79], a[252:255], a[208:211], v[76:79]
    ds_read_b64_tr_b16 a[248:249], v171 offset:64
    ds_read_b64_tr_b16 a[250:251], v171 offset:320
    v_mfma_f32_16x16x32_bf16 v[108:111], a[252:255], a[212:215], v[108:111]
    s_add_u32 m0, s88, 3168
    ds_read_b128 a[208:211], v167 offset:2048
    v_mfma_f32_16x16x32_bf16 v[140:143], a[252:255], a[216:219], v[140:143]
    s_waitcnt lgkmcnt(14)
    s_mov_b32 s46, 0
    ds_read_b128 a[212:215], v167 offset:4096
    v_mfma_f32_16x16x32_bf16 v[16:19], a[224:227], a[184:187], v[16:19]
    ds_read_b128 a[216:219], v167 offset:6144
    v_mfma_f32_16x16x32_bf16 v[48:51], a[224:227], a[188:191], v[48:51]
    ds_read_b128 a[220:223], v169 offset:0
    v_mfma_f32_16x16x32_bf16 v[80:83], a[224:227], a[192:195], v[80:83]
    ds_read_b64_tr_b16 a[252:253], v171 offset:72
    ds_read_b64_tr_b16 a[254:255], v171 offset:328
    v_mfma_f32_16x16x32_bf16 v[112:115], a[224:227], a[196:199], v[112:115]
    buffer_load_dwordx4 v249, s[12:15], s46 offen nt lds
    v_mfma_f32_16x16x32_bf16 v[144:147], a[224:227], a[200:203], v[144:147]
    s_waitcnt lgkmcnt(15)
    v_mfma_f32_16x16x32_bf16 v[20:23], a[228:231], a[184:187], v[20:23]
    ds_read_b64_tr_b16 a[224:225], v170 offset:512
    ds_read_b64_tr_b16 a[226:227], v170 offset:768
    v_mfma_f32_16x16x32_bf16 v[52:55], a[228:231], a[188:191], v[52:55]
    v_mfma_f32_16x16x32_bf16 v[84:87], a[228:231], a[192:195], v[84:87]
    v_mfma_f32_16x16x32_bf16 v[116:119], a[228:231], a[196:199], v[116:119]
    v_mfma_f32_16x16x32_bf16 v[148:151], a[228:231], a[200:203], v[148:151]
    v_mfma_f32_16x16x32_bf16 v[24:27], a[232:235], a[184:187], v[24:27]
    ds_read_b64_tr_b16 a[228:229], v170 offset:520
    ds_read_b64_tr_b16 a[230:231], v170 offset:776
    v_mfma_f32_16x16x32_bf16 v[56:59], a[232:235], a[188:191], v[56:59]
    s_add_u32 s29, s43, s89
    s_waitcnt lgkmcnt(6)
    s_nop 0
    v_mfma_f32_16x16x32_bf16 v[88:91], a[232:235], a[192:195], v[88:91]
    s_add_u32 s89, s89, 128
    s_sub_u32 s57, s89, 1152
    v_mfma_f32_16x16x32_bf16 v[120:123], a[232:235], a[196:199], v[120:123]
    s_min_u32 s89, s89, s57
    s_add_u32 m0, s42, 108544
    v_mfma_f32_16x16x32_bf16 v[152:155], a[232:235], a[200:203], v[152:155]
    buffer_load_dwordx4 v2, s[4:7], s29 offen sc1 lds
    v_mfma_f32_16x16x32_bf16 v[28:31], a[236:239], a[184:187], v[28:31]
    ds_read_b64_tr_b16 a[232:233], v170 offset:576
    ds_read_b64_tr_b16 a[234:235], v170 offset:832
    v_mfma_f32_16x16x32_bf16 v[60:63], a[236:239], a[188:191], v[60:63]
    s_add_u32 m0, s42, 109568
    s_add_u32 s46, s29, 9216
    v_mfma_f32_16x16x32_bf16 v[92:95], a[236:239], a[192:195], v[92:95]
    buffer_load_dwordx4 v3, s[4:7], s46 offen sc1 lds
    v_mfma_f32_16x16x32_bf16 v[124:127], a[236:239], a[196:199], v[124:127]
    v_mfma_f32_16x16x32_bf16 v[156:159], a[236:239], a[200:203], v[156:159]
    v_mfma_f32_16x16x32_bf16 v[32:35], a[240:243], a[184:187], v[32:35]
    ds_read_b64_tr_b16 a[236:237], v170 offset:584
    ds_read_b64_tr_b16 a[238:239], v170 offset:840
    v_mfma_f32_16x16x32_bf16 v[64:67], a[240:243], a[188:191], v[64:67]
    s_add_u32 m0, s42, 110592
    s_add_u32 s46, s29, 18432
    v_mfma_f32_16x16x32_bf16 v[96:99], a[240:243], a[192:195], v[96:99]
    buffer_load_dwordx4 v2, s[4:7], s46 offen sc1 lds
    v_mfma_f32_16x16x32_bf16 v[128:131], a[240:243], a[196:199], v[128:131]
    v_mfma_f32_16x16x32_bf16 v[36:39], a[244:247], a[184:187], v[36:39]
    ds_read_b64_tr_b16 a[240:241], v171 offset:512
    ds_read_b64_tr_b16 a[242:243], v171 offset:768
    v_mfma_f32_16x16x32_bf16 v[68:71], a[244:247], a[188:191], v[68:71]
    v_mfma_f32_16x16x32_bf16 v[100:103], a[244:247], a[192:195], v[100:103]
    s_add_u32 m0, s42, 111616
    s_add_u32 s46, s29, 27648
    v_mfma_f32_16x16x32_bf16 v[132:135], a[244:247], a[196:199], v[132:135]
    buffer_load_dwordx4 v3, s[4:7], s46 offen sc1 lds
    v_mfma_f32_16x16x32_bf16 v[40:43], a[248:251], a[184:187], v[40:43]
    ds_read_b64_tr_b16 a[244:245], v171 offset:520
    ds_read_b64_tr_b16 a[246:247], v171 offset:776
    v_mfma_f32_16x16x32_bf16 v[72:75], a[248:251], a[188:191], v[72:75]
    v_mfma_f32_16x16x32_bf16 v[104:107], a[248:251], a[192:195], v[104:107]
    v_mfma_f32_16x16x32_bf16 v[136:139], a[248:251], a[196:199], v[136:139]
    s_waitcnt lgkmcnt(12)
    s_add_u32 m0, s42, 112640
    s_add_u32 s46, s29, 36864
    v_mfma_f32_16x16x32_bf16 v[44:47], a[252:255], a[184:187], v[44:47]
    ds_read_b64_tr_b16 a[248:249], v171 offset:576
    ds_read_b64_tr_b16 a[250:251], v171 offset:832
    v_mfma_f32_16x16x32_bf16 v[76:79], a[252:255], a[188:191], v[76:79]
    buffer_load_dwordx4 v2, s[4:7], s46 offen sc1 lds
    v_mfma_f32_16x16x32_bf16 v[108:111], a[252:255], a[192:195], v[108:111]
    v_mfma_f32_16x16x32_bf16 v[140:143], a[252:255], a[196:199], v[140:143]
    s_waitcnt lgkmcnt(12)
    v_mfma_f32_16x16x32_bf16 v[16:19], a[224:227], a[204:207], v[16:19]
    s_add_u32 m0, s42, 113664
    ds_read_b64_tr_b16 a[252:253], v171 offset:584
    ds_read_b64_tr_b16 a[254:255], v171 offset:840
    v_mfma_f32_16x16x32_bf16 v[48:51], a[224:227], a[208:211], v[48:51]
    s_add_u32 s46, s29, 46080
    v_mfma_f32_16x16x32_bf16 v[80:83], a[224:227], a[212:215], v[80:83]
    buffer_load_dwordx4 v3, s[4:7], s46 offen sc1 lds
    v_mfma_f32_16x16x32_bf16 v[112:115], a[224:227], a[216:219], v[112:115]
    v_mfma_f32_16x16x32_bf16 v[144:147], a[224:227], a[220:223], v[144:147]
    s_waitcnt lgkmcnt(12)
    v_mfma_f32_16x16x32_bf16 v[20:23], a[228:231], a[204:207], v[20:23]
    s_add_u32 m0, s42, 114688
    s_add_u32 s46, s29, 55296
    v_mfma_f32_16x16x32_bf16 v[52:55], a[228:231], a[208:211], v[52:55]
    buffer_load_dwordx4 v2, s[4:7], s46 offen sc1 lds
    v_mfma_f32_16x16x32_bf16 v[84:87], a[228:231], a[212:215], v[84:87]
    s_add_u32 m0, s42, 115712
    s_add_u32 s46, s29, 64512
    v_mfma_f32_16x16x32_bf16 v[116:119], a[228:231], a[216:219], v[116:119]
    buffer_load_dwordx4 v3, s[4:7], s46 offen sc1 lds
    v_mfma_f32_16x16x32_bf16 v[148:151], a[228:231], a[220:223], v[148:151]
    s_waitcnt lgkmcnt(10)
    v_mfma_f32_16x16x32_bf16 v[24:27], a[232:235], a[204:207], v[24:27]
    v_mfma_f32_16x16x32_bf16 v[56:59], a[232:235], a[208:211], v[56:59]
    v_mfma_f32_16x16x32_bf16 v[88:91], a[232:235], a[212:215], v[88:91]
    v_mfma_f32_16x16x32_bf16 v[120:123], a[232:235], a[216:219], v[120:123]
    v_mfma_f32_16x16x32_bf16 v[152:155], a[232:235], a[220:223], v[152:155]
    s_waitcnt vmcnt(12) lgkmcnt(0)
    s_barrier
    s_lshl_b32 s26, s100, 12
    ds_read_b128 a[184:187], v160 offset:54272
    v_mfma_f32_16x16x32_bf16 v[28:31], a[236:239], a[204:207], v[28:31]
    s_add_u32 s26, s26, s45
    ds_read_b128 a[188:191], v160 offset:56320
    v_mfma_f32_16x16x32_bf16 v[60:63], a[236:239], a[208:211], v[60:63]
    s_add_u32 s101, s55, s100
    ds_read_b128 a[192:195], v160 offset:58368
    v_mfma_f32_16x16x32_bf16 v[92:95], a[236:239], a[212:215], v[92:95]
    s_add_u32 s100, s100, 128
    ds_read_b128 a[196:199], v160 offset:60416
    v_mfma_f32_16x16x32_bf16 v[124:127], a[236:239], a[216:219], v[124:127]
    s_sub_u32 s57, s100, 1152
    ds_read_b128 a[200:203], v162 offset:54272
    v_mfma_f32_16x16x32_bf16 v[156:159], a[236:239], a[220:223], v[156:159]
    s_min_u32 s100, s100, s57
    ds_read_b64_tr_b16 a[224:225], v164 offset:54272
    ds_read_b64_tr_b16 a[226:227], v164 offset:54528
    v_mfma_f32_16x16x32_bf16 v[32:35], a[240:243], a[204:207], v[32:35]
    s_add_u32 m0, s44, 108544
    ds_read_b64_tr_b16 a[228:229], v164 offset:54280
    ds_read_b64_tr_b16 a[230:231], v164 offset:54536
    v_mfma_f32_16x16x32_bf16 v[64:67], a[240:243], a[208:211], v[64:67]
    ds_read_b64_tr_b16 a[232:233], v164 offset:54336
    ds_read_b64_tr_b16 a[234:235], v164 offset:54592
    v_mfma_f32_16x16x32_bf16 v[96:99], a[240:243], a[212:215], v[96:99]
    ds_read_b64_tr_b16 a[236:237], v164 offset:54344
    ds_read_b64_tr_b16 a[238:239], v164 offset:54600
    v_mfma_f32_16x16x32_bf16 v[128:131], a[240:243], a[216:219], v[128:131]
    buffer_load_dwordx4 v5, s[8:11], s26 offen sc1 lds
    v_mfma_f32_16x16x32_bf16 v[36:39], a[244:247], a[204:207], v[36:39]
    s_add_u32 m0, s44, 109632
    ds_read_b64_tr_b16 a[240:241], v165 offset:54272
    ds_read_b64_tr_b16 a[242:243], v165 offset:54528
    v_mfma_f32_16x16x32_bf16 v[68:71], a[244:247], a[208:211], v[68:71]
    s_add_u32 s46, s26, 8192
    v_mfma_f32_16x16x32_bf16 v[100:103], a[244:247], a[212:215], v[100:103]
    buffer_load_dwordx4 v5, s[8:11], s46 offen sc1 lds
    v_mfma_f32_16x16x32_bf16 v[132:135], a[244:247], a[216:219], v[132:135]
    v_mfma_f32_16x16x32_bf16 v[40:43], a[248:251], a[204:207], v[40:43]
    ds_read_b64_tr_b16 a[244:245], v165 offset:54280
    ds_read_b64_tr_b16 a[246:247], v165 offset:54536
    v_mfma_f32_16x16x32_bf16 v[72:75], a[248:251], a[208:211], v[72:75]
    s_add_u32 m0, s44, 110720
    s_add_u32 s46, s26, 16384
    v_mfma_f32_16x16x32_bf16 v[104:107], a[248:251], a[212:215], v[104:107]
    buffer_load_dwordx4 v5, s[8:11], s46 offen sc1 lds
    v_mfma_f32_16x16x32_bf16 v[136:139], a[248:251], a[216:219], v[136:139]
    v_mfma_f32_16x16x32_bf16 v[44:47], a[252:255], a[204:207], v[44:47]
    ds_read_b128 a[204:207], v161 offset:54272
    v_mfma_f32_16x16x32_bf16 v[76:79], a[252:255], a[208:211], v[76:79]
    ds_read_b64_tr_b16 a[248:249], v165 offset:54336
    ds_read_b64_tr_b16 a[250:251], v165 offset:54592
    v_mfma_f32_16x16x32_bf16 v[108:111], a[252:255], a[212:215], v[108:111]
    s_add_u32 m0, s44, 111808
    ds_read_b128 a[208:211], v161 offset:56320
    v_mfma_f32_16x16x32_bf16 v[140:143], a[252:255], a[216:219], v[140:143]
    s_waitcnt lgkmcnt(14)
    s_add_u32 s46, s26, 24576
    ds_read_b128 a[212:215], v161 offset:58368
    v_mfma_f32_16x16x32_bf16 v[16:19], a[224:227], a[184:187], v[16:19]
    ds_read_b128 a[216:219], v161 offset:60416
    v_mfma_f32_16x16x32_bf16 v[48:51], a[224:227], a[188:191], v[48:51]
    ds_read_b128 a[220:223], v163 offset:54272
    v_mfma_f32_16x16x32_bf16 v[80:83], a[224:227], a[192:195], v[80:83]
    ds_read_b64_tr_b16 a[252:253], v165 offset:54344
    ds_read_b64_tr_b16 a[254:255], v165 offset:54600
    v_mfma_f32_16x16x32_bf16 v[112:115], a[224:227], a[196:199], v[112:115]
    buffer_load_dwordx4 v5, s[8:11], s46 offen sc1 lds
    v_mfma_f32_16x16x32_bf16 v[144:147], a[224:227], a[200:203], v[144:147]
    s_waitcnt lgkmcnt(15)
    s_add_u32 m0, s48, 108544
    v_mfma_f32_16x16x32_bf16 v[20:23], a[228:231], a[184:187], v[20:23]
    ds_read_b64_tr_b16 a[224:225], v164 offset:54784
    ds_read_b64_tr_b16 a[226:227], v164 offset:55040
    v_mfma_f32_16x16x32_bf16 v[52:55], a[228:231], a[188:191], v[52:55]
    buffer_load_dwordx4 v4, s[4:7], s101 offen sc1 lds
    v_mfma_f32_16x16x32_bf16 v[84:87], a[228:231], a[192:195], v[84:87]
    v_mfma_f32_16x16x32_bf16 v[116:119], a[228:231], a[196:199], v[116:119]
    v_mfma_f32_16x16x32_bf16 v[148:151], a[228:231], a[200:203], v[148:151]
    s_add_u32 m0, s88, 16896
    s_mov_b32 s46, 0
    v_mfma_f32_16x16x32_bf16 v[24:27], a[232:235], a[184:187], v[24:27]
    ds_read_b64_tr_b16 a[228:229], v164 offset:54792
    ds_read_b64_tr_b16 a[230:231], v164 offset:55048
    v_mfma_f32_16x16x32_bf16 v[56:59], a[232:235], a[188:191], v[56:59]
    buffer_load_dwordx4 v246, s[16:19], s46 offen nt lds
    v_mfma_f32_16x16x32_bf16 v[88:91], a[232:235], a[192:195], v[88:91]
    s_add_u32 m0, s88, 17952
    s_mov_b32 s46, 0
    v_mfma_f32_16x16x32_bf16 v[120:123], a[232:235], a[196:199], v[120:123]
    buffer_load_dwordx4 v247, s[16:19], s46 offen nt lds
    v_mfma_f32_16x16x32_bf16 v[152:155], a[232:235], a[200:203], v[152:155]
    s_waitcnt lgkmcnt(15)
    s_add_u32 m0, s88, 19008
    s_mov_b32 s46, 0
    v_mfma_f32_16x16x32_bf16 v[28:31], a[236:239], a[184:187], v[28:31]
    ds_read_b64_tr_b16 a[232:233], v164 offset:54848
    ds_read_b64_tr_b16 a[234:235], v164 offset:55104
    v_mfma_f32_16x16x32_bf16 v[60:63], a[236:239], a[188:191], v[60:63]
    buffer_load_dwordx4 v248, s[16:19], s46 offen nt lds
    v_mfma_f32_16x16x32_bf16 v[92:95], a[236:239], a[192:195], v[92:95]
    s_add_u32 m0, s88, 20064
    s_mov_b32 s46, 0
    v_mfma_f32_16x16x32_bf16 v[124:127], a[236:239], a[196:199], v[124:127]
    buffer_load_dwordx4 v249, s[16:19], s46 offen nt lds
    v_mfma_f32_16x16x32_bf16 v[156:159], a[236:239], a[200:203], v[156:159]
    s_add_u32 s29, s43, s89
    s_waitcnt lgkmcnt(8)
    s_nop 0
    v_mfma_f32_16x16x32_bf16 v[32:35], a[240:243], a[184:187], v[32:35]
    s_add_u32 s89, s89, 128
    ds_read_b64_tr_b16 a[236:237], v164 offset:54856
    ds_read_b64_tr_b16 a[238:239], v164 offset:55112
    v_mfma_f32_16x16x32_bf16 v[64:67], a[240:243], a[188:191], v[64:67]
    s_sub_u32 s57, s89, 1152
    s_min_u32 s89, s89, s57
    v_mfma_f32_16x16x32_bf16 v[96:99], a[240:243], a[192:195], v[96:99]
    s_add_u32 m0, s42, 54272
    v_mfma_f32_16x16x32_bf16 v[128:131], a[240:243], a[196:199], v[128:131]
    buffer_load_dwordx4 v2, s[4:7], s29 offen sc1 lds
    v_mfma_f32_16x16x32_bf16 v[36:39], a[244:247], a[184:187], v[36:39]
    s_add_u32 m0, s42, 55296
    ds_read_b64_tr_b16 a[240:241], v165 offset:54784
    ds_read_b64_tr_b16 a[242:243], v165 offset:55040
    v_mfma_f32_16x16x32_bf16 v[68:71], a[244:247], a[188:191], v[68:71]
    s_add_u32 s46, s29, 9216
    v_mfma_f32_16x16x32_bf16 v[100:103], a[244:247], a[192:195], v[100:103]
    buffer_load_dwordx4 v3, s[4:7], s46 offen sc1 lds
    v_mfma_f32_16x16x32_bf16 v[132:135], a[244:247], a[196:199], v[132:135]
    v_mfma_f32_16x16x32_bf16 v[40:43], a[248:251], a[184:187], v[40:43]
    ds_read_b64_tr_b16 a[244:245], v165 offset:54792
    ds_read_b64_tr_b16 a[246:247], v165 offset:55048
    v_mfma_f32_16x16x32_bf16 v[72:75], a[248:251], a[188:191], v[72:75]
    s_add_u32 m0, s42, 56320
    s_add_u32 s46, s29, 18432
    v_mfma_f32_16x16x32_bf16 v[104:107], a[248:251], a[192:195], v[104:107]
    buffer_load_dwordx4 v2, s[4:7], s46 offen sc1 lds
    v_mfma_f32_16x16x32_bf16 v[136:139], a[248:251], a[196:199], v[136:139]
    s_waitcnt lgkmcnt(12)
    v_mfma_f32_16x16x32_bf16 v[44:47], a[252:255], a[184:187], v[44:47]
    ds_read_b64_tr_b16 a[248:249], v165 offset:54848
    ds_read_b64_tr_b16 a[250:251], v165 offset:55104
    v_mfma_f32_16x16x32_bf16 v[76:79], a[252:255], a[188:191], v[76:79]
    v_mfma_f32_16x16x32_bf16 v[108:111], a[252:255], a[192:195], v[108:111]
    s_add_u32 m0, s42, 57344
    s_add_u32 s46, s29, 27648
    v_mfma_f32_16x16x32_bf16 v[140:143], a[252:255], a[196:199], v[140:143]
    s_waitcnt lgkmcnt(12)
    buffer_load_dwordx4 v3, s[4:7], s46 offen sc1 lds
    v_mfma_f32_16x16x32_bf16 v[16:19], a[224:227], a[204:207], v[16:19]
    ds_read_b64_tr_b16 a[252:253], v165 offset:54856
    ds_read_b64_tr_b16 a[254:255], v165 offset:55112
    v_mfma_f32_16x16x32_bf16 v[48:51], a[224:227], a[208:211], v[48:51]
    v_mfma_f32_16x16x32_bf16 v[80:83], a[224:227], a[212:215], v[80:83]
    v_mfma_f32_16x16x32_bf16 v[112:115], a[224:227], a[216:219], v[112:115]
    s_add_u32 m0, s42, 58368
    s_add_u32 s46, s29, 36864
    v_mfma_f32_16x16x32_bf16 v[144:147], a[224:227], a[220:223], v[144:147]
    s_waitcnt lgkmcnt(12)
    buffer_load_dwordx4 v2, s[4:7], s46 offen sc1 lds
    v_mfma_f32_16x16x32_bf16 v[20:23], a[228:231], a[204:207], v[20:23]
    v_mfma_f32_16x16x32_bf16 v[52:55], a[228:231], a[208:211], v[52:55]
    v_mfma_f32_16x16x32_bf16 v[84:87], a[228:231], a[212:215], v[84:87]
    v_mfma_f32_16x16x32_bf16 v[116:119], a[228:231], a[216:219], v[116:119]
    s_add_u32 m0, s42, 59392
    s_add_u32 s46, s29, 46080
    v_mfma_f32_16x16x32_bf16 v[148:151], a[228:231], a[220:223], v[148:151]
    s_waitcnt lgkmcnt(10)
    buffer_load_dwordx4 v3, s[4:7], s46 offen sc1 lds
    v_mfma_f32_16x16x32_bf16 v[24:27], a[232:235], a[204:207], v[24:27]
    s_add_u32 m0, s42, 60416
    s_add_u32 s46, s29, 55296
    v_mfma_f32_16x16x32_bf16 v[56:59], a[232:235], a[208:211], v[56:59]
    buffer_load_dwordx4 v2, s[4:7], s46 offen sc1 lds
    v_mfma_f32_16x16x32_bf16 v[88:91], a[232:235], a[212:215], v[88:91]
    s_add_u32 m0, s42, 61440
    s_add_u32 s46, s29, 64512
    v_mfma_f32_16x16x32_bf16 v[120:123], a[232:235], a[216:219], v[120:123]
    buffer_load_dwordx4 v3, s[4:7], s46 offen sc1 lds
    v_mfma_f32_16x16x32_bf16 v[152:155], a[232:235], a[220:223], v[152:155]
    s_waitcnt vmcnt(12) lgkmcnt(0)
    s_barrier
    s_lshl_b32 s26, s100, 12
    ds_read_b128 a[184:187], v166 offset:0
    v_mfma_f32_16x16x32_bf16 v[28:31], a[236:239], a[204:207], v[28:31]
    s_add_u32 s26, s26, s45
    ds_read_b128 a[188:191], v166 offset:2048
    v_mfma_f32_16x16x32_bf16 v[60:63], a[236:239], a[208:211], v[60:63]
    s_add_u32 s101, s55, s100
    ds_read_b128 a[192:195], v166 offset:4096
    v_mfma_f32_16x16x32_bf16 v[92:95], a[236:239], a[212:215], v[92:95]
    s_add_u32 s100, s100, 128
    ds_read_b128 a[196:199], v166 offset:6144
    v_mfma_f32_16x16x32_bf16 v[124:127], a[236:239], a[216:219], v[124:127]
    s_sub_u32 s57, s100, 1152
    ds_read_b128 a[200:203], v168 offset:0
    v_mfma_f32_16x16x32_bf16 v[156:159], a[236:239], a[220:223], v[156:159]
    s_min_u32 s100, s100, s57
    ds_read_b64_tr_b16 a[224:225], v170 offset:0
    ds_read_b64_tr_b16 a[226:227], v170 offset:256
    v_mfma_f32_16x16x32_bf16 v[32:35], a[240:243], a[204:207], v[32:35]
    s_add_u32 m0, s44, 54272
    ds_read_b64_tr_b16 a[228:229], v170 offset:8
    ds_read_b64_tr_b16 a[230:231], v170 offset:264
    v_mfma_f32_16x16x32_bf16 v[64:67], a[240:243], a[208:211], v[64:67]
    ds_read_b64_tr_b16 a[232:233], v170 offset:64
    ds_read_b64_tr_b16 a[234:235], v170 offset:320
    v_mfma_f32_16x16x32_bf16 v[96:99], a[240:243], a[212:215], v[96:99]
    ds_read_b64_tr_b16 a[236:237], v170 offset:72
    ds_read_b64_tr_b16 a[238:239], v170 offset:328
    v_mfma_f32_16x16x32_bf16 v[128:131], a[240:243], a[216:219], v[128:131]
    buffer_load_dwordx4 v5, s[8:11], s26 offen sc1 lds
    v_mfma_f32_16x16x32_bf16 v[36:39], a[244:247], a[204:207], v[36:39]
    s_add_u32 m0, s44, 55360
    ds_read_b64_tr_b16 a[240:241], v171 offset:0
    ds_read_b64_tr_b16 a[242:243], v171 offset:256
    v_mfma_f32_16x16x32_bf16 v[68:71], a[244:247], a[208:211], v[68:71]
    s_add_u32 s46, s26, 8192
    s_load_dwordx4 s[32:35], s[0:1], 40
    v_mfma_f32_16x16x32_bf16 v[100:103], a[244:247], a[212:215], v[100:103]
    buffer_load_dwordx4 v5, s[8:11], s46 offen sc1 lds
    v_mfma_f32_16x16x32_bf16 v[132:135], a[244:247], a[216:219], v[132:135]
    v_mfma_f32_16x16x32_bf16 v[40:43], a[248:251], a[204:207], v[40:43]
    ds_read_b64_tr_b16 a[244:245], v171 offset:8
    ds_read_b64_tr_b16 a[246:247], v171 offset:264
    v_mfma_f32_16x16x32_bf16 v[72:75], a[248:251], a[208:211], v[72:75]
    s_add_u32 m0, s44, 56448
    s_add_u32 s46, s26, 16384
    v_mfma_f32_16x16x32_bf16 v[104:107], a[248:251], a[212:215], v[104:107]
    buffer_load_dwordx4 v5, s[8:11], s46 offen sc1 lds
    v_mfma_f32_16x16x32_bf16 v[136:139], a[248:251], a[216:219], v[136:139]
    v_mfma_f32_16x16x32_bf16 v[44:47], a[252:255], a[204:207], v[44:47]
    ds_read_b128 a[204:207], v167 offset:0
    v_mfma_f32_16x16x32_bf16 v[76:79], a[252:255], a[208:211], v[76:79]
    ds_read_b64_tr_b16 a[248:249], v171 offset:64
    ds_read_b64_tr_b16 a[250:251], v171 offset:320
    v_mfma_f32_16x16x32_bf16 v[108:111], a[252:255], a[212:215], v[108:111]
    s_add_u32 m0, s44, 57536
    ds_read_b128 a[208:211], v167 offset:2048
    v_mfma_f32_16x16x32_bf16 v[140:143], a[252:255], a[216:219], v[140:143]
    s_waitcnt lgkmcnt(14)
    s_add_u32 s46, s26, 24576
    ds_read_b128 a[212:215], v167 offset:4096
    v_mfma_f32_16x16x32_bf16 v[16:19], a[224:227], a[184:187], v[16:19]
    ds_read_b128 a[216:219], v167 offset:6144
    v_mfma_f32_16x16x32_bf16 v[48:51], a[224:227], a[188:191], v[48:51]
    ds_read_b128 a[220:223], v169 offset:0
    v_mfma_f32_16x16x32_bf16 v[80:83], a[224:227], a[192:195], v[80:83]
    ds_read_b64_tr_b16 a[252:253], v171 offset:72
    ds_read_b64_tr_b16 a[254:255], v171 offset:328
    v_mfma_f32_16x16x32_bf16 v[112:115], a[224:227], a[196:199], v[112:115]
    buffer_load_dwordx4 v5, s[8:11], s46 offen sc1 lds
    v_mfma_f32_16x16x32_bf16 v[144:147], a[224:227], a[200:203], v[144:147]
    s_waitcnt lgkmcnt(15)
    s_add_u32 m0, s48, 54272
    v_mfma_f32_16x16x32_bf16 v[20:23], a[228:231], a[184:187], v[20:23]
    ds_read_b64_tr_b16 a[224:225], v170 offset:512
    ds_read_b64_tr_b16 a[226:227], v170 offset:768
    v_mfma_f32_16x16x32_bf16 v[52:55], a[228:231], a[188:191], v[52:55]
    buffer_load_dwordx4 v4, s[4:7], s101 offen sc1 lds
    v_mfma_f32_16x16x32_bf16 v[84:87], a[228:231], a[192:195], v[84:87]
    v_mfma_f32_16x16x32_bf16 v[116:119], a[228:231], a[196:199], v[116:119]
    v_mfma_f32_16x16x32_bf16 v[148:151], a[228:231], a[200:203], v[148:151]
    s_add_u32 m0, s88, 33792
    s_mov_b32 s46, 16384
    v_mfma_f32_16x16x32_bf16 v[24:27], a[232:235], a[184:187], v[24:27]
    ds_read_b64_tr_b16 a[228:229], v170 offset:520
    ds_read_b64_tr_b16 a[230:231], v170 offset:776
    v_mfma_f32_16x16x32_bf16 v[56:59], a[232:235], a[188:191], v[56:59]
    buffer_load_dwordx4 v246, s[12:15], s46 offen nt lds
    v_mfma_f32_16x16x32_bf16 v[88:91], a[232:235], a[192:195], v[88:91]
    s_add_u32 m0, s88, 34848
    s_mov_b32 s46, 16384
    v_mfma_f32_16x16x32_bf16 v[120:123], a[232:235], a[196:199], v[120:123]
    buffer_load_dwordx4 v247, s[12:15], s46 offen nt lds
    v_mfma_f32_16x16x32_bf16 v[152:155], a[232:235], a[200:203], v[152:155]
    s_waitcnt lgkmcnt(15)
    s_add_u32 m0, s88, 35904
    s_mov_b32 s46, 16384
    v_mfma_f32_16x16x32_bf16 v[28:31], a[236:239], a[184:187], v[28:31]
    ds_read_b64_tr_b16 a[232:233], v170 offset:576
    ds_read_b64_tr_b16 a[234:235], v170 offset:832
    v_mfma_f32_16x16x32_bf16 v[60:63], a[236:239], a[188:191], v[60:63]
    buffer_load_dwordx4 v248, s[12:15], s46 offen nt lds
    v_mfma_f32_16x16x32_bf16 v[92:95], a[236:239], a[192:195], v[92:95]
    s_add_u32 m0, s88, 36960
    s_mov_b32 s46, 16384
    v_mfma_f32_16x16x32_bf16 v[124:127], a[236:239], a[196:199], v[124:127]
    buffer_load_dwordx4 v249, s[12:15], s46 offen nt lds
    v_mfma_f32_16x16x32_bf16 v[156:159], a[236:239], a[200:203], v[156:159]
    s_add_u32 s29, s43, s89
    s_waitcnt lgkmcnt(8)
    s_nop 0
    v_mfma_f32_16x16x32_bf16 v[32:35], a[240:243], a[184:187], v[32:35]
    s_add_u32 s89, s89, 128
    ds_read_b64_tr_b16 a[236:237], v170 offset:584
    ds_read_b64_tr_b16 a[238:239], v170 offset:840
    v_mfma_f32_16x16x32_bf16 v[64:67], a[240:243], a[188:191], v[64:67]
    s_sub_u32 s57, s89, 1152
    s_min_u32 s89, s89, s57
    v_mfma_f32_16x16x32_bf16 v[96:99], a[240:243], a[192:195], v[96:99]
    s_add_u32 m0, s42, 108544
    v_mfma_f32_16x16x32_bf16 v[128:131], a[240:243], a[196:199], v[128:131]
    buffer_load_dwordx4 v2, s[4:7], s29 offen sc1 lds
    v_mfma_f32_16x16x32_bf16 v[36:39], a[244:247], a[184:187], v[36:39]
    s_add_u32 m0, s42, 109568
    ds_read_b64_tr_b16 a[240:241], v171 offset:512
    ds_read_b64_tr_b16 a[242:243], v171 offset:768
    v_mfma_f32_16x16x32_bf16 v[68:71], a[244:247], a[188:191], v[68:71]
    s_add_u32 s46, s29, 9216
    v_mfma_f32_16x16x32_bf16 v[100:103], a[244:247], a[192:195], v[100:103]
    buffer_load_dwordx4 v3, s[4:7], s46 offen sc1 lds
    v_mfma_f32_16x16x32_bf16 v[132:135], a[244:247], a[196:199], v[132:135]
    v_mfma_f32_16x16x32_bf16 v[40:43], a[248:251], a[184:187], v[40:43]
    ds_read_b64_tr_b16 a[244:245], v171 offset:520
    ds_read_b64_tr_b16 a[246:247], v171 offset:776
    v_mfma_f32_16x16x32_bf16 v[72:75], a[248:251], a[188:191], v[72:75]
    s_add_u32 m0, s42, 110592
    s_add_u32 s46, s29, 18432
    v_mfma_f32_16x16x32_bf16 v[104:107], a[248:251], a[192:195], v[104:107]
    buffer_load_dwordx4 v2, s[4:7], s46 offen sc1 lds
    v_mfma_f32_16x16x32_bf16 v[136:139], a[248:251], a[196:199], v[136:139]
    s_waitcnt lgkmcnt(12)
    v_mfma_f32_16x16x32_bf16 v[44:47], a[252:255], a[184:187], v[44:47]
    ds_read_b64_tr_b16 a[248:249], v171 offset:576
    ds_read_b64_tr_b16 a[250:251], v171 offset:832
    v_mfma_f32_16x16x32_bf16 v[76:79], a[252:255], a[188:191], v[76:79]
    v_mfma_f32_16x16x32_bf16 v[108:111], a[252:255], a[192:195], v[108:111]
    s_add_u32 m0, s42, 111616
    s_add_u32 s46, s29, 27648
    v_mfma_f32_16x16x32_bf16 v[140:143], a[252:255], a[196:199], v[140:143]
    s_waitcnt lgkmcnt(12)
    buffer_load_dwordx4 v3, s[4:7], s46 offen sc1 lds
    v_mfma_f32_16x16x32_bf16 v[16:19], a[224:227], a[204:207], v[16:19]
    ds_read_b64_tr_b16 a[252:253], v171 offset:584
    ds_read_b64_tr_b16 a[254:255], v171 offset:840
    v_mfma_f32_16x16x32_bf16 v[48:51], a[224:227], a[208:211], v[48:51]
    v_mfma_f32_16x16x32_bf16 v[80:83], a[224:227], a[212:215], v[80:83]
    v_mfma_f32_16x16x32_bf16 v[112:115], a[224:227], a[216:219], v[112:115]
    s_add_u32 m0, s42, 112640
    s_add_u32 s46, s29, 36864
    v_mfma_f32_16x16x32_bf16 v[144:147], a[224:227], a[220:223], v[144:147]
    s_waitcnt lgkmcnt(12)
    buffer_load_dwordx4 v2, s[4:7], s46 offen sc1 lds
    v_mfma_f32_16x16x32_bf16 v[20:23], a[228:231], a[204:207], v[20:23]
    v_mfma_f32_16x16x32_bf16 v[52:55], a[228:231], a[208:211], v[52:55]
    v_mfma_f32_16x16x32_bf16 v[84:87], a[228:231], a[212:215], v[84:87]
    v_mfma_f32_16x16x32_bf16 v[116:119], a[228:231], a[216:219], v[116:119]
    s_add_u32 m0, s42, 113664
    s_add_u32 s46, s29, 46080
    v_mfma_f32_16x16x32_bf16 v[148:151], a[228:231], a[220:223], v[148:151]
    s_waitcnt lgkmcnt(10)
    buffer_load_dwordx4 v3, s[4:7], s46 offen sc1 lds
    v_mfma_f32_16x16x32_bf16 v[24:27], a[232:235], a[204:207], v[24:27]
    s_add_u32 m0, s42, 114688
    s_add_u32 s46, s29, 55296
    v_mfma_f32_16x16x32_bf16 v[56:59], a[232:235], a[208:211], v[56:59]
    buffer_load_dwordx4 v2, s[4:7], s46 offen sc1 lds
    v_mfma_f32_16x16x32_bf16 v[88:91], a[232:235], a[212:215], v[88:91]
    s_add_u32 m0, s42, 115712
    s_add_u32 s46, s29, 64512
    v_mfma_f32_16x16x32_bf16 v[120:123], a[232:235], a[216:219], v[120:123]
    buffer_load_dwordx4 v3, s[4:7], s46 offen sc1 lds
    v_mfma_f32_16x16x32_bf16 v[152:155], a[232:235], a[220:223], v[152:155]
    s_waitcnt vmcnt(12) lgkmcnt(0)
    s_barrier
    s_lshl_b32 s26, s100, 12
    ds_read_b128 a[184:187], v160 offset:54272
    v_mfma_f32_16x16x32_bf16 v[28:31], a[236:239], a[204:207], v[28:31]
    s_add_u32 s26, s26, s45
    ds_read_b128 a[188:191], v160 offset:56320
    v_mfma_f32_16x16x32_bf16 v[60:63], a[236:239], a[208:211], v[60:63]
    s_add_u32 s101, s55, s100
    ds_read_b128 a[192:195], v160 offset:58368
    v_mfma_f32_16x16x32_bf16 v[92:95], a[236:239], a[212:215], v[92:95]
    s_add_u32 s100, s100, 128
    ds_read_b128 a[196:199], v160 offset:60416
    v_mfma_f32_16x16x32_bf16 v[124:127], a[236:239], a[216:219], v[124:127]
    s_sub_u32 s57, s100, 1152
    ds_read_b128 a[200:203], v162 offset:54272
    v_mfma_f32_16x16x32_bf16 v[156:159], a[236:239], a[220:223], v[156:159]
    s_min_u32 s100, s100, s57
    ds_read_b64_tr_b16 a[224:225], v164 offset:54272
    ds_read_b64_tr_b16 a[226:227], v164 offset:54528
    v_mfma_f32_16x16x32_bf16 v[32:35], a[240:243], a[204:207], v[32:35]
    s_add_u32 m0, s44, 108544
    ds_read_b64_tr_b16 a[228:229], v164 offset:54280
    ds_read_b64_tr_b16 a[230:231], v164 offset:54536
    v_mfma_f32_16x16x32_bf16 v[64:67], a[240:243], a[208:211], v[64:67]
    ds_read_b64_tr_b16 a[232:233], v164 offset:54336
    ds_read_b64_tr_b16 a[234:235], v164 offset:54592
    v_mfma_f32_16x16x32_bf16 v[96:99], a[240:243], a[212:215], v[96:99]
    ds_read_b64_tr_b16 a[236:237], v164 offset:54344
    ds_read_b64_tr_b16 a[238:239], v164 offset:54600
    v_mfma_f32_16x16x32_bf16 v[128:131], a[240:243], a[216:219], v[128:131]
    buffer_load_dwordx4 v5, s[8:11], s26 offen sc1 lds
    v_mfma_f32_16x16x32_bf16 v[36:39], a[244:247], a[204:207], v[36:39]
    s_add_u32 m0, s44, 109632
    ds_read_b64_tr_b16 a[240:241], v165 offset:54272
    ds_read_b64_tr_b16 a[242:243], v165 offset:54528
    v_mfma_f32_16x16x32_bf16 v[68:71], a[244:247], a[208:211], v[68:71]
    s_add_u32 s46, s26, 8192
    v_mfma_f32_16x16x32_bf16 v[100:103], a[244:247], a[212:215], v[100:103]
    buffer_load_dwordx4 v5, s[8:11], s46 offen sc1 lds
    v_mfma_f32_16x16x32_bf16 v[132:135], a[244:247], a[216:219], v[132:135]
    v_mfma_f32_16x16x32_bf16 v[40:43], a[248:251], a[204:207], v[40:43]
    ds_read_b64_tr_b16 a[244:245], v165 offset:54280
    ds_read_b64_tr_b16 a[246:247], v165 offset:54536
    v_mfma_f32_16x16x32_bf16 v[72:75], a[248:251], a[208:211], v[72:75]
    s_add_u32 m0, s44, 110720
    s_add_u32 s46, s26, 16384
    v_mfma_f32_16x16x32_bf16 v[104:107], a[248:251], a[212:215], v[104:107]
    buffer_load_dwordx4 v5, s[8:11], s46 offen sc1 lds
    v_mfma_f32_16x16x32_bf16 v[136:139], a[248:251], a[216:219], v[136:139]
    v_mfma_f32_16x16x32_bf16 v[44:47], a[252:255], a[204:207], v[44:47]
    ds_read_b128 a[204:207], v161 offset:54272
    v_mfma_f32_16x16x32_bf16 v[76:79], a[252:255], a[208:211], v[76:79]
    ds_read_b64_tr_b16 a[248:249], v165 offset:54336
    ds_read_b64_tr_b16 a[250:251], v165 offset:54592
    v_mfma_f32_16x16x32_bf16 v[108:111], a[252:255], a[212:215], v[108:111]
    s_add_u32 m0, s44, 111808
    ds_read_b128 a[208:211], v161 offset:56320
    v_mfma_f32_16x16x32_bf16 v[140:143], a[252:255], a[216:219], v[140:143]
    s_waitcnt lgkmcnt(14)
    s_add_u32 s46, s26, 24576
    ds_read_b128 a[212:215], v161 offset:58368
    v_mfma_f32_16x16x32_bf16 v[16:19], a[224:227], a[184:187], v[16:19]
    ds_read_b128 a[216:219], v161 offset:60416
    v_mfma_f32_16x16x32_bf16 v[48:51], a[224:227], a[188:191], v[48:51]
    ds_read_b128 a[220:223], v163 offset:54272
    v_mfma_f32_16x16x32_bf16 v[80:83], a[224:227], a[192:195], v[80:83]
    ds_read_b64_tr_b16 a[252:253], v165 offset:54344
    ds_read_b64_tr_b16 a[254:255], v165 offset:54600
    v_mfma_f32_16x16x32_bf16 v[112:115], a[224:227], a[196:199], v[112:115]
    buffer_load_dwordx4 v5, s[8:11], s46 offen sc1 lds
    v_mfma_f32_16x16x32_bf16 v[144:147], a[224:227], a[200:203], v[144:147]
    s_waitcnt lgkmcnt(15)
    s_add_u32 m0, s48, 108544
    v_mfma_f32_16x16x32_bf16 v[20:23], a[228:231], a[184:187], v[20:23]
    ds_read_b64_tr_b16 a[224:225], v164 offset:54784
    ds_read_b64_tr_b16 a[226:227], v164 offset:55040
    v_mfma_f32_16x16x32_bf16 v[52:55], a[228:231], a[188:191], v[52:55]
    buffer_load_dwordx4 v4, s[4:7], s101 offen sc1 lds
    v_mfma_f32_16x16x32_bf16 v[84:87], a[228:231], a[192:195], v[84:87]
    v_mfma_f32_16x16x32_bf16 v[116:119], a[228:231], a[196:199], v[116:119]
    v_mfma_f32_16x16x32_bf16 v[148:151], a[228:231], a[200:203], v[148:151]
    v_mfma_f32_16x16x32_bf16 v[24:27], a[232:235], a[184:187], v[24:27]
    ds_read_b64_tr_b16 a[228:229], v164 offset:54792
    ds_read_b64_tr_b16 a[230:231], v164 offset:55048
    v_mfma_f32_16x16x32_bf16 v[56:59], a[232:235], a[188:191], v[56:59]
    v_mfma_f32_16x16x32_bf16 v[88:91], a[232:235], a[192:195], v[88:91]
    v_mfma_f32_16x16x32_bf16 v[120:123], a[232:235], a[196:199], v[120:123]
    v_mfma_f32_16x16x32_bf16 v[152:155], a[232:235], a[200:203], v[152:155]
    s_waitcnt lgkmcnt(15)
    v_mfma_f32_16x16x32_bf16 v[28:31], a[236:239], a[184:187], v[28:31]
    ds_read_b64_tr_b16 a[232:233], v164 offset:54848
    ds_read_b64_tr_b16 a[234:235], v164 offset:55104
    v_mfma_f32_16x16x32_bf16 v[60:63], a[236:239], a[188:191], v[60:63]
    v_mfma_f32_16x16x32_bf16 v[92:95], a[236:239], a[192:195], v[92:95]
    v_mfma_f32_16x16x32_bf16 v[124:127], a[236:239], a[196:199], v[124:127]
    v_mfma_f32_16x16x32_bf16 v[156:159], a[236:239], a[200:203], v[156:159]
    v_mfma_f32_16x16x32_bf16 v[32:35], a[240:243], a[184:187], v[32:35]
    ds_read_b64_tr_b16 a[236:237], v164 offset:54856
    ds_read_b64_tr_b16 a[238:239], v164 offset:55112
    v_mfma_f32_16x16x32_bf16 v[64:67], a[240:243], a[188:191], v[64:67]
    v_mfma_f32_16x16x32_bf16 v[96:99], a[240:243], a[192:195], v[96:99]
    v_mfma_f32_16x16x32_bf16 v[128:131], a[240:243], a[196:199], v[128:131]
    s_waitcnt lgkmcnt(15)
    v_mfma_f32_16x16x32_bf16 v[36:39], a[244:247], a[184:187], v[36:39]
    ds_read_b64_tr_b16 a[240:241], v165 offset:54784
    ds_read_b64_tr_b16 a[242:243], v165 offset:55040
    v_mfma_f32_16x16x32_bf16 v[68:71], a[244:247], a[188:191], v[68:71]
    v_mfma_f32_16x16x32_bf16 v[100:103], a[244:247], a[192:195], v[100:103]
    v_mfma_f32_16x16x32_bf16 v[132:135], a[244:247], a[196:199], v[132:135]
    s_waitcnt lgkmcnt(15)
    v_mfma_f32_16x16x32_bf16 v[40:43], a[248:251], a[184:187], v[40:43]
    ds_read_b64_tr_b16 a[244:245], v165 offset:54792
    ds_read_b64_tr_b16 a[246:247], v165 offset:55048
    v_mfma_f32_16x16x32_bf16 v[72:75], a[248:251], a[188:191], v[72:75]
    v_mfma_f32_16x16x32_bf16 v[104:107], a[248:251], a[192:195], v[104:107]
    v_mfma_f32_16x16x32_bf16 v[136:139], a[248:251], a[196:199], v[136:139]
    s_waitcnt lgkmcnt(12)
    v_mfma_f32_16x16x32_bf16 v[44:47], a[252:255], a[184:187], v[44:47]
    ds_read_b64_tr_b16 a[248:249], v165 offset:54848
    ds_read_b64_tr_b16 a[250:251], v165 offset:55104
    v_mfma_f32_16x16x32_bf16 v[76:79], a[252:255], a[188:191], v[76:79]
    v_mfma_f32_16x16x32_bf16 v[108:111], a[252:255], a[192:195], v[108:111]
    v_mfma_f32_16x16x32_bf16 v[140:143], a[252:255], a[196:199], v[140:143]
    s_waitcnt lgkmcnt(12)
    v_mfma_f32_16x16x32_bf16 v[16:19], a[224:227], a[204:207], v[16:19]
    ds_read_b64_tr_b16 a[252:253], v165 offset:54856
    ds_read_b64_tr_b16 a[254:255], v165 offset:55112
    v_mfma_f32_16x16x32_bf16 v[48:51], a[224:227], a[208:211], v[48:51]
    v_mfma_f32_16x16x32_bf16 v[80:83], a[224:227], a[212:215], v[80:83]
    v_mfma_f32_16x16x32_bf16 v[112:115], a[224:227], a[216:219], v[112:115]
    v_mfma_f32_16x16x32_bf16 v[144:147], a[224:227], a[220:223], v[144:147]
    s_waitcnt lgkmcnt(12)
    v_mfma_f32_16x16x32_bf16 v[20:23], a[228:231], a[204:207], v[20:23]
    v_mfma_f32_16x16x32_bf16 v[52:55], a[228:231], a[208:211], v[52:55]
    v_mfma_f32_16x16x32_bf16 v[84:87], a[228:231], a[212:215], v[84:87]
    v_mfma_f32_16x16x32_bf16 v[116:119], a[228:231], a[216:219], v[116:119]
    v_mfma_f32_16x16x32_bf16 v[148:151], a[228:231], a[220:223], v[148:151]
    s_waitcnt lgkmcnt(10)
    v_mfma_f32_16x16x32_bf16 v[24:27], a[232:235], a[204:207], v[24:27]
    v_mfma_f32_16x16x32_bf16 v[56:59], a[232:235], a[208:211], v[56:59]
    v_mfma_f32_16x16x32_bf16 v[88:91], a[232:235], a[212:215], v[88:91]
    v_mfma_f32_16x16x32_bf16 v[120:123], a[232:235], a[216:219], v[120:123]
    v_mfma_f32_16x16x32_bf16 v[152:155], a[232:235], a[220:223], v[152:155]
    s_waitcnt vmcnt(0) lgkmcnt(0)
    s_barrier
    s_add_u32 m0, s88, 50688
    ds_read_b128 a[184:187], v166 offset:0
    v_mfma_f32_16x16x32_bf16 v[28:31], a[236:239], a[204:207], v[28:31]
    s_mov_b32 s46, 16384
    ds_read_b128 a[188:191], v166 offset:2048
    v_mfma_f32_16x16x32_bf16 v[60:63], a[236:239], a[208:211], v[60:63]
    ds_read_b128 a[192:195], v166 offset:4096
    v_mfma_f32_16x16x32_bf16 v[92:95], a[236:239], a[212:215], v[92:95]
    ds_read_b128 a[196:199], v166 offset:6144
    v_mfma_f32_16x16x32_bf16 v[124:127], a[236:239], a[216:219], v[124:127]
    ds_read_b128 a[200:203], v168 offset:0
    v_mfma_f32_16x16x32_bf16 v[156:159], a[236:239], a[220:223], v[156:159]
    ds_read_b64_tr_b16 a[224:225], v170 offset:0
    ds_read_b64_tr_b16 a[226:227], v170 offset:256
    v_mfma_f32_16x16x32_bf16 v[32:35], a[240:243], a[204:207], v[32:35]
    ds_read_b64_tr_b16 a[228:229], v170 offset:8
    ds_read_b64_tr_b16 a[230:231], v170 offset:264
    v_mfma_f32_16x16x32_bf16 v[64:67], a[240:243], a[208:211], v[64:67]
    ds_read_b64_tr_b16 a[232:233], v170 offset:64
    ds_read_b64_tr_b16 a[234:235], v170 offset:320
    v_mfma_f32_16x16x32_bf16 v[96:99], a[240:243], a[212:215], v[96:99]
    ds_read_b64_tr_b16 a[236:237], v170 offset:72
    ds_read_b64_tr_b16 a[238:239], v170 offset:328
    v_mfma_f32_16x16x32_bf16 v[128:131], a[240:243], a[216:219], v[128:131]
    buffer_load_dwordx4 v246, s[16:19], s46 offen nt lds
    v_mfma_f32_16x16x32_bf16 v[36:39], a[244:247], a[204:207], v[36:39]
    s_add_u32 m0, s88, 51744
    ds_read_b64_tr_b16 a[240:241], v171 offset:0
    ds_read_b64_tr_b16 a[242:243], v171 offset:256
    v_mfma_f32_16x16x32_bf16 v[68:71], a[244:247], a[208:211], v[68:71]
    s_mov_b32 s46, 16384
    s_lshr_b32 s55, s2, 3
    s_mul_i32 s40, s55, 1152
    v_mfma_f32_16x16x32_bf16 v[100:103], a[244:247], a[212:215], v[100:103]
    buffer_load_dwordx4 v247, s[16:19], s46 offen nt lds
    v_mfma_f32_16x16x32_bf16 v[132:135], a[244:247], a[216:219], v[132:135]
    s_mul_i32 s43, s55, 43
    s_lshr_b32 s43, s43, 7
    v_mfma_f32_16x16x32_bf16 v[40:43], a[248:251], a[204:207], v[40:43]
    ds_read_b64_tr_b16 a[244:245], v171 offset:8
    ds_read_b64_tr_b16 a[246:247], v171 offset:264
    v_mfma_f32_16x16x32_bf16 v[72:75], a[248:251], a[208:211], v[72:75]
    s_add_u32 m0, s88, 52800
    s_mov_b32 s46, 16384
    s_mul_i32 s42, s43, 3
    s_sub_u32 s42, s55, s42
    v_mfma_f32_16x16x32_bf16 v[104:107], a[248:251], a[212:215], v[104:107]
    buffer_load_dwordx4 v248, s[16:19], s46 offen nt lds
    v_mfma_f32_16x16x32_bf16 v[136:139], a[248:251], a[216:219], v[136:139]
    s_and_b32 s100, s2, 1
    s_xor_b32 s100, s100, 1
    v_mfma_f32_16x16x32_bf16 v[44:47], a[252:255], a[204:207], v[44:47]
    ds_read_b128 a[204:207], v167 offset:0
    v_mfma_f32_16x16x32_bf16 v[76:79], a[252:255], a[208:211], v[76:79]
    ds_read_b64_tr_b16 a[248:249], v171 offset:64
    ds_read_b64_tr_b16 a[250:251], v171 offset:320
    v_mfma_f32_16x16x32_bf16 v[108:111], a[252:255], a[212:215], v[108:111]
    s_add_u32 m0, s88, 53856
    ds_read_b128 a[208:211], v167 offset:2048
    v_mfma_f32_16x16x32_bf16 v[140:143], a[252:255], a[216:219], v[140:143]
    s_waitcnt lgkmcnt(14)
    s_mov_b32 s46, 16384
    ds_read_b128 a[212:215], v167 offset:4096
    v_mfma_f32_16x16x32_bf16 v[16:19], a[224:227], a[184:187], v[16:19]
    ds_read_b128 a[216:219], v167 offset:6144
    v_mfma_f32_16x16x32_bf16 v[48:51], a[224:227], a[188:191], v[48:51]
    ds_read_b128 a[220:223], v169 offset:0
    v_mfma_f32_16x16x32_bf16 v[80:83], a[224:227], a[192:195], v[80:83]
    ds_read_b64_tr_b16 a[252:253], v171 offset:72
    ds_read_b64_tr_b16 a[254:255], v171 offset:328
    v_mfma_f32_16x16x32_bf16 v[112:115], a[224:227], a[196:199], v[112:115]
    buffer_load_dwordx4 v249, s[16:19], s46 offen nt lds
    v_mfma_f32_16x16x32_bf16 v[144:147], a[224:227], a[200:203], v[144:147]
    s_waitcnt lgkmcnt(15)
    s_lshl_b32 s100, s100, 2
    s_bfe_u32 s55, s2, 0x20001
    v_mfma_f32_16x16x32_bf16 v[20:23], a[228:231], a[184:187], v[20:23]
    ds_read_b64_tr_b16 a[224:225], v170 offset:512
    ds_read_b64_tr_b16 a[226:227], v170 offset:768
    v_mfma_f32_16x16x32_bf16 v[52:55], a[228:231], a[188:191], v[52:55]
    s_add_u32 s100, s100, s55
    s_mul_i32 s55, s100, 3
    v_mfma_f32_16x16x32_bf16 v[84:87], a[228:231], a[192:195], v[84:87]
    s_add_u32 s42, s42, s55
    s_lshl_b32 s100, s100, 2
    v_mfma_f32_16x16x32_bf16 v[116:119], a[228:231], a[196:199], v[116:119]
    s_add_u32 s100, s100, s24
    s_lshl_b32 s100, s100, 3
    v_mfma_f32_16x16x32_bf16 v[148:151], a[228:231], a[200:203], v[148:151]
    s_lshl_b32 s89, s27, 2
    s_lshr_b32 s55, s28, 3
    v_mfma_f32_16x16x32_bf16 v[24:27], a[232:235], a[184:187], v[24:27]
    ds_read_b64_tr_b16 a[228:229], v170 offset:520
    ds_read_b64_tr_b16 a[230:231], v170 offset:776
    v_mfma_f32_16x16x32_bf16 v[56:59], a[232:235], a[188:191], v[56:59]
    s_add_u32 s89, s89, s55
    s_lshl_b32 s89, s89, 3
    v_mfma_f32_16x16x32_bf16 v[88:91], a[232:235], a[192:195], v[88:91]
    v_lshrrev_b32 v3, 3, v0
    v_mul_u32_u24 v2, 1152, v3
    v_mfma_f32_16x16x32_bf16 v[120:123], a[232:235], a[196:199], v[120:123]
    v_lshlrev_b32 v3, 1, v12
    v_and_b32 v4, 7, v0
    v_mfma_f32_16x16x32_bf16 v[152:155], a[232:235], a[200:203], v[152:155]
    s_waitcnt lgkmcnt(15)
    v_xor_b32 v3, v3, v4
    v_lshl_add_u32 v2, v3, 4, v2
    v_mfma_f32_16x16x32_bf16 v[28:31], a[236:239], a[184:187], v[28:31]
    ds_read_b64_tr_b16 a[232:233], v170 offset:576
    ds_read_b64_tr_b16 a[234:235], v170 offset:832
    v_mfma_f32_16x16x32_bf16 v[60:63], a[236:239], a[188:191], v[60:63]
    v_min_u32 v3, 8, v0
    v_lshlrev_b32 v3, 7, v3
    v_mfma_f32_16x16x32_bf16 v[92:95], a[236:239], a[192:195], v[92:95]
    s_lshl_b32 s48, s24, 12
    v_mov_b32 v4, 0
    v_mfma_f32_16x16x32_bf16 v[124:127], a[236:239], a[196:199], v[124:127]
    s_mul_i32 s45, s24, 1179648
    s_add_u32 s40, s40, s45
    v_mfma_f32_16x16x32_bf16 v[156:159], a[236:239], a[200:203], v[156:159]
    s_lshl_b32 s55, s43, 7
    s_add_u32 s45, s45, s55
    v_mfma_f32_16x16x32_bf16 v[32:35], a[240:243], a[184:187], v[32:35]
    ds_read_b64_tr_b16 a[236:237], v170 offset:584
    ds_read_b64_tr_b16 a[238:239], v170 offset:840
    v_mfma_f32_16x16x32_bf16 v[64:67], a[240:243], a[188:191], v[64:67]
    s_cmp_ge_u32 s2, 216
    s_cselect_b32 s45, 0x40000000, s45
    v_mfma_f32_16x16x32_bf16 v[96:99], a[240:243], a[192:195], v[96:99]
    s_mov_b32 s4, s32
    s_mov_b32 s5, s33
    v_mfma_f32_16x16x32_bf16 v[128:131], a[240:243], a[196:199], v[128:131]
    s_waitcnt lgkmcnt(15)
    s_mov_b32 s6, 2654208
    s_mov_b32 s8, s34
    v_mfma_f32_16x16x32_bf16 v[36:39], a[244:247], a[184:187], v[36:39]
    ds_read_b64_tr_b16 a[240:241], v171 offset:512
    ds_read_b64_tr_b16 a[242:243], v171 offset:768
    v_mfma_f32_16x16x32_bf16 v[68:71], a[244:247], a[188:191], v[68:71]
    s_mov_b32 s9, s35
    s_mov_b32 s10, 256
    v_mfma_f32_16x16x32_bf16 v[100:103], a[244:247], a[192:195], v[100:103]
    v_mfma_f32_16x16x32_bf16 v[132:135], a[244:247], a[196:199], v[132:135]
    s_waitcnt lgkmcnt(15)
    v_mfma_f32_16x16x32_bf16 v[40:43], a[248:251], a[184:187], v[40:43]
    ds_read_b64_tr_b16 a[244:245], v171 offset:520
    ds_read_b64_tr_b16 a[246:247], v171 offset:776
    v_mfma_f32_16x16x32_bf16 v[72:75], a[248:251], a[188:191], v[72:75]
    v_mfma_f32_16x16x32_bf16 v[104:107], a[248:251], a[192:195], v[104:107]
    v_mfma_f32_16x16x32_bf16 v[136:139], a[248:251], a[196:199], v[136:139]
    s_waitcnt lgkmcnt(12)
    v_mfma_f32_16x16x32_bf16 v[44:47], a[252:255], a[184:187], v[44:47]
    ds_read_b64_tr_b16 a[248:249], v171 offset:576
    ds_read_b64_tr_b16 a[250:251], v171 offset:832
    v_mfma_f32_16x16x32_bf16 v[76:79], a[252:255], a[188:191], v[76:79]
    v_mfma_f32_16x16x32_bf16 v[108:111], a[252:255], a[192:195], v[108:111]
    v_mfma_f32_16x16x32_bf16 v[140:143], a[252:255], a[196:199], v[140:143]
    s_waitcnt lgkmcnt(12)
    v_mfma_f32_16x16x32_bf16 v[16:19], a[224:227], a[204:207], v[16:19]
    ds_read_b64_tr_b16 a[252:253], v171 offset:584
    ds_read_b64_tr_b16 a[254:255], v171 offset:840
    v_mfma_f32_16x16x32_bf16 v[48:51], a[224:227], a[208:211], v[48:51]
    v_mfma_f32_16x16x32_bf16 v[80:83], a[224:227], a[212:215], v[80:83]
    v_mfma_f32_16x16x32_bf16 v[112:115], a[224:227], a[216:219], v[112:115]
    v_mfma_f32_16x16x32_bf16 v[144:147], a[224:227], a[220:223], v[144:147]
    s_waitcnt lgkmcnt(12)
    v_mfma_f32_16x16x32_bf16 v[20:23], a[228:231], a[204:207], v[20:23]
    v_mfma_f32_16x16x32_bf16 v[52:55], a[228:231], a[208:211], v[52:55]
    v_mfma_f32_16x16x32_bf16 v[84:87], a[228:231], a[212:215], v[84:87]
    v_mfma_f32_16x16x32_bf16 v[116:119], a[228:231], a[216:219], v[116:119]
    v_mfma_f32_16x16x32_bf16 v[148:151], a[228:231], a[220:223], v[148:151]
    s_waitcnt lgkmcnt(10)
    v_mfma_f32_16x16x32_bf16 v[24:27], a[232:235], a[204:207], v[24:27]
    v_mfma_f32_16x16x32_bf16 v[56:59], a[232:235], a[208:211], v[56:59]
    v_mfma_f32_16x16x32_bf16 v[88:91], a[232:235], a[212:215], v[88:91]
    v_mfma_f32_16x16x32_bf16 v[120:123], a[232:235], a[216:219], v[120:123]
    v_mul_f32 v144, s56, v144
    v_mul_f32 v145, s56, v145
    v_mul_f32 v146, s56, v146
    v_mul_f32 v147, s56, v147
    v_mul_f32 v148, s56, v148
    v_mul_f32 v149, s56, v149
    v_mfma_f32_16x16x32_bf16 v[152:155], a[232:235], a[220:223], v[152:155]
    s_waitcnt lgkmcnt(8)
    v_mul_f32 v150, s56, v150
    v_mul_f32 v151, s56, v151
    v_cvt_pk_bf16_f32 v224, v144, v145
    v_cvt_pk_bf16_f32 v225, v146, v147
    v_cvt_pk_bf16_f32 v226, v148, v149
    v_mfma_f32_16x16x32_bf16 v[28:31], a[236:239], a[204:207], v[28:31]
    v_cvt_pk_bf16_f32 v227, v150, v151
    v_mul_f32 v16, s56, v16
    v_mul_f32 v17, s56, v17
    v_mul_f32 v18, s56, v18
    v_mul_f32 v19, s56, v19
    v_mfma_f32_16x16x32_bf16 v[60:63], a[236:239], a[208:211], v[60:63]
    v_mul_f32 v20, s56, v20
    v_mul_f32 v21, s56, v21
    v_mul_f32 v22, s56, v22
    v_mul_f32 v23, s56, v23
    v_cvt_pk_bf16_f32 v160, v16, v17
    v_cvt_pk_bf16_f32 v161, v18, v19
    v_mfma_f32_16x16x32_bf16 v[92:95], a[236:239], a[212:215], v[92:95]
    v_cvt_pk_bf16_f32 v162, v20, v21
    v_cvt_pk_bf16_f32 v163, v22, v23
    v_mul_f32 v48, s56, v48
    v_mul_f32 v49, s56, v49
    v_mul_f32 v50, s56, v50
    v_mfma_f32_16x16x32_bf16 v[124:127], a[236:239], a[216:219], v[124:127]
    v_mul_f32 v51, s56, v51
    v_mul_f32 v52, s56, v52
    v_mul_f32 v53, s56, v53
    v_mul_f32 v54, s56, v54
    v_mul_f32 v55, s56, v55
    v_mfma_f32_16x16x32_bf16 v[156:159], a[236:239], a[220:223], v[156:159]
    s_waitcnt lgkmcnt(6)
    v_cvt_pk_bf16_f32 v176, v48, v49
    v_cvt_pk_bf16_f32 v177, v50, v51
    v_cvt_pk_bf16_f32 v178, v52, v53
    v_cvt_pk_bf16_f32 v179, v54, v55
    v_mul_f32 v80, s56, v80
    v_mul_f32 v81, s56, v81
    v_mfma_f32_16x16x32_bf16 v[32:35], a[240:243], a[204:207], v[32:35]
    v_mul_f32 v82, s56, v82
    v_mul_f32 v83, s56, v83
    v_mul_f32 v84, s56, v84
    v_mul_f32 v85, s56, v85
    v_mul_f32 v86, s56, v86
    v_mfma_f32_16x16x32_bf16 v[64:67], a[240:243], a[208:211], v[64:67]
    v_mul_f32 v87, s56, v87
    v_cvt_pk_bf16_f32 v192, v80, v81
    v_cvt_pk_bf16_f32 v193, v82, v83
    v_cvt_pk_bf16_f32 v194, v84, v85
    v_cvt_pk_bf16_f32 v195, v86, v87
    v_mfma_f32_16x16x32_bf16 v[96:99], a[240:243], a[212:215], v[96:99]
    v_mul_f32 v152, s56, v152
    v_mul_f32 v153, s56, v153
    v_mul_f32 v154, s56, v154
    v_mul_f32 v155, s56, v155
    v_mul_f32 v156, s56, v156
    v_mul_f32 v157, s56, v157
    v_mfma_f32_16x16x32_bf16 v[128:131], a[240:243], a[216:219], v[128:131]
    s_waitcnt lgkmcnt(4)
    v_mul_f32 v158, s56, v158
    v_mul_f32 v159, s56, v159
    v_cvt_pk_bf16_f32 v228, v152, v153
    v_cvt_pk_bf16_f32 v229, v154, v155
    v_cvt_pk_bf16_f32 v230, v156, v157
    v_mfma_f32_16x16x32_bf16 v[36:39], a[244:247], a[204:207], v[36:39]
    ds_write_b128 v9, v[224:227]
    v_cvt_pk_bf16_f32 v231, v158, v159
    ds_write_b128 v9, v[228:231] offset:1024
    v_mul_f32 v112, s56, v112
    v_mul_f32 v113, s56, v113
    v_mul_f32 v114, s56, v114
    v_mfma_f32_16x16x32_bf16 v[68:71], a[244:247], a[208:211], v[68:71]
    v_mul_f32 v115, s56, v115
    v_mul_f32 v116, s56, v116
    v_mul_f32 v117, s56, v117
    v_mul_f32 v118, s56, v118
    v_mul_f32 v119, s56, v119
    v_mfma_f32_16x16x32_bf16 v[100:103], a[244:247], a[212:215], v[100:103]
    v_cvt_pk_bf16_f32 v208, v112, v113
    v_cvt_pk_bf16_f32 v209, v114, v115
    v_cvt_pk_bf16_f32 v210, v116, v117
    v_cvt_pk_bf16_f32 v211, v118, v119
    v_mul_f32 v24, s56, v24
    v_mul_f32 v25, s56, v25
    v_mfma_f32_16x16x32_bf16 v[132:135], a[244:247], a[216:219], v[132:135]
    s_waitcnt lgkmcnt(4)
    v_mul_f32 v26, s56, v26
    v_mul_f32 v27, s56, v27
    v_mul_f32 v28, s56, v28
    v_mul_f32 v29, s56, v29
    v_mul_f32 v30, s56, v30
    v_mfma_f32_16x16x32_bf16 v[40:43], a[248:251], a[204:207], v[40:43]
    v_mul_f32 v31, s56, v31
    v_cvt_pk_bf16_f32 v164, v24, v25
    v_cvt_pk_bf16_f32 v165, v26, v27
    v_cvt_pk_bf16_f32 v166, v28, v29
    v_cvt_pk_bf16_f32 v167, v30, v31
    v_mfma_f32_16x16x32_bf16 v[72:75], a[248:251], a[208:211], v[72:75]
    s_waitcnt vmcnt(34) lgkmcnt(0)
    s_barrier
    ds_read_b128 v[232:235], v10
    ds_read_b128 v[236:239], v10 offset:1024
    ds_read_b128 a[184:187], v240 offset:0
    ds_read_b128 a[188:191], v240 offset:64
    ds_read_b128 a[192:195], v241 offset:0
    ds_read_b128 a[196:199], v241 offset:64
    v_mul_f32 v56, s56, v56
    v_mfma_f32_16x16x32_bf16 v[104:107], a[248:251], a[212:215], v[104:107]
    v_mul_f32 v57, s56, v57
    v_mul_f32 v58, s56, v58
    v_mul_f32 v59, s56, v59
    v_mul_f32 v60, s56, v60
    v_mul_f32 v61, s56, v61
    v_mul_f32 v62, s56, v62
    v_mul_f32 v63, s56, v63
    v_mfma_f32_16x16x32_bf16 v[136:139], a[248:251], a[216:219], v[136:139]
    ds_read_b128 a[224:227], v240 offset:256
    ds_read_b128 a[228:231], v240 offset:320
    v_cvt_pk_bf16_f32 v180, v56, v57
    v_cvt_pk_bf16_f32 v181, v58, v59
    v_cvt_pk_bf16_f32 v182, v60, v61
    v_cvt_pk_bf16_f32 v183, v62, v63
    v_mfma_f32_16x16x32_bf16 v[44:47], a[252:255], a[204:207], v[44:47]
    ds_read_b128 a[232:235], v241 offset:256
    ds_read_b128 a[236:239], v241 offset:320
    v_mul_f32 v88, s56, v88
    v_mul_f32 v89, s56, v89
    v_mul_f32 v90, s56, v90
    v_mul_f32 v91, s56, v91
    v_mul_f32 v92, s56, v92
    v_mfma_f32_16x16x32_bf16 v[76:79], a[252:255], a[208:211], v[76:79]
    v_mul_f32 v93, s56, v93
    v_mul_f32 v94, s56, v94
    v_mul_f32 v95, s56, v95
    v_cvt_pk_bf16_f32 v196, v88, v89
    v_cvt_pk_bf16_f32 v197, v90, v91
    v_cvt_pk_bf16_f32 v198, v92, v93
    v_mfma_f32_16x16x32_bf16 v[108:111], a[252:255], a[212:215], v[108:111]
    v_cvt_pk_bf16_f32 v199, v94, v95
    v_mul_f32 v120, s56, v120
    v_mul_f32 v121, s56, v121
    v_mul_f32 v122, s56, v122
    v_mul_f32 v123, s56, v123
    v_mul_f32 v124, s56, v124
    v_mul_f32 v125, s56, v125
    v_mfma_f32_16x16x32_bf16 v[140:143], a[252:255], a[216:219], v[140:143]
    v_mul_f32 v126, s56, v126
    v_mul_f32 v127, s56, v127
    v_cvt_pk_bf16_f32 v212, v120, v121
    v_cvt_pk_bf16_f32 v213, v122, v123
    v_cvt_pk_bf16_f32 v214, v124, v125
    v_cvt_pk_bf16_f32 v215, v126, v127
    v_mul_f32 v32, s56, v32
    v_mul_f32 v33, s56, v33
    v_mul_f32 v34, s56, v34
    v_mul_f32 v35, s56, v35
    v_mul_f32 v36, s56, v36
    v_mul_f32 v37, s56, v37
    v_mul_f32 v38, s56, v38
    v_mul_f32 v39, s56, v39
    v_cvt_pk_bf16_f32 v168, v32, v33
    v_cvt_pk_bf16_f32 v169, v34, v35
    v_cvt_pk_bf16_f32 v170, v36, v37
    v_cvt_pk_bf16_f32 v171, v38, v39
    s_add_u32 m0, s88, 67584
    s_mov_b32 s46, 32768
    buffer_load_dwordx4 v246, s[12:15], s46 offen nt lds
    s_add_u32 m0, s88, 68640
    s_mov_b32 s46, 32768
    buffer_load_dwordx4 v247, s[12:15], s46 offen nt lds
    v_mul_f32 v40, s56, v40
    v_mul_f32 v41, s56, v41
    v_mul_f32 v42, s56, v42
    v_mul_f32 v43, s56, v43
    v_mul_f32 v44, s56, v44
    v_mul_f32 v45, s56, v45
    v_mul_f32 v46, s56, v46
    v_mul_f32 v47, s56, v47
    v_cvt_pk_bf16_f32 v172, v40, v41
    v_cvt_pk_bf16_f32 v173, v42, v43
    v_cvt_pk_bf16_f32 v174, v44, v45
    v_cvt_pk_bf16_f32 v175, v46, v47
    s_waitcnt lgkmcnt(0)
    v_mfma_f32_16x16x32_bf16 v[16:19], a[184:187], v[160:163], 0
    v_mul_f32 v64, s56, v64
    v_mul_f32 v65, s56, v65
    v_mul_f32 v66, s56, v66
    v_mul_f32 v67, s56, v67
    v_mfma_f32_16x16x32_bf16 v[24:27], a[184:187], v[176:179], 0
    v_mul_f32 v68, s56, v68
    v_mul_f32 v69, s56, v69
    v_mul_f32 v70, s56, v70
    v_mul_f32 v71, s56, v71
    v_mfma_f32_16x16x32_bf16 v[32:35], a[184:187], v[192:195], 0
    v_cvt_pk_bf16_f32 v184, v64, v65
    v_cvt_pk_bf16_f32 v185, v66, v67
    v_cvt_pk_bf16_f32 v186, v68, v69
    v_cvt_pk_bf16_f32 v187, v70, v71
    v_mfma_f32_16x16x32_bf16 v[40:43], a[184:187], v[208:211], 0
    v_mul_f32 v96, s56, v96
    v_mul_f32 v97, s56, v97
    v_mul_f32 v98, s56, v98
    v_mul_f32 v99, s56, v99
    v_mfma_f32_16x16x32_bf16 v[48:51], a[184:187], v[224:227], 0
    v_mul_f32 v100, s56, v100
    v_mul_f32 v101, s56, v101
    v_mul_f32 v102, s56, v102
    v_mul_f32 v103, s56, v103
    v_cvt_pk_bf16_f32 v200, v96, v97
    v_mfma_f32_16x16x32_bf16 v[16:19], a[188:191], v[164:167], v[16:19]
    v_cvt_pk_bf16_f32 v201, v98, v99
    v_cvt_pk_bf16_f32 v202, v100, v101
    v_cvt_pk_bf16_f32 v203, v102, v103
    v_mul_f32 v128, s56, v128
    v_mfma_f32_16x16x32_bf16 v[24:27], a[188:191], v[180:183], v[24:27]
    v_mul_f32 v129, s56, v129
    v_mul_f32 v130, s56, v130
    v_mul_f32 v131, s56, v131
    v_mul_f32 v132, s56, v132
    v_mfma_f32_16x16x32_bf16 v[32:35], a[188:191], v[196:199], v[32:35]
    v_mul_f32 v133, s56, v133
    v_mul_f32 v134, s56, v134
    v_mul_f32 v135, s56, v135
    v_cvt_pk_bf16_f32 v216, v128, v129
    v_mfma_f32_16x16x32_bf16 v[40:43], a[188:191], v[212:215], v[40:43]
    s_add_u32 m0, s88, 69696
    v_cvt_pk_bf16_f32 v217, v130, v131
    v_cvt_pk_bf16_f32 v218, v132, v133
    v_cvt_pk_bf16_f32 v219, v134, v135
    v_mfma_f32_16x16x32_bf16 v[48:51], a[188:191], v[228:231], v[48:51]
    s_mov_b32 s46, 32768
    buffer_load_dwordx4 v248, s[12:15], s46 offen nt lds
    s_add_u32 m0, s88, 70752
    s_mov_b32 s46, 32768
    buffer_load_dwordx4 v249, s[12:15], s46 offen nt lds
    v_mfma_f32_16x16x32_bf16 v[16:19], a[192:195], v[168:171], v[16:19]
    v_mul_f32 v72, s56, v72
    v_mul_f32 v73, s56, v73
    v_mul_f32 v74, s56, v74
    v_mul_f32 v75, s56, v75
    v_mul_f32 v76, s56, v76
    v_mul_f32 v77, s56, v77
    v_mul_f32 v78, s56, v78
    v_mfma_f32_16x16x32_bf16 v[24:27], a[192:195], v[184:187], v[24:27]
    v_mul_f32 v79, s56, v79
    v_cvt_pk_bf16_f32 v188, v72, v73
    v_cvt_pk_bf16_f32 v189, v74, v75
    v_cvt_pk_bf16_f32 v190, v76, v77
    v_cvt_pk_bf16_f32 v191, v78, v79
    v_mul_f32 v104, s56, v104
    v_mul_f32 v105, s56, v105
    v_mfma_f32_16x16x32_bf16 v[32:35], a[192:195], v[200:203], v[32:35]
    v_mul_f32 v106, s56, v106
    v_mul_f32 v107, s56, v107
    v_mul_f32 v108, s56, v108
    v_mul_f32 v109, s56, v109
    v_mul_f32 v110, s56, v110
    v_mul_f32 v111, s56, v111
    v_cvt_pk_bf16_f32 v204, v104, v105
    v_mfma_f32_16x16x32_bf16 v[40:43], a[192:195], v[216:219], v[40:43]
    v_cvt_pk_bf16_f32 v205, v106, v107
    v_cvt_pk_bf16_f32 v206, v108, v109
    v_cvt_pk_bf16_f32 v207, v110, v111
    v_mul_f32 v136, s56, v136
    v_mul_f32 v137, s56, v137
    v_mul_f32 v138, s56, v138
    v_mul_f32 v139, s56, v139
    v_mfma_f32_16x16x32_bf16 v[48:51], a[192:195], v[232:235], v[48:51]
    v_mul_f32 v140, s56, v140
    v_mul_f32 v141, s56, v141
    v_mul_f32 v142, s56, v142
    v_mul_f32 v143, s56, v143
    v_cvt_pk_bf16_f32 v220, v136, v137
    v_cvt_pk_bf16_f32 v221, v138, v139
    v_cvt_pk_bf16_f32 v222, v140, v141
    v_cvt_pk_bf16_f32 v223, v142, v143
    s_nop 0
    v_mfma_f32_16x16x32_bf16 v[16:19], a[196:199], v[172:175], v[16:19]
    v_mfma_f32_16x16x32_bf16 v[24:27], a[196:199], v[188:191], v[24:27]
    v_mfma_f32_16x16x32_bf16 v[32:35], a[196:199], v[204:207], v[32:35]
    v_mfma_f32_16x16x32_bf16 v[40:43], a[196:199], v[220:223], v[40:43]
    v_mfma_f32_16x16x32_bf16 v[48:51], a[196:199], v[236:239], v[48:51]
    v_add_u32 v148, 33792, v240
    v_add_u32 v149, 33792, v241
    v_mov_b32 v150, v242
    v_mov_b32 v151, v243
    ds_read_b128 a[192:195], v150 offset:0
    ds_read_b128 a[196:199], v150 offset:64
    ds_read_b128 a[200:203], v151 offset:0
    ds_read_b128 a[204:207], v151 offset:64
    ds_read_b128 a[208:211], v150 offset:256
    ds_read_b128 a[212:215], v150 offset:320
    ds_read_b128 a[216:219], v151 offset:256
    ds_read_b128 a[220:223], v151 offset:320
    s_add_u32 m0, s88, 84480
    s_mov_b32 s46, 32768
    buffer_load_dwordx4 v246, s[16:19], s46 offen nt lds
    s_add_u32 m0, s88, 85536
    s_mov_b32 s46, 32768
    buffer_load_dwordx4 v247, s[16:19], s46 offen nt lds
    v_max3_f32 v96, v16, v17, v18
    v_max3_f32 v97, v24, v25, v26
    v_max3_f32 v98, v32, v33, v34
    v_max3_f32 v99, v40, v41, v42
    v_max3_f32 v100, v48, v49, v50
    v_max_f32 v96, v96, v19
    v_max_f32 v97, v97, v27
    v_max_f32 v98, v98, v35
    v_max_f32 v99, v99, v43
    v_max_f32 v100, v100, v51
    v_mov_b32 v104, v96
    v_mov_b32 v105, v97
    v_mov_b32 v106, v98
    v_mov_b32 v107, v99
    v_mov_b32 v108, v100
    v_permlane32_swap_b32 v96, v104
    v_permlane32_swap_b32 v97, v105
    v_permlane32_swap_b32 v98, v106
    v_permlane32_swap_b32 v99, v107
    v_permlane32_swap_b32 v100, v108
    v_max_f32 v96, v96, v104
    v_max_f32 v97, v97, v105
    v_max_f32 v98, v98, v106
    v_max_f32 v99, v99, v107
    v_max_f32 v100, v100, v108
    v_mov_b32 v104, v96
    v_mov_b32 v105, v97
    v_mov_b32 v106, v98
    v_mov_b32 v107, v99
    v_mov_b32 v108, v100
    v_permlane16_swap_b32 v96, v104
    v_permlane16_swap_b32 v97, v105
    v_permlane16_swap_b32 v98, v106
    v_permlane16_swap_b32 v99, v107
    v_permlane16_swap_b32 v100, v108
    v_max_f32 v96, v96, v104
    v_max_f32 v97, v97, v105
    v_max_f32 v98, v98, v106
    v_max_f32 v99, v99, v107
    v_max_f32 v100, v100, v108
    v_sub_f32 v128, 0, v96
    v_sub_f32 v129, 0, v96
    v_sub_f32 v130, 0, v96
    v_sub_f32 v131, 0, v96
    v_sub_f32 v132, 0, v97
    v_sub_f32 v133, 0, v97
    v_sub_f32 v134, 0, v97
    v_sub_f32 v135, 0, v97
    v_sub_f32 v136, 0, v98
    v_sub_f32 v137, 0, v98
    v_sub_f32 v138, 0, v98
    v_sub_f32 v139, 0, v98
    v_sub_f32 v140, 0, v99
    v_sub_f32 v141, 0, v99
    v_sub_f32 v142, 0, v99
    v_sub_f32 v143, 0, v99
    v_sub_f32 v144, 0, v100
    v_sub_f32 v145, 0, v100
    v_sub_f32 v146, 0, v100
    v_sub_f32 v147, 0, v100
    s_add_u32 m0, s88, 86592
    s_mov_b32 s46, 32768
    buffer_load_dwordx4 v248, s[16:19], s46 offen nt lds
    s_add_u32 m0, s88, 87648
    s_mov_b32 s46, 32768
    buffer_load_dwordx4 v249, s[16:19], s46 offen nt lds
    buffer_load_dword v252, v7, s[84:87], s30 offen
    v_mfma_f32_16x16x32_bf16 v[20:23], a[224:227], v[160:163], v[128:131]
    v_sub_f32 v16, v16, v96
    v_sub_f32 v17, v17, v96
    v_mfma_f32_16x16x32_bf16 v[28:31], a[224:227], v[176:179], v[132:135]
    v_sub_f32 v18, v18, v96
    v_sub_f32 v19, v19, v96
    v_sub_f32 v24, v24, v97
    v_mfma_f32_16x16x32_bf16 v[36:39], a[224:227], v[192:195], v[136:139]
    v_sub_f32 v25, v25, v97
    v_sub_f32 v26, v26, v97
    v_mfma_f32_16x16x32_bf16 v[44:47], a[224:227], v[208:211], v[140:143]
    v_sub_f32 v27, v27, v97
    v_sub_f32 v32, v32, v98
    v_sub_f32 v33, v33, v98
    v_mfma_f32_16x16x32_bf16 v[52:55], a[224:227], v[224:227], v[144:147]
    v_sub_f32 v34, v34, v98
    v_sub_f32 v35, v35, v98
    v_mfma_f32_16x16x32_bf16 v[20:23], a[228:231], v[164:167], v[20:23]
    v_sub_f32 v40, v40, v99
    v_sub_f32 v41, v41, v99
    v_sub_f32 v42, v42, v99
    v_mfma_f32_16x16x32_bf16 v[28:31], a[228:231], v[180:183], v[28:31]
    v_sub_f32 v43, v43, v99
    v_sub_f32 v48, v48, v100
    v_mfma_f32_16x16x32_bf16 v[36:39], a[228:231], v[196:199], v[36:39]
    v_sub_f32 v49, v49, v100
    v_sub_f32 v50, v50, v100
    v_sub_f32 v51, v51, v100
    v_mfma_f32_16x16x32_bf16 v[44:47], a[228:231], v[212:215], v[44:47]
    v_exp_f32 v16, v16
    v_exp_f32 v17, v17
    v_mfma_f32_16x16x32_bf16 v[52:55], a[228:231], v[228:231], v[52:55]
    v_exp_f32 v18, v18
    v_cvt_pk_bf16_f32 v16, v16, v17
    v_exp_f32 v19, v19
    v_mfma_f32_16x16x32_bf16 v[20:23], a[232:235], v[168:171], v[20:23]
    v_exp_f32 v24, v24
    v_cvt_pk_bf16_f32 v17, v18, v19
    v_exp_f32 v25, v25
    v_mfma_f32_16x16x32_bf16 v[28:31], a[232:235], v[184:187], v[28:31]
    v_exp_f32 v26, v26
    v_cvt_pk_bf16_f32 v24, v24, v25
    v_mfma_f32_16x16x32_bf16 v[36:39], a[232:235], v[200:203], v[36:39]
    v_exp_f32 v27, v27
    v_exp_f32 v32, v32
    v_cvt_pk_bf16_f32 v25, v26, v27
    v_mfma_f32_16x16x32_bf16 v[44:47], a[232:235], v[216:219], v[44:47]
    v_exp_f32 v33, v33
    v_exp_f32 v34, v34
    v_mfma_f32_16x16x32_bf16 v[52:55], a[232:235], v[232:235], v[52:55]
    v_cvt_pk_bf16_f32 v32, v32, v33
    v_exp_f32 v35, v35
    v_exp_f32 v40, v40
    v_mfma_f32_16x16x32_bf16 v[20:23], a[236:239], v[172:175], v[20:23]
    v_cvt_pk_bf16_f32 v33, v34, v35
    v_exp_f32 v41, v41
    v_mfma_f32_16x16x32_bf16 v[28:31], a[236:239], v[188:191], v[28:31]
    v_exp_f32 v42, v42
    v_cvt_pk_bf16_f32 v40, v40, v41
    v_exp_f32 v43, v43
    v_mfma_f32_16x16x32_bf16 v[36:39], a[236:239], v[204:207], v[36:39]
    v_exp_f32 v48, v48
    v_cvt_pk_bf16_f32 v41, v42, v43
    v_mfma_f32_16x16x32_bf16 v[44:47], a[236:239], v[220:223], v[44:47]
    v_exp_f32 v49, v49
    v_exp_f32 v50, v50
    v_cvt_pk_bf16_f32 v48, v48, v49
    v_mfma_f32_16x16x32_bf16 v[52:55], a[236:239], v[236:239], v[52:55]
    v_exp_f32 v51, v51
    s_nop 0
    v_cvt_pk_bf16_f32 v49, v50, v51
    s_nop 3
L1_presm:
    v_exp_f32 v20, v20
    v_exp_f32 v21, v21
    v_exp_f32 v22, v22
    v_cvt_pk_bf16_f32 v18, v20, v21
    v_exp_f32 v23, v23
    v_exp_f32 v28, v28
    v_cvt_pk_bf16_f32 v19, v22, v23
    v_exp_f32 v29, v29
    v_exp_f32 v30, v30
    v_exp_f32 v31, v31
    v_cvt_pk_bf16_f32 v26, v28, v29
    v_exp_f32 v36, v36
    v_cvt_pk_bf16_f32 v27, v30, v31
    v_exp_f32 v37, v37
    v_exp_f32 v38, v38
    v_cvt_pk_bf16_f32 v34, v36, v37
    v_exp_f32 v39, v39
    v_exp_f32 v44, v44
    v_cvt_pk_bf16_f32 v35, v38, v39
    v_exp_f32 v45, v45
    v_exp_f32 v46, v46
    v_cvt_pk_bf16_f32 v42, v44, v45
    v_exp_f32 v47, v47
    s_waitcnt lgkmcnt(0)
.p2align 6
L1_loop:
    v_mfma_f32_16x16x32_bf16 v[96:99], a[192:195], v[160:163], v[128:131]
    v_cvt_pk_bf16_f32 v43, v46, v47
    v_add_u32 v152, s54, v244
    v_mfma_f32_16x16x32_bf16 v[96:99], a[196:199], v[164:167], v[96:99]
    v_exp_f32 v52, v52
    v_mfma_f32_16x16x32_bf16 v[96:99], a[200:203], v[168:171], v[96:99]
    s_waitcnt vmcnt(9)
    v_exp_f32 v53, v53
    v_mfma_f32_16x16x32_bf16 v[96:99], a[204:207], v[172:175], v[96:99]
    s_barrier
    v_mfma_f32_16x16x32_bf16 v[104:107], a[192:195], v[176:179], v[132:135]
    ds_read_b128 a[224:227], v148 offset:0
    v_cvt_pk_bf16_f32 v50, v52, v53
    v_mfma_f32_16x16x32_bf16 v[104:107], a[196:199], v[180:183], v[104:107]
    v_exp_f32 v54, v54
    v_mfma_f32_16x16x32_bf16 v[104:107], a[200:203], v[184:187], v[104:107]
    ds_read_b128 a[228:231], v148 offset:64
    ds_read_b128 a[232:235], v149 offset:0
    v_mfma_f32_16x16x32_bf16 v[104:107], a[204:207], v[188:191], v[104:107]
    v_exp_f32 v55, v55
    v_mfma_f32_16x16x32_bf16 v[112:115], a[192:195], v[192:195], v[136:139]
    ds_read_b128 a[236:239], v149 offset:64
    v_cvt_pk_bf16_f32 v51, v54, v55
    v_mfma_f32_16x16x32_bf16 v[112:115], a[196:199], v[196:199], v[112:115]
    s_add_u32 m0, s51, 0
    v_exp_f32 v96, v96
    v_mfma_f32_16x16x32_bf16 v[112:115], a[200:203], v[200:203], v[112:115]
    buffer_load_dwordx4 v246, s[16:19], s52 offen nt lds
    v_mfma_f32_16x16x32_bf16 v[112:115], a[204:207], v[204:207], v[112:115]
    v_exp_f32 v97, v97
    v_mfma_f32_16x16x32_bf16 v[120:123], a[192:195], v[208:211], v[140:143]
    v_cvt_pk_bf16_f32 v20, v96, v97
    v_add_u32 v153, s54, v245
    v_mfma_f32_16x16x32_bf16 v[120:123], a[196:199], v[212:215], v[120:123]
    s_add_u32 s54, s54, 33792
    v_exp_f32 v98, v98
    v_mfma_f32_16x16x32_bf16 v[120:123], a[200:203], v[216:219], v[120:123]
    s_sub_u32 s47, s54, 118272
    v_add_u32 v150, s3, v148
    v_add_u32 v151, s3, v149
    v_mfma_f32_16x16x32_bf16 v[120:123], a[204:207], v[220:223], v[120:123]
    s_min_u32 s54, s54, s47
    v_exp_f32 v99, v99
    v_mfma_f32_16x16x32_bf16 v[100:103], a[208:211], v[160:163], v[128:131]
    v_cvt_pk_bf16_f32 v21, v98, v99
    v_mfma_f32_16x16x32_bf16 v[100:103], a[212:215], v[164:167], v[100:103]
    v_exp_f32 v104, v104
    v_mfma_f32_16x16x32_bf16 v[100:103], a[216:219], v[168:171], v[100:103]
    v_mfma_f32_16x16x32_bf16 v[100:103], a[220:223], v[172:175], v[100:103]
    v_exp_f32 v105, v105
    v_mfma_f32_16x16x32_bf16 v[108:111], a[208:211], v[176:179], v[132:135]
    v_cvt_pk_bf16_f32 v28, v104, v105
    v_mfma_f32_16x16x32_bf16 v[108:111], a[212:215], v[180:183], v[108:111]
    v_exp_f32 v106, v106
    v_mfma_f32_16x16x32_bf16 v[108:111], a[216:219], v[184:187], v[108:111]
    ds_read_b128 a[240:243], v148 offset:256
    ds_read_b128 a[244:247], v148 offset:320
    v_mfma_f32_16x16x32_bf16 v[108:111], a[220:223], v[188:191], v[108:111]
    v_exp_f32 v107, v107
    v_mfma_f32_16x16x32_bf16 v[116:119], a[208:211], v[192:195], v[136:139]
    ds_read_b128 a[248:251], v149 offset:256
    v_cvt_pk_bf16_f32 v29, v106, v107
    v_mfma_f32_16x16x32_bf16 v[116:119], a[212:215], v[196:199], v[116:119]
    s_add_u32 m0, s51, 1056
    v_exp_f32 v112, v112
    v_mfma_f32_16x16x32_bf16 v[116:119], a[216:219], v[200:203], v[116:119]
    buffer_load_dwordx4 v247, s[16:19], s52 offen nt lds
    v_mfma_f32_16x16x32_bf16 v[116:119], a[220:223], v[204:207], v[116:119]
    v_exp_f32 v113, v113
    v_mfma_f32_16x16x32_bf16 v[124:127], a[208:211], v[208:211], v[140:143]
    ds_read_b128 a[252:255], v149 offset:320
    v_cvt_pk_bf16_f32 v36, v112, v113
    v_mfma_f32_16x16x32_bf16 v[124:127], a[212:215], v[212:215], v[124:127]
    v_exp_f32 v114, v114
    v_mfma_f32_16x16x32_bf16 v[124:127], a[216:219], v[216:219], v[124:127]
    s_waitcnt lgkmcnt(4)
    v_mfma_f32_16x16x32_bf16 v[124:127], a[220:223], v[220:223], v[124:127]
    v_exp_f32 v115, v115
    v_mfma_f32_16x16x32_bf16 v[56:59], a[224:227], v[160:163], v[128:131]
    v_cvt_pk_bf16_f32 v37, v114, v115
    v_mfma_f32_16x16x32_bf16 v[56:59], a[228:231], v[164:167], v[56:59]
    v_exp_f32 v120, v120
    v_mfma_f32_16x16x32_bf16 v[56:59], a[232:235], v[168:171], v[56:59]
    v_mfma_f32_16x16x32_bf16 v[56:59], a[236:239], v[172:175], v[56:59]
    v_exp_f32 v121, v121
    v_mfma_f32_16x16x32_bf16 v[64:67], a[224:227], v[176:179], v[132:135]
    v_cvt_pk_bf16_f32 v44, v120, v121
    v_mfma_f32_16x16x32_bf16 v[64:67], a[228:231], v[180:183], v[64:67]
    v_exp_f32 v122, v122
    v_mfma_f32_16x16x32_bf16 v[64:67], a[232:235], v[184:187], v[64:67]
    v_mfma_f32_16x16x32_bf16 v[64:67], a[236:239], v[188:191], v[64:67]
    v_exp_f32 v123, v123
    v_mfma_f32_16x16x32_bf16 v[72:75], a[224:227], v[192:195], v[136:139]
    v_exp_f32 v100, v100
    v_mfma_f32_16x16x32_bf16 v[72:75], a[228:231], v[196:199], v[72:75]
    s_add_u32 m0, s51, 2112
    v_cvt_pk_bf16_f32 v45, v122, v123
    v_mfma_f32_16x16x32_bf16 v[72:75], a[232:235], v[200:203], v[72:75]
    v_exp_f32 v101, v101
    v_mfma_f32_16x16x32_bf16 v[72:75], a[236:239], v[204:207], v[72:75]
    buffer_load_dwordx4 v248, s[16:19], s52 offen nt lds
    v_mfma_f32_16x16x32_bf16 v[80:83], a[224:227], v[208:211], v[140:143]
    v_exp_f32 v102, v102
    v_mfma_f32_16x16x32_bf16 v[80:83], a[228:231], v[212:215], v[80:83]
    ds_read_b64_tr_b16 a[192:193], v152 offset:0
    v_cvt_pk_bf16_f32 v22, v100, v101
    v_mfma_f32_16x16x32_bf16 v[80:83], a[232:235], v[216:219], v[80:83]
    v_exp_f32 v103, v103
    v_mfma_f32_16x16x32_bf16 v[80:83], a[236:239], v[220:223], v[80:83]
    ds_read_b64_tr_b16 a[194:195], v152 offset:256
    v_cvt_pk_bf16_f32 v23, v102, v103
    v_mfma_f32_16x16x32_bf16 v[88:91], a[224:227], v[224:227], v[144:147]
    v_exp_f32 v108, v108
    v_mfma_f32_16x16x32_bf16 v[88:91], a[228:231], v[228:231], v[88:91]
    ds_read_b64_tr_b16 a[196:197], v153 offset:0
    ds_read_b64_tr_b16 a[198:199], v153 offset:256
    v_mfma_f32_16x16x32_bf16 v[88:91], a[232:235], v[232:235], v[88:91]
    v_exp_f32 v109, v109
    v_mfma_f32_16x16x32_bf16 v[88:91], a[236:239], v[236:239], v[88:91]
    s_waitcnt lgkmcnt(4)
    ds_read_b64_tr_b16 a[200:201], v152 offset:32
    v_cvt_pk_bf16_f32 v30, v108, v109
    v_mfma_f32_16x16x32_bf16 v[60:63], a[240:243], v[160:163], v[128:131]
    v_exp_f32 v110, v110
    v_mfma_f32_16x16x32_bf16 v[60:63], a[244:247], v[164:167], v[60:63]
    ds_read_b64_tr_b16 a[202:203], v152 offset:288
    ds_read_b64_tr_b16 a[204:205], v153 offset:32
    v_mfma_f32_16x16x32_bf16 v[60:63], a[248:251], v[168:171], v[60:63]
    v_exp_f32 v111, v111
    v_mfma_f32_16x16x32_bf16 v[60:63], a[252:255], v[172:175], v[60:63]
    ds_read_b64_tr_b16 a[206:207], v153 offset:288
    v_cvt_pk_bf16_f32 v31, v110, v111
    v_mfma_f32_16x16x32_bf16 v[68:71], a[240:243], v[176:179], v[132:135]
    v_exp_f32 v116, v116
    v_mfma_f32_16x16x32_bf16 v[68:71], a[244:247], v[180:183], v[68:71]
    s_add_u32 m0, s51, 3168
    v_mfma_f32_16x16x32_bf16 v[68:71], a[248:251], v[184:187], v[68:71]
    v_exp_f32 v117, v117
    v_mfma_f32_16x16x32_bf16 v[68:71], a[252:255], v[188:191], v[68:71]
    buffer_load_dwordx4 v249, s[16:19], s52 offen nt lds
    v_mfma_f32_16x16x32_bf16 v[76:79], a[240:243], v[192:195], v[136:139]
    s_add_u32 s51, s53, s88
    v_exp_f32 v118, v118
    v_mfma_f32_16x16x32_bf16 v[76:79], a[244:247], v[196:199], v[76:79]
    s_add_u32 s53, s53, 33792
    ds_read_b64_tr_b16 a[208:209], v152 offset:64
    v_cvt_pk_bf16_f32 v38, v116, v117
    v_mfma_f32_16x16x32_bf16 v[76:79], a[248:251], v[200:203], v[76:79]
    s_sub_u32 s57, s53, 118272
    v_exp_f32 v119, v119
    v_mfma_f32_16x16x32_bf16 v[76:79], a[252:255], v[204:207], v[76:79]
    s_min_u32 s53, s53, s57
    ds_read_b64_tr_b16 a[210:211], v152 offset:320
    v_cvt_pk_bf16_f32 v39, v118, v119
    v_mfma_f32_16x16x32_bf16 v[84:87], a[240:243], v[208:211], v[140:143]
    v_exp_f32 v124, v124
    v_mfma_f32_16x16x32_bf16 v[84:87], a[244:247], v[212:215], v[84:87]
    ds_read_b64_tr_b16 a[212:213], v153 offset:64
    ds_read_b64_tr_b16 a[214:215], v153 offset:320
    v_mfma_f32_16x16x32_bf16 v[84:87], a[248:251], v[216:219], v[84:87]
    v_exp_f32 v125, v125
    v_mfma_f32_16x16x32_bf16 v[84:87], a[252:255], v[220:223], v[84:87]
    v_cvt_pk_bf16_f32 v46, v124, v125
    v_add_u32 v148, s53, v240
    v_mfma_f32_16x16x32_bf16 v[92:95], a[240:243], v[224:227], v[144:147]
    v_exp_f32 v126, v126
    v_mfma_f32_16x16x32_bf16 v[92:95], a[244:247], v[228:231], v[92:95]
    v_add_u32 v149, s53, v241
    v_mfma_f32_16x16x32_bf16 v[92:95], a[248:251], v[232:235], v[92:95]
    v_exp_f32 v127, v127
    v_mfma_f32_16x16x32_bf16 v[92:95], a[252:255], v[236:239], v[92:95]
    s_waitcnt lgkmcnt(8)
    ds_read_b64_tr_b16 a[216:217], v152 offset:96
    v_cvt_pk_bf16_f32 v47, v126, v127
    v_mfma_f32_16x16x32_bf16 a[0:3], a[192:195], v[16:19], a[0:3]
    v_exp_f32 v56, v56
    v_mfma_f32_16x16x32_bf16 a[0:3], a[196:199], v[20:23], a[0:3]
    s_add_u32 m0, s50, 0
    ds_read_b64_tr_b16 a[218:219], v152 offset:352
    ds_read_b64_tr_b16 a[220:221], v153 offset:96
    v_mfma_f32_16x16x32_bf16 a[32:35], a[192:195], v[24:27], a[32:35]
    v_exp_f32 v57, v57
    v_mfma_f32_16x16x32_bf16 a[32:35], a[196:199], v[28:31], a[32:35]
    buffer_load_dwordx4 v246, s[12:15], s52 offen nt lds
    v_mfma_f32_16x16x32_bf16 a[64:67], a[192:195], v[32:35], a[64:67]
    v_exp_f32 v58, v58
    v_mfma_f32_16x16x32_bf16 a[64:67], a[196:199], v[36:39], a[64:67]
    ds_read_b64_tr_b16 a[222:223], v153 offset:352
    v_cvt_pk_bf16_f32 v56, v56, v57
    v_mfma_f32_16x16x32_bf16 a[96:99], a[192:195], v[40:43], a[96:99]
    v_exp_f32 v59, v59
    v_mfma_f32_16x16x32_bf16 a[96:99], a[196:199], v[44:47], a[96:99]
    v_cvt_pk_bf16_f32 v57, v58, v59
    v_mfma_f32_16x16x32_bf16 a[128:131], a[192:195], v[48:51], a[128:131]
    s_waitcnt lgkmcnt(8)
    ds_read_b64_tr_b16 a[224:225], v152 offset:128
    ds_read_b64_tr_b16 a[226:227], v152 offset:384
    v_mfma_f32_16x16x32_bf16 a[4:7], a[200:203], v[16:19], a[4:7]
    v_exp_f32 v64, v64
    v_mfma_f32_16x16x32_bf16 a[4:7], a[204:207], v[20:23], a[4:7]
    ds_read_b64_tr_b16 a[228:229], v153 offset:128
    ds_read_b64_tr_b16 a[230:231], v153 offset:384
    v_mfma_f32_16x16x32_bf16 a[36:39], a[200:203], v[24:27], a[36:39]
    v_exp_f32 v65, v65
    v_mfma_f32_16x16x32_bf16 a[36:39], a[204:207], v[28:31], a[36:39]
    v_cvt_pk_bf16_f32 v64, v64, v65
    v_mfma_f32_16x16x32_bf16 a[68:71], a[200:203], v[32:35], a[68:71]
    v_exp_f32 v66, v66
    v_mfma_f32_16x16x32_bf16 a[68:71], a[204:207], v[36:39], a[68:71]
    buffer_load_dword v252, v7, s[84:87], s30 offen
    v_mfma_f32_16x16x32_bf16 a[100:103], a[200:203], v[40:43], a[100:103]
    s_add_u32 s30, s30, s61
    v_exp_f32 v67, v67
    v_mfma_f32_16x16x32_bf16 a[100:103], a[204:207], v[44:47], a[100:103]
    v_cvt_pk_bf16_f32 v65, v66, v67
    v_mfma_f32_16x16x32_bf16 a[132:135], a[200:203], v[48:51], a[132:135]
    s_waitcnt lgkmcnt(8)
    v_exp_f32 v72, v72
    v_mfma_f32_16x16x32_bf16 a[8:11], a[208:211], v[16:19], a[8:11]
    s_add_u32 m0, s50, 1056
    ds_read_b64_tr_b16 a[232:233], v152 offset:160
    ds_read_b64_tr_b16 a[234:235], v152 offset:416
    v_mfma_f32_16x16x32_bf16 a[8:11], a[212:215], v[20:23], a[8:11]
    v_exp_f32 v73, v73
    v_mfma_f32_16x16x32_bf16 a[40:43], a[208:211], v[24:27], a[40:43]
    buffer_load_dwordx4 v247, s[12:15], s52 offen nt lds
    v_mfma_f32_16x16x32_bf16 a[40:43], a[212:215], v[28:31], a[40:43]
    ds_read_b64_tr_b16 a[236:237], v153 offset:160
    v_cvt_pk_bf16_f32 v72, v72, v73
    v_mfma_f32_16x16x32_bf16 a[72:75], a[208:211], v[32:35], a[72:75]
    v_exp_f32 v74, v74
    v_mfma_f32_16x16x32_bf16 a[72:75], a[212:215], v[36:39], a[72:75]
    ds_read_b64_tr_b16 a[238:239], v153 offset:416
    v_mfma_f32_16x16x32_bf16 a[104:107], a[208:211], v[40:43], a[104:107]
    v_exp_f32 v75, v75
    v_mfma_f32_16x16x32_bf16 a[104:107], a[212:215], v[44:47], a[104:107]
    v_cvt_pk_bf16_f32 v73, v74, v75
    v_mfma_f32_16x16x32_bf16 a[136:139], a[208:211], v[48:51], a[136:139]
    v_exp_f32 v80, v80
    v_smfmac_f32_16x16x64_bf16 a[160:163], a[180:183], v[16:23], v255
    s_waitcnt lgkmcnt(8)
    v_mfma_f32_16x16x32_bf16 a[12:15], a[216:219], v[16:19], a[12:15]
    v_exp_f32 v81, v81
    v_mfma_f32_16x16x32_bf16 a[12:15], a[220:223], v[20:23], a[12:15]
    ds_read_b64_tr_b16 a[240:241], v152 offset:192
    v_cvt_pk_bf16_f32 v80, v80, v81
    v_mfma_f32_16x16x32_bf16 a[44:47], a[216:219], v[24:27], a[44:47]
    v_exp_f32 v82, v82
    v_mfma_f32_16x16x32_bf16 a[44:47], a[220:223], v[28:31], a[44:47]
    ds_read_b64_tr_b16 a[242:243], v152 offset:448
    ds_read_b64_tr_b16 a[244:245], v153 offset:192
    v_mfma_f32_16x16x32_bf16 a[76:79], a[216:219], v[32:35], a[76:79]
    v_exp_f32 v83, v83
    v_mfma_f32_16x16x32_bf16 a[76:79], a[220:223], v[36:39], a[76:79]
    s_add_u32 m0, s50, 2112
    ds_read_b64_tr_b16 a[246:247], v153 offset:448
    v_cvt_pk_bf16_f32 v81, v82, v83
    v_mfma_f32_16x16x32_bf16 a[108:111], a[216:219], v[40:43], a[108:111]
    v_exp_f32 v88, v88
    v_mfma_f32_16x16x32_bf16 a[108:111], a[220:223], v[44:47], a[108:111]
    buffer_load_dwordx4 v248, s[12:15], s52 offen nt lds
    v_mfma_f32_16x16x32_bf16 a[140:143], a[216:219], v[48:51], a[140:143]
    v_exp_f32 v89, v89
    v_smfmac_f32_16x16x64_bf16 a[164:167], a[180:183], v[24:31], v255
    s_waitcnt lgkmcnt(8)
    v_cvt_pk_bf16_f32 v88, v88, v89
    v_mfma_f32_16x16x32_bf16 a[16:19], a[224:227], v[16:19], a[16:19]
    ds_read_b64_tr_b16 a[248:249], v152 offset:224
    ds_read_b64_tr_b16 a[250:251], v152 offset:480
    v_mfma_f32_16x16x32_bf16 a[16:19], a[228:231], v[20:23], a[16:19]
    v_exp_f32 v90, v90
    v_mfma_f32_16x16x32_bf16 a[48:51], a[224:227], v[24:27], a[48:51]
    ds_read_b64_tr_b16 a[252:253], v153 offset:224
    ds_read_b64_tr_b16 a[254:255], v153 offset:480
    v_mfma_f32_16x16x32_bf16 a[48:51], a[228:231], v[28:31], a[48:51]
    v_exp_f32 v91, v91
    v_mfma_f32_16x16x32_bf16 a[80:83], a[224:227], v[32:35], a[80:83]
    v_cvt_pk_bf16_f32 v89, v90, v91
    v_mfma_f32_16x16x32_bf16 a[80:83], a[228:231], v[36:39], a[80:83]
    v_exp_f32 v60, v60
    v_mfma_f32_16x16x32_bf16 a[112:115], a[224:227], v[40:43], a[112:115]
    v_mfma_f32_16x16x32_bf16 a[112:115], a[228:231], v[44:47], a[112:115]
    v_exp_f32 v61, v61
    v_mfma_f32_16x16x32_bf16 a[144:147], a[224:227], v[48:51], a[144:147]
    v_cvt_pk_bf16_f32 v58, v60, v61
    v_smfmac_f32_16x16x64_bf16 a[168:171], a[180:183], v[32:39], v255
    s_waitcnt lgkmcnt(8)
    ds_read_b128 a[192:195], v150 offset:0
    v_mfma_f32_16x16x32_bf16 a[20:23], a[232:235], v[16:19], a[20:23]
    v_exp_f32 v62, v62
    v_mfma_f32_16x16x32_bf16 a[20:23], a[236:239], v[20:23], a[20:23]
    s_add_u32 m0, s50, 3168
    ds_read_b128 a[196:199], v150 offset:64
    ds_read_b128 a[200:203], v151 offset:0
    v_mfma_f32_16x16x32_bf16 a[52:55], a[232:235], v[24:27], a[52:55]
    v_exp_f32 v63, v63
    v_mfma_f32_16x16x32_bf16 a[52:55], a[236:239], v[28:31], a[52:55]
    buffer_load_dwordx4 v249, s[12:15], s52 offen nt lds
    v_mfma_f32_16x16x32_bf16 a[84:87], a[232:235], v[32:35], a[84:87]
    s_add_u32 s50, s50, 33792
    v_exp_f32 v68, v68
    v_mfma_f32_16x16x32_bf16 a[84:87], a[236:239], v[36:39], a[84:87]
    s_sub_u32 s46, s50, 118272
    ds_read_b128 a[204:207], v151 offset:64
    v_cvt_pk_bf16_f32 v59, v62, v63
    v_mfma_f32_16x16x32_bf16 a[116:119], a[232:235], v[40:43], a[116:119]
    s_min_u32 s50, s50, s46
    v_exp_f32 v69, v69
    v_mfma_f32_16x16x32_bf16 a[116:119], a[236:239], v[44:47], a[116:119]
    ds_read_b128 a[208:211], v150 offset:256
    ds_read_b128 a[212:215], v150 offset:320
    v_mfma_f32_16x16x32_bf16 a[148:151], a[232:235], v[48:51], a[148:151]
    v_exp_f32 v70, v70
    v_smfmac_f32_16x16x64_bf16 a[172:175], a[180:183], v[40:47], v255
    s_waitcnt lgkmcnt(10)
    ds_read_b128 a[216:219], v151 offset:256
    v_mfma_f32_16x16x32_bf16 a[24:27], a[240:243], v[16:19], a[24:27]
    v_exp_f32 v71, v71
    v_mfma_f32_16x16x32_bf16 a[24:27], a[244:247], v[20:23], a[24:27]
    ds_read_b128 a[220:223], v151 offset:320
    v_cvt_pk_bf16_f32 v66, v68, v69
    v_mfma_f32_16x16x32_bf16 a[56:59], a[240:243], v[24:27], a[56:59]
    v_exp_f32 v76, v76
    v_mfma_f32_16x16x32_bf16 a[56:59], a[244:247], v[28:31], a[56:59]
    s_sub_u32 s49, s49, 1
    v_cvt_pk_bf16_f32 v67, v70, v71
    v_mfma_f32_16x16x32_bf16 a[88:91], a[240:243], v[32:35], a[88:91]
    s_cbranch_scc1 L1_side
    L1_back:
    v_exp_f32 v77, v77
    v_mfma_f32_16x16x32_bf16 a[88:91], a[244:247], v[36:39], a[88:91]
    s_add_u32 s52, s52, s60
    v_cvt_pk_bf16_f32 v74, v76, v77
    v_mfma_f32_16x16x32_bf16 a[120:123], a[240:243], v[40:43], a[120:123]
    v_mfma_f32_16x16x32_bf16 a[120:123], a[244:247], v[44:47], a[120:123]
    v_exp_f32 v78, v78
    v_mfma_f32_16x16x32_bf16 a[152:155], a[240:243], v[48:51], a[152:155]
    v_mfma_f32_16x16x32_bf16 a[176:179], a[180:183], v[48:51], a[176:179]
    s_waitcnt lgkmcnt(8)
    v_exp_f32 v79, v79
    v_mfma_f32_16x16x32_bf16 a[28:31], a[248:251], v[16:19], a[28:31]
    v_cvt_pk_bf16_f32 v75, v78, v79
    v_mfma_f32_16x16x32_bf16 a[28:31], a[252:255], v[20:23], a[28:31]
    v_exp_f32 v84, v84
    v_mfma_f32_16x16x32_bf16 a[60:63], a[248:251], v[24:27], a[60:63]
    v_mfma_f32_16x16x32_bf16 a[60:63], a[252:255], v[28:31], a[60:63]
    v_exp_f32 v85, v85
    v_mfma_f32_16x16x32_bf16 a[92:95], a[248:251], v[32:35], a[92:95]
    v_cvt_pk_bf16_f32 v82, v84, v85
    v_mfma_f32_16x16x32_bf16 a[92:95], a[252:255], v[36:39], a[92:95]
    v_exp_f32 v86, v86
    v_mfma_f32_16x16x32_bf16 a[124:127], a[248:251], v[40:43], a[124:127]
    v_mfma_f32_16x16x32_bf16 a[124:127], a[252:255], v[44:47], a[124:127]
    s_waitcnt lgkmcnt(0)
    v_exp_f32 v87, v87
    v_mfma_f32_16x16x32_bf16 a[156:159], a[248:251], v[48:51], a[156:159]
    v_mfma_f32_16x16x32_bf16 v[96:99], a[192:195], v[160:163], v[128:131]
    v_cvt_pk_bf16_f32 v83, v86, v87
    v_add_u32 v152, s54, v244
    v_mfma_f32_16x16x32_bf16 v[96:99], a[196:199], v[164:167], v[96:99]
    v_exp_f32 v92, v92
    v_mfma_f32_16x16x32_bf16 v[96:99], a[200:203], v[168:171], v[96:99]
    s_waitcnt vmcnt(9)
    v_exp_f32 v93, v93
    v_mfma_f32_16x16x32_bf16 v[96:99], a[204:207], v[172:175], v[96:99]
    s_barrier
    v_mfma_f32_16x16x32_bf16 v[104:107], a[192:195], v[176:179], v[132:135]
    ds_read_b128 a[224:227], v148 offset:0
    v_cvt_pk_bf16_f32 v90, v92, v93
    v_mfma_f32_16x16x32_bf16 v[104:107], a[196:199], v[180:183], v[104:107]
    v_exp_f32 v94, v94
    v_mfma_f32_16x16x32_bf16 v[104:107], a[200:203], v[184:187], v[104:107]
    ds_read_b128 a[228:231], v148 offset:64
    ds_read_b128 a[232:235], v149 offset:0
    v_mfma_f32_16x16x32_bf16 v[104:107], a[204:207], v[188:191], v[104:107]
    v_exp_f32 v95, v95
    v_mfma_f32_16x16x32_bf16 v[112:115], a[192:195], v[192:195], v[136:139]
    ds_read_b128 a[236:239], v149 offset:64
    v_cvt_pk_bf16_f32 v91, v94, v95
    v_mfma_f32_16x16x32_bf16 v[112:115], a[196:199], v[196:199], v[112:115]
    s_add_u32 m0, s51, 0
    v_exp_f32 v96, v96
    v_mfma_f32_16x16x32_bf16 v[112:115], a[200:203], v[200:203], v[112:115]
    buffer_load_dwordx4 v246, s[16:19], s52 offen nt lds
    v_mfma_f32_16x16x32_bf16 v[112:115], a[204:207], v[204:207], v[112:115]
    v_exp_f32 v97, v97
    v_mfma_f32_16x16x32_bf16 v[120:123], a[192:195], v[208:211], v[140:143]
    v_cvt_pk_bf16_f32 v60, v96, v97
    v_add_u32 v153, s54, v245
    v_mfma_f32_16x16x32_bf16 v[120:123], a[196:199], v[212:215], v[120:123]
    s_add_u32 s54, s54, 33792
    v_exp_f32 v98, v98
    v_mfma_f32_16x16x32_bf16 v[120:123], a[200:203], v[216:219], v[120:123]
    s_sub_u32 s47, s54, 118272
    v_add_u32 v150, s3, v148
    v_add_u32 v151, s3, v149
    v_mfma_f32_16x16x32_bf16 v[120:123], a[204:207], v[220:223], v[120:123]
    s_min_u32 s54, s54, s47
    v_exp_f32 v99, v99
    v_mfma_f32_16x16x32_bf16 v[100:103], a[208:211], v[160:163], v[128:131]
    v_cvt_pk_bf16_f32 v61, v98, v99
    v_mfma_f32_16x16x32_bf16 v[100:103], a[212:215], v[164:167], v[100:103]
    v_exp_f32 v104, v104
    v_mfma_f32_16x16x32_bf16 v[100:103], a[216:219], v[168:171], v[100:103]
    v_mfma_f32_16x16x32_bf16 v[100:103], a[220:223], v[172:175], v[100:103]
    v_exp_f32 v105, v105
    v_mfma_f32_16x16x32_bf16 v[108:111], a[208:211], v[176:179], v[132:135]
    v_cvt_pk_bf16_f32 v68, v104, v105
    v_mfma_f32_16x16x32_bf16 v[108:111], a[212:215], v[180:183], v[108:111]
    v_exp_f32 v106, v106
    v_mfma_f32_16x16x32_bf16 v[108:111], a[216:219], v[184:187], v[108:111]
    ds_read_b128 a[240:243], v148 offset:256
    ds_read_b128 a[244:247], v148 offset:320
    v_mfma_f32_16x16x32_bf16 v[108:111], a[220:223], v[188:191], v[108:111]
    v_exp_f32 v107, v107
    v_mfma_f32_16x16x32_bf16 v[116:119], a[208:211], v[192:195], v[136:139]
    ds_read_b128 a[248:251], v149 offset:256
    v_cvt_pk_bf16_f32 v69, v106, v107
    v_mfma_f32_16x16x32_bf16 v[116:119], a[212:215], v[196:199], v[116:119]
    s_add_u32 m0, s51, 1056
    v_exp_f32 v112, v112
    v_mfma_f32_16x16x32_bf16 v[116:119], a[216:219], v[200:203], v[116:119]
    buffer_load_dwordx4 v247, s[16:19], s52 offen nt lds
    v_mfma_f32_16x16x32_bf16 v[116:119], a[220:223], v[204:207], v[116:119]
    v_exp_f32 v113, v113
    v_mfma_f32_16x16x32_bf16 v[124:127], a[208:211], v[208:211], v[140:143]
    ds_read_b128 a[252:255], v149 offset:320
    v_cvt_pk_bf16_f32 v76, v112, v113
    v_mfma_f32_16x16x32_bf16 v[124:127], a[212:215], v[212:215], v[124:127]
    s_cmp_eq_u32 s38, 2
    v_exp_f32 v114, v114
    v_mfma_f32_16x16x32_bf16 v[124:127], a[216:219], v[216:219], v[124:127]
    s_waitcnt lgkmcnt(4)
    v_mfma_f32_16x16x32_bf16 v[124:127], a[220:223], v[220:223], v[124:127]
    s_cbranch_scc1 L1_tail
    v_exp_f32 v115, v115
    v_mfma_f32_16x16x32_bf16 v[16:19], a[224:227], v[160:163], v[128:131]
    v_cvt_pk_bf16_f32 v77, v114, v115
    v_mfma_f32_16x16x32_bf16 v[16:19], a[228:231], v[164:167], v[16:19]
    v_exp_f32 v120, v120
    v_mfma_f32_16x16x32_bf16 v[16:19], a[232:235], v[168:171], v[16:19]
    v_mfma_f32_16x16x32_bf16 v[16:19], a[236:239], v[172:175], v[16:19]
    v_exp_f32 v121, v121
    v_mfma_f32_16x16x32_bf16 v[24:27], a[224:227], v[176:179], v[132:135]
    v_cvt_pk_bf16_f32 v84, v120, v121
    v_mfma_f32_16x16x32_bf16 v[24:27], a[228:231], v[180:183], v[24:27]
    v_exp_f32 v122, v122
    v_mfma_f32_16x16x32_bf16 v[24:27], a[232:235], v[184:187], v[24:27]
    v_mfma_f32_16x16x32_bf16 v[24:27], a[236:239], v[188:191], v[24:27]
    v_exp_f32 v123, v123
    v_mfma_f32_16x16x32_bf16 v[32:35], a[224:227], v[192:195], v[136:139]
    v_exp_f32 v100, v100
    v_mfma_f32_16x16x32_bf16 v[32:35], a[228:231], v[196:199], v[32:35]
    s_add_u32 m0, s51, 2112
    v_cvt_pk_bf16_f32 v85, v122, v123
    v_mfma_f32_16x16x32_bf16 v[32:35], a[232:235], v[200:203], v[32:35]
    v_exp_f32 v101, v101
    v_mfma_f32_16x16x32_bf16 v[32:35], a[236:239], v[204:207], v[32:35]
    buffer_load_dwordx4 v248, s[16:19], s52 offen nt lds
    v_mfma_f32_16x16x32_bf16 v[40:43], a[224:227], v[208:211], v[140:143]
    v_exp_f32 v102, v102
    v_mfma_f32_16x16x32_bf16 v[40:43], a[228:231], v[212:215], v[40:43]
    ds_read_b64_tr_b16 a[192:193], v152 offset:0
    v_cvt_pk_bf16_f32 v62, v100, v101
    v_mfma_f32_16x16x32_bf16 v[40:43], a[232:235], v[216:219], v[40:43]
    v_exp_f32 v103, v103
    v_mfma_f32_16x16x32_bf16 v[40:43], a[236:239], v[220:223], v[40:43]
    ds_read_b64_tr_b16 a[194:195], v152 offset:256
    v_cvt_pk_bf16_f32 v63, v102, v103
    v_mfma_f32_16x16x32_bf16 v[48:51], a[224:227], v[224:227], v[144:147]
    v_exp_f32 v108, v108
    v_mfma_f32_16x16x32_bf16 v[48:51], a[228:231], v[228:231], v[48:51]
    ds_read_b64_tr_b16 a[196:197], v153 offset:0
    ds_read_b64_tr_b16 a[198:199], v153 offset:256
    v_mfma_f32_16x16x32_bf16 v[48:51], a[232:235], v[232:235], v[48:51]
    v_exp_f32 v109, v109
    v_mfma_f32_16x16x32_bf16 v[48:51], a[236:239], v[236:239], v[48:51]
    s_waitcnt lgkmcnt(4)
    ds_read_b64_tr_b16 a[200:201], v152 offset:32
    v_cvt_pk_bf16_f32 v70, v108, v109
    v_mfma_f32_16x16x32_bf16 v[20:23], a[240:243], v[160:163], v[128:131]
    v_exp_f32 v110, v110
    v_mfma_f32_16x16x32_bf16 v[20:23], a[244:247], v[164:167], v[20:23]
    ds_read_b64_tr_b16 a[202:203], v152 offset:288
    ds_read_b64_tr_b16 a[204:205], v153 offset:32
    v_mfma_f32_16x16x32_bf16 v[20:23], a[248:251], v[168:171], v[20:23]
    v_exp_f32 v111, v111
    v_mfma_f32_16x16x32_bf16 v[20:23], a[252:255], v[172:175], v[20:23]
    ds_read_b64_tr_b16 a[206:207], v153 offset:288
    v_cvt_pk_bf16_f32 v71, v110, v111
    v_mfma_f32_16x16x32_bf16 v[28:31], a[240:243], v[176:179], v[132:135]
    v_exp_f32 v116, v116
    v_mfma_f32_16x16x32_bf16 v[28:31], a[244:247], v[180:183], v[28:31]
    s_add_u32 m0, s51, 3168
    v_mfma_f32_16x16x32_bf16 v[28:31], a[248:251], v[184:187], v[28:31]
    v_exp_f32 v117, v117
    v_mfma_f32_16x16x32_bf16 v[28:31], a[252:255], v[188:191], v[28:31]
    buffer_load_dwordx4 v249, s[16:19], s52 offen nt lds
    v_mfma_f32_16x16x32_bf16 v[36:39], a[240:243], v[192:195], v[136:139]
    s_add_u32 s51, s53, s88
    v_exp_f32 v118, v118
    v_mfma_f32_16x16x32_bf16 v[36:39], a[244:247], v[196:199], v[36:39]
    s_add_u32 s53, s53, 33792
    ds_read_b64_tr_b16 a[208:209], v152 offset:64
    v_cvt_pk_bf16_f32 v78, v116, v117
    v_mfma_f32_16x16x32_bf16 v[36:39], a[248:251], v[200:203], v[36:39]
    s_sub_u32 s57, s53, 118272
    v_exp_f32 v119, v119
    v_mfma_f32_16x16x32_bf16 v[36:39], a[252:255], v[204:207], v[36:39]
    s_min_u32 s53, s53, s57
    ds_read_b64_tr_b16 a[210:211], v152 offset:320
    v_cvt_pk_bf16_f32 v79, v118, v119
    v_mfma_f32_16x16x32_bf16 v[44:47], a[240:243], v[208:211], v[140:143]
    v_exp_f32 v124, v124
    v_mfma_f32_16x16x32_bf16 v[44:47], a[244:247], v[212:215], v[44:47]
    ds_read_b64_tr_b16 a[212:213], v153 offset:64
    ds_read_b64_tr_b16 a[214:215], v153 offset:320
    v_mfma_f32_16x16x32_bf16 v[44:47], a[248:251], v[216:219], v[44:47]
    v_exp_f32 v125, v125
    v_mfma_f32_16x16x32_bf16 v[44:47], a[252:255], v[220:223], v[44:47]
    v_cvt_pk_bf16_f32 v86, v124, v125
    v_add_u32 v148, s53, v240
    v_mfma_f32_16x16x32_bf16 v[52:55], a[240:243], v[224:227], v[144:147]
    v_exp_f32 v126, v126
    v_mfma_f32_16x16x32_bf16 v[52:55], a[244:247], v[228:231], v[52:55]
    v_add_u32 v149, s53, v241
    v_mfma_f32_16x16x32_bf16 v[52:55], a[248:251], v[232:235], v[52:55]
    v_exp_f32 v127, v127
    v_mfma_f32_16x16x32_bf16 v[52:55], a[252:255], v[236:239], v[52:55]
    s_waitcnt lgkmcnt(8)
    ds_read_b64_tr_b16 a[216:217], v152 offset:96
    v_cvt_pk_bf16_f32 v87, v126, v127
    v_mfma_f32_16x16x32_bf16 a[0:3], a[192:195], v[56:59], a[0:3]
    v_exp_f32 v16, v16
    v_mfma_f32_16x16x32_bf16 a[0:3], a[196:199], v[60:63], a[0:3]
    s_add_u32 m0, s50, 0
    ds_read_b64_tr_b16 a[218:219], v152 offset:352
    ds_read_b64_tr_b16 a[220:221], v153 offset:96
    v_mfma_f32_16x16x32_bf16 a[32:35], a[192:195], v[64:67], a[32:35]
    v_exp_f32 v17, v17
    v_mfma_f32_16x16x32_bf16 a[32:35], a[196:199], v[68:71], a[32:35]
    buffer_load_dwordx4 v246, s[12:15], s52 offen nt lds
    v_mfma_f32_16x16x32_bf16 a[64:67], a[192:195], v[72:75], a[64:67]
    v_exp_f32 v18, v18
    v_mfma_f32_16x16x32_bf16 a[64:67], a[196:199], v[76:79], a[64:67]
    ds_read_b64_tr_b16 a[222:223], v153 offset:352
    v_cvt_pk_bf16_f32 v16, v16, v17
    v_mfma_f32_16x16x32_bf16 a[96:99], a[192:195], v[80:83], a[96:99]
    v_exp_f32 v19, v19
    v_mfma_f32_16x16x32_bf16 a[96:99], a[196:199], v[84:87], a[96:99]
    v_cvt_pk_bf16_f32 v17, v18, v19
    v_mfma_f32_16x16x32_bf16 a[128:131], a[192:195], v[88:91], a[128:131]
    s_waitcnt lgkmcnt(8)
    ds_read_b64_tr_b16 a[224:225], v152 offset:128
    ds_read_b64_tr_b16 a[226:227], v152 offset:384
    v_mfma_f32_16x16x32_bf16 a[4:7], a[200:203], v[56:59], a[4:7]
    v_exp_f32 v24, v24
    v_mfma_f32_16x16x32_bf16 a[4:7], a[204:207], v[60:63], a[4:7]
    ds_read_b64_tr_b16 a[228:229], v153 offset:128
    ds_read_b64_tr_b16 a[230:231], v153 offset:384
    v_mfma_f32_16x16x32_bf16 a[36:39], a[200:203], v[64:67], a[36:39]
    v_exp_f32 v25, v25
    v_mfma_f32_16x16x32_bf16 a[36:39], a[204:207], v[68:71], a[36:39]
    v_cvt_pk_bf16_f32 v24, v24, v25
    v_mfma_f32_16x16x32_bf16 a[68:71], a[200:203], v[72:75], a[68:71]
    v_exp_f32 v26, v26
    v_mfma_f32_16x16x32_bf16 a[68:71], a[204:207], v[76:79], a[68:71]
    buffer_load_dword v252, v7, s[84:87], s30 offen
    v_mfma_f32_16x16x32_bf16 a[100:103], a[200:203], v[80:83], a[100:103]
    s_add_u32 s30, s30, s61
    v_exp_f32 v27, v27
    v_mfma_f32_16x16x32_bf16 a[100:103], a[204:207], v[84:87], a[100:103]
    v_cvt_pk_bf16_f32 v25, v26, v27
    v_mfma_f32_16x16x32_bf16 a[132:135], a[200:203], v[88:91], a[132:135]
    s_waitcnt lgkmcnt(8)
    v_exp_f32 v32, v32
    v_mfma_f32_16x16x32_bf16 a[8:11], a[208:211], v[56:59], a[8:11]
    s_add_u32 m0, s50, 1056
    ds_read_b64_tr_b16 a[232:233], v152 offset:160
    ds_read_b64_tr_b16 a[234:235], v152 offset:416
    v_mfma_f32_16x16x32_bf16 a[8:11], a[212:215], v[60:63], a[8:11]
    v_exp_f32 v33, v33
    v_mfma_f32_16x16x32_bf16 a[40:43], a[208:211], v[64:67], a[40:43]
    buffer_load_dwordx4 v247, s[12:15], s52 offen nt lds
    v_mfma_f32_16x16x32_bf16 a[40:43], a[212:215], v[68:71], a[40:43]
    ds_read_b64_tr_b16 a[236:237], v153 offset:160
    v_cvt_pk_bf16_f32 v32, v32, v33
    v_mfma_f32_16x16x32_bf16 a[72:75], a[208:211], v[72:75], a[72:75]
    v_exp_f32 v34, v34
    v_mfma_f32_16x16x32_bf16 a[72:75], a[212:215], v[76:79], a[72:75]
    ds_read_b64_tr_b16 a[238:239], v153 offset:416
    v_mfma_f32_16x16x32_bf16 a[104:107], a[208:211], v[80:83], a[104:107]
    v_exp_f32 v35, v35
    v_mfma_f32_16x16x32_bf16 a[104:107], a[212:215], v[84:87], a[104:107]
    v_cvt_pk_bf16_f32 v33, v34, v35
    v_mfma_f32_16x16x32_bf16 a[136:139], a[208:211], v[88:91], a[136:139]
    v_exp_f32 v40, v40
    v_smfmac_f32_16x16x64_bf16 a[160:163], a[180:183], v[56:63], v255
    s_waitcnt lgkmcnt(8)
    v_mfma_f32_16x16x32_bf16 a[12:15], a[216:219], v[56:59], a[12:15]
    v_exp_f32 v41, v41
    v_mfma_f32_16x16x32_bf16 a[12:15], a[220:223], v[60:63], a[12:15]
    ds_read_b64_tr_b16 a[240:241], v152 offset:192
    v_cvt_pk_bf16_f32 v40, v40, v41
    v_mfma_f32_16x16x32_bf16 a[44:47], a[216:219], v[64:67], a[44:47]
    v_exp_f32 v42, v42
    v_mfma_f32_16x16x32_bf16 a[44:47], a[220:223], v[68:71], a[44:47]
    ds_read_b64_tr_b16 a[242:243], v152 offset:448
    ds_read_b64_tr_b16 a[244:245], v153 offset:192
    v_mfma_f32_16x16x32_bf16 a[76:79], a[216:219], v[72:75], a[76:79]
    v_exp_f32 v43, v43
    v_mfma_f32_16x16x32_bf16 a[76:79], a[220:223], v[76:79], a[76:79]
    s_add_u32 m0, s50, 2112
    ds_read_b64_tr_b16 a[246:247], v153 offset:448
    v_cvt_pk_bf16_f32 v41, v42, v43
    v_mfma_f32_16x16x32_bf16 a[108:111], a[216:219], v[80:83], a[108:111]
    v_exp_f32 v48, v48
    v_mfma_f32_16x16x32_bf16 a[108:111], a[220:223], v[84:87], a[108:111]
    buffer_load_dwordx4 v248, s[12:15], s52 offen nt lds
    v_mfma_f32_16x16x32_bf16 a[140:143], a[216:219], v[88:91], a[140:143]
    v_exp_f32 v49, v49
    v_smfmac_f32_16x16x64_bf16 a[164:167], a[180:183], v[64:71], v255
    s_waitcnt lgkmcnt(8)
    v_cvt_pk_bf16_f32 v48, v48, v49
    v_mfma_f32_16x16x32_bf16 a[16:19], a[224:227], v[56:59], a[16:19]
    ds_read_b64_tr_b16 a[248:249], v152 offset:224
    ds_read_b64_tr_b16 a[250:251], v152 offset:480
    v_mfma_f32_16x16x32_bf16 a[16:19], a[228:231], v[60:63], a[16:19]
    v_exp_f32 v50, v50
    v_mfma_f32_16x16x32_bf16 a[48:51], a[224:227], v[64:67], a[48:51]
    ds_read_b64_tr_b16 a[252:253], v153 offset:224
    ds_read_b64_tr_b16 a[254:255], v153 offset:480
    v_mfma_f32_16x16x32_bf16 a[48:51], a[228:231], v[68:71], a[48:51]
    v_exp_f32 v51, v51
    v_mfma_f32_16x16x32_bf16 a[80:83], a[224:227], v[72:75], a[80:83]
    v_cvt_pk_bf16_f32 v49, v50, v51
    v_mfma_f32_16x16x32_bf16 a[80:83], a[228:231], v[76:79], a[80:83]
    v_exp_f32 v20, v20
    v_mfma_f32_16x16x32_bf16 a[112:115], a[224:227], v[80:83], a[112:115]
    v_mfma_f32_16x16x32_bf16 a[112:115], a[228:231], v[84:87], a[112:115]
    v_exp_f32 v21, v21
    v_mfma_f32_16x16x32_bf16 a[144:147], a[224:227], v[88:91], a[144:147]
    v_cvt_pk_bf16_f32 v18, v20, v21
    v_smfmac_f32_16x16x64_bf16 a[168:171], a[180:183], v[72:79], v255
    s_waitcnt lgkmcnt(8)
    ds_read_b128 a[192:195], v150 offset:0
    v_mfma_f32_16x16x32_bf16 a[20:23], a[232:235], v[56:59], a[20:23]
    v_exp_f32 v22, v22
    v_mfma_f32_16x16x32_bf16 a[20:23], a[236:239], v[60:63], a[20:23]
    s_add_u32 m0, s50, 3168
    ds_read_b128 a[196:199], v150 offset:64
    ds_read_b128 a[200:203], v151 offset:0
    v_mfma_f32_16x16x32_bf16 a[52:55], a[232:235], v[64:67], a[52:55]
    v_exp_f32 v23, v23
    v_mfma_f32_16x16x32_bf16 a[52:55], a[236:239], v[68:71], a[52:55]
    buffer_load_dwordx4 v249, s[12:15], s52 offen nt lds
    v_mfma_f32_16x16x32_bf16 a[84:87], a[232:235], v[72:75], a[84:87]
    s_add_u32 s50, s50, 33792
    v_exp_f32 v28, v28
    v_mfma_f32_16x16x32_bf16 a[84:87], a[236:239], v[76:79], a[84:87]
    s_sub_u32 s46, s50, 118272
    ds_read_b128 a[204:207], v151 offset:64
    v_cvt_pk_bf16_f32 v19, v22, v23
    v_mfma_f32_16x16x32_bf16 a[116:119], a[232:235], v[80:83], a[116:119]
    s_min_u32 s50, s50, s46
    v_exp_f32 v29, v29
    v_mfma_f32_16x16x32_bf16 a[116:119], a[236:239], v[84:87], a[116:119]
    ds_read_b128 a[208:211], v150 offset:256
    ds_read_b128 a[212:215], v150 offset:320
    v_mfma_f32_16x16x32_bf16 a[148:151], a[232:235], v[88:91], a[148:151]
    v_exp_f32 v30, v30
    v_smfmac_f32_16x16x64_bf16 a[172:175], a[180:183], v[80:87], v255
    s_waitcnt lgkmcnt(10)
    ds_read_b128 a[216:219], v151 offset:256
    v_mfma_f32_16x16x32_bf16 a[24:27], a[240:243], v[56:59], a[24:27]
    v_exp_f32 v31, v31
    v_mfma_f32_16x16x32_bf16 a[24:27], a[244:247], v[60:63], a[24:27]
    ds_read_b128 a[220:223], v151 offset:320
    v_cvt_pk_bf16_f32 v26, v28, v29
    v_mfma_f32_16x16x32_bf16 a[56:59], a[240:243], v[64:67], a[56:59]
    v_exp_f32 v36, v36
    v_mfma_f32_16x16x32_bf16 a[56:59], a[244:247], v[68:71], a[56:59]
    v_cvt_pk_bf16_f32 v27, v30, v31
    v_mfma_f32_16x16x32_bf16 a[88:91], a[240:243], v[72:75], a[88:91]
    v_exp_f32 v37, v37
    v_mfma_f32_16x16x32_bf16 a[88:91], a[244:247], v[76:79], a[88:91]
    s_add_u32 s52, s52, s60
    v_cvt_pk_bf16_f32 v34, v36, v37
    v_mfma_f32_16x16x32_bf16 a[120:123], a[240:243], v[80:83], a[120:123]
    v_mfma_f32_16x16x32_bf16 a[120:123], a[244:247], v[84:87], a[120:123]
    v_exp_f32 v38, v38
    v_mfma_f32_16x16x32_bf16 a[152:155], a[240:243], v[88:91], a[152:155]
    v_mfma_f32_16x16x32_bf16 a[176:179], a[180:183], v[88:91], a[176:179]
    s_waitcnt lgkmcnt(8)
    v_exp_f32 v39, v39
    v_mfma_f32_16x16x32_bf16 a[28:31], a[248:251], v[56:59], a[28:31]
    v_cvt_pk_bf16_f32 v35, v38, v39
    v_mfma_f32_16x16x32_bf16 a[28:31], a[252:255], v[60:63], a[28:31]
    v_exp_f32 v44, v44
    v_mfma_f32_16x16x32_bf16 a[60:63], a[248:251], v[64:67], a[60:63]
    v_mfma_f32_16x16x32_bf16 a[60:63], a[252:255], v[68:71], a[60:63]
    v_exp_f32 v45, v45
    v_mfma_f32_16x16x32_bf16 a[92:95], a[248:251], v[72:75], a[92:95]
    v_cvt_pk_bf16_f32 v42, v44, v45
    v_mfma_f32_16x16x32_bf16 a[92:95], a[252:255], v[76:79], a[92:95]
    v_exp_f32 v46, v46
    v_mfma_f32_16x16x32_bf16 a[124:127], a[248:251], v[80:83], a[124:127]
    v_mfma_f32_16x16x32_bf16 a[124:127], a[252:255], v[84:87], a[124:127]
    s_waitcnt lgkmcnt(0)
    v_exp_f32 v47, v47
    v_mfma_f32_16x16x32_bf16 a[156:159], a[248:251], v[88:91], a[156:159]
    s_branch L1_loop
L1_side:
    s_cmp_eq_u32 s38, 0
    s_cbranch_scc1 L1_side1
    s_mov_b32 s38, 2
    s_mov_b32 s52, 0x40000000
    s_branch L1_back
L1_side1:
    global_load_dword v252, v6, s[98:99]
    s_mov_b32 s38, 1
    s_mov_b32 s49, 0
    s_mov_b32 s60, 73728
    s_sub_u32 s52, s45, 73728
    s_mov_b32 s12, s84
    s_mov_b32 s13, s85
    s_mov_b32 s14, 4718592
    s_add_u32 s16, s84, 36864
    s_addc_u32 s17, s85, 0
    s_mov_b32 s18, 4681728
    v_add_u32 v246, 0, v2
    v_add_u32 v247, 9216, v2
    v_add_u32 v248, 18432, v2
    v_add_u32 v249, 27648, v2
    s_branch L1_back
L1_tail:
    ds_read_b64_tr_b16 a[192:193], v152 offset:0
    ds_read_b64_tr_b16 a[194:195], v152 offset:256
    ds_read_b64_tr_b16 a[196:197], v153 offset:0
    ds_read_b64_tr_b16 a[198:199], v153 offset:256
    ds_read_b64_tr_b16 a[200:201], v152 offset:32
    ds_read_b64_tr_b16 a[202:203], v152 offset:288
    ds_read_b64_tr_b16 a[204:205], v153 offset:32
    ds_read_b64_tr_b16 a[206:207], v153 offset:288
    ds_read_b64_tr_b16 a[208:209], v152 offset:64
    ds_read_b64_tr_b16 a[210:211], v152 offset:320
    ds_read_b64_tr_b16 a[212:213], v153 offset:64
    ds_read_b64_tr_b16 a[214:215], v153 offset:320
    v_exp_f32 v100, v100
    v_exp_f32 v101, v101
    v_exp_f32 v102, v102
    v_cvt_pk_bf16_f32 v62, v100, v101
    v_exp_f32 v103, v103
    s_nop 0
    v_cvt_pk_bf16_f32 v63, v102, v103
    s_mul_i32 s58, s27, 18
    s_lshl_b32 s46, s24, 2
    v_smfmac_f32_16x16x64_bf16 a[160:163], a[180:183], v[56:63], v255
    s_add_u32 s46, s46, s58
    s_mul_i32 s46, s46, 140032
    s_lshr_b32 s53, s28, 3
    s_mul_i32 s53, s53, 1152
    s_lshl_b32 s54, s28, 12
    s_add_u32 s53, s53, s54
    s_waitcnt lgkmcnt(4)
    v_mfma_f32_16x16x32_bf16 a[0:3], a[192:195], v[56:59], a[0:3]
    ds_read_b64_tr_b16 a[216:217], v152 offset:96
    ds_read_b64_tr_b16 a[218:219], v152 offset:352
    v_mfma_f32_16x16x32_bf16 a[0:3], a[196:199], v[60:63], a[0:3]
    ds_read_b64_tr_b16 a[220:221], v153 offset:96
    ds_read_b64_tr_b16 a[222:223], v153 offset:352
    v_mfma_f32_16x16x32_bf16 a[4:7], a[200:203], v[56:59], a[4:7]
    ds_read_b64_tr_b16 a[224:225], v152 offset:128
    ds_read_b64_tr_b16 a[226:227], v152 offset:384
    v_mfma_f32_16x16x32_bf16 a[4:7], a[204:207], v[60:63], a[4:7]
    ds_read_b64_tr_b16 a[228:229], v153 offset:128
    ds_read_b64_tr_b16 a[230:231], v153 offset:384
    s_waitcnt lgkmcnt(4)
    v_mfma_f32_16x16x32_bf16 a[8:11], a[208:211], v[56:59], a[8:11]
    ds_read_b64_tr_b16 a[232:233], v152 offset:160
    ds_read_b64_tr_b16 a[234:235], v152 offset:416
    v_mfma_f32_16x16x32_bf16 a[8:11], a[212:215], v[60:63], a[8:11]
    ds_read_b64_tr_b16 a[236:237], v153 offset:160
    ds_read_b64_tr_b16 a[238:239], v153 offset:416
    v_mfma_f32_16x16x32_bf16 a[12:15], a[216:219], v[56:59], a[12:15]
    ds_read_b64_tr_b16 a[240:241], v152 offset:192
    ds_read_b64_tr_b16 a[242:243], v152 offset:448
    v_mfma_f32_16x16x32_bf16 a[12:15], a[220:223], v[60:63], a[12:15]
    ds_read_b64_tr_b16 a[244:245], v153 offset:192
    ds_read_b64_tr_b16 a[246:247], v153 offset:448
    ds_read_b64_tr_b16 a[248:249], v152 offset:224
    ds_read_b64_tr_b16 a[250:251], v152 offset:480
    ds_read_b64_tr_b16 a[252:253], v153 offset:224
    ds_read_b64_tr_b16 a[254:255], v153 offset:480
    s_add_u32 s46, s46, s53
    v_lshlrev_b32 v11, 4, v0
    s_add_u32 s47, s88, 118272
    v_lshl_add_u32 v9, v0, 4, s47
    v_accvgpr_read_b32 v48, a160
    v_accvgpr_read_b32 v55, a161
    v_add_f32 v48, v48, v55
    v_rcp_f32 v148, v48
    s_waitcnt lgkmcnt(8)
    v_mfma_f32_16x16x32_bf16 a[16:19], a[224:227], v[56:59], a[16:19]
    v_accvgpr_read_b32 v16, a0
    v_accvgpr_read_b32 v17, a1
    v_accvgpr_read_b32 v18, a2
    v_mfma_f32_16x16x32_bf16 a[16:19], a[228:231], v[60:63], a[16:19]
    v_accvgpr_read_b32 v19, a3
    v_accvgpr_read_b32 v20, a4
    v_accvgpr_read_b32 v21, a5
    v_mfma_f32_16x16x32_bf16 a[20:23], a[232:235], v[56:59], a[20:23]
    v_accvgpr_read_b32 v22, a6
    v_accvgpr_read_b32 v23, a7
    v_mul_f32 v16, v148, v16
    v_mfma_f32_16x16x32_bf16 a[20:23], a[236:239], v[60:63], a[20:23]
    v_mul_f32 v17, v148, v17
    v_mul_f32 v18, v148, v18
    v_mul_f32 v19, v148, v19
    s_waitcnt lgkmcnt(0)
    v_mfma_f32_16x16x32_bf16 a[24:27], a[240:243], v[56:59], a[24:27]
    v_mul_f32 v20, v148, v20
    v_mul_f32 v21, v148, v21
    v_mfma_f32_16x16x32_bf16 a[24:27], a[244:247], v[60:63], a[24:27]
    v_mul_f32 v22, v148, v22
    v_mul_f32 v23, v148, v23
    v_mfma_f32_16x16x32_bf16 a[28:31], a[248:251], v[56:59], a[28:31]
    v_cvt_pk_bf16_f32 v16, v16, v17
    v_cvt_pk_bf16_f32 v17, v18, v19
    v_mfma_f32_16x16x32_bf16 a[28:31], a[252:255], v[60:63], a[28:31]
    v_cvt_pk_bf16_f32 v18, v20, v21
    v_cvt_pk_bf16_f32 v19, v22, v23
    buffer_store_dwordx4 v[16:19], v11, s[20:23], s46 offen sc1
    v_mfma_f32_16x16x32_bf16 a[176:179], a[180:183], v[88:91], a[176:179]
    v_exp_f32 v108, v108
    v_exp_f32 v109, v109
    v_exp_f32 v110, v110
    v_mfma_f32_16x16x32_bf16 a[128:131], a[192:195], v[88:91], a[128:131]
    v_cvt_pk_bf16_f32 v70, v108, v109
    v_exp_f32 v111, v111
    s_nop 0
    v_mfma_f32_16x16x32_bf16 a[132:135], a[200:203], v[88:91], a[132:135]
    v_cvt_pk_bf16_f32 v71, v110, v111
    v_accvgpr_read_b32 v24, a8
    v_accvgpr_read_b32 v25, a9
    v_mfma_f32_16x16x32_bf16 a[136:139], a[208:211], v[88:91], a[136:139]
    v_accvgpr_read_b32 v26, a10
    v_accvgpr_read_b32 v27, a11
    v_accvgpr_read_b32 v28, a12
    v_mfma_f32_16x16x32_bf16 a[140:143], a[216:219], v[88:91], a[140:143]
    v_accvgpr_read_b32 v29, a13
    v_accvgpr_read_b32 v30, a14
    v_accvgpr_read_b32 v31, a15
    v_mfma_f32_16x16x32_bf16 a[144:147], a[224:227], v[88:91], a[144:147]
    v_mul_f32 v24, v148, v24
    v_mul_f32 v25, v148, v25
    v_mul_f32 v26, v148, v26
    v_mfma_f32_16x16x32_bf16 a[148:151], a[232:235], v[88:91], a[148:151]
    v_mul_f32 v27, v148, v27
    v_mul_f32 v28, v148, v28
    v_mul_f32 v29, v148, v29
    v_mfma_f32_16x16x32_bf16 a[152:155], a[240:243], v[88:91], a[152:155]
    v_mul_f32 v30, v148, v30
    v_mul_f32 v31, v148, v31
    v_cvt_pk_bf16_f32 v24, v24, v25
    v_mfma_f32_16x16x32_bf16 a[156:159], a[248:251], v[88:91], a[156:159]
    v_cvt_pk_bf16_f32 v25, v26, v27
    v_cvt_pk_bf16_f32 v26, v28, v29
    v_cvt_pk_bf16_f32 v27, v30, v31
    buffer_store_dwordx4 v[24:27], v11, s[20:23], s46 offen offset:1024 sc1
    v_smfmac_f32_16x16x64_bf16 a[164:167], a[180:183], v[64:71], v255
    v_exp_f32 v115, v115
    v_exp_f32 v116, v116
    v_mfma_f32_16x16x32_bf16 a[32:35], a[192:195], v[64:67], a[32:35]
    v_cvt_pk_bf16_f32 v77, v114, v115
    v_exp_f32 v117, v117
    v_exp_f32 v118, v118
    v_mfma_f32_16x16x32_bf16 a[32:35], a[196:199], v[68:71], a[32:35]
    v_cvt_pk_bf16_f32 v78, v116, v117
    v_exp_f32 v119, v119
    s_nop 0
    v_mfma_f32_16x16x32_bf16 a[36:39], a[200:203], v[64:67], a[36:39]
    v_cvt_pk_bf16_f32 v79, v118, v119
    v_accvgpr_read_b32 v32, a16
    v_accvgpr_read_b32 v33, a17
    v_mfma_f32_16x16x32_bf16 a[36:39], a[204:207], v[68:71], a[36:39]
    v_accvgpr_read_b32 v34, a18
    v_accvgpr_read_b32 v35, a19
    v_mfma_f32_16x16x32_bf16 a[40:43], a[208:211], v[64:67], a[40:43]
    v_accvgpr_read_b32 v36, a20
    v_accvgpr_read_b32 v37, a21
    v_accvgpr_read_b32 v38, a22
    v_mfma_f32_16x16x32_bf16 a[40:43], a[212:215], v[68:71], a[40:43]
    v_accvgpr_read_b32 v39, a23
    v_mul_f32 v32, v148, v32
    v_mul_f32 v33, v148, v33
    v_mfma_f32_16x16x32_bf16 a[44:47], a[216:219], v[64:67], a[44:47]
    v_mul_f32 v34, v148, v34
    v_mul_f32 v35, v148, v35
    v_mul_f32 v36, v148, v36
    v_mfma_f32_16x16x32_bf16 a[44:47], a[220:223], v[68:71], a[44:47]
    v_mul_f32 v37, v148, v37
    v_mul_f32 v38, v148, v38
    v_mfma_f32_16x16x32_bf16 a[48:51], a[224:227], v[64:67], a[48:51]
    v_mul_f32 v39, v148, v39
    v_cvt_pk_bf16_f32 v32, v32, v33
    v_cvt_pk_bf16_f32 v33, v34, v35
    v_mfma_f32_16x16x32_bf16 a[48:51], a[228:231], v[68:71], a[48:51]
    v_cvt_pk_bf16_f32 v34, v36, v37
    v_cvt_pk_bf16_f32 v35, v38, v39
    buffer_store_dwordx4 v[32:35], v11, s[20:23], s46 offen offset:2048 sc1
    v_mfma_f32_16x16x32_bf16 a[52:55], a[232:235], v[64:67], a[52:55]
    v_exp_f32 v120, v120
    v_exp_f32 v121, v121
    v_exp_f32 v122, v122
    v_mfma_f32_16x16x32_bf16 a[52:55], a[236:239], v[68:71], a[52:55]
    v_cvt_pk_bf16_f32 v84, v120, v121
    v_exp_f32 v123, v123
    v_mfma_f32_16x16x32_bf16 a[56:59], a[240:243], v[64:67], a[56:59]
    v_exp_f32 v124, v124
    v_cvt_pk_bf16_f32 v85, v122, v123
    v_exp_f32 v125, v125
    v_mfma_f32_16x16x32_bf16 a[56:59], a[244:247], v[68:71], a[56:59]
    v_exp_f32 v126, v126
    v_cvt_pk_bf16_f32 v86, v124, v125
    v_exp_f32 v127, v127
    v_mfma_f32_16x16x32_bf16 a[60:63], a[248:251], v[64:67], a[60:63]
    s_nop 0
    ds_write_b128 v9, a[128:131] offset:0
    v_cvt_pk_bf16_f32 v87, v126, v127
    v_mfma_f32_16x16x32_bf16 a[60:63], a[252:255], v[68:71], a[60:63]
    ds_write_b128 v9, a[132:135] offset:1024
    ds_write_b128 v9, a[136:139] offset:2048
    ds_write_b128 v9, a[140:143] offset:3072
    v_smfmac_f32_16x16x64_bf16 a[168:171], a[180:183], v[72:79], v255
    v_accvgpr_read_b32 v40, a24
    v_accvgpr_read_b32 v41, a25
    v_smfmac_f32_16x16x64_bf16 a[172:175], a[180:183], v[80:87], v255
    v_accvgpr_read_b32 v42, a26
    v_accvgpr_read_b32 v43, a27
    v_accvgpr_read_b32 v44, a28
    v_mfma_f32_16x16x32_bf16 a[64:67], a[192:195], v[72:75], a[64:67]
    v_accvgpr_read_b32 v45, a29
    v_accvgpr_read_b32 v46, a30
    v_accvgpr_read_b32 v47, a31
    v_mfma_f32_16x16x32_bf16 a[64:67], a[196:199], v[76:79], a[64:67]
    v_mul_f32 v40, v148, v40
    v_mul_f32 v41, v148, v41
    v_mul_f32 v42, v148, v42
    v_mfma_f32_16x16x32_bf16 a[68:71], a[200:203], v[72:75], a[68:71]
    v_mul_f32 v43, v148, v43
    v_mul_f32 v44, v148, v44
    v_mul_f32 v45, v148, v45
    v_mfma_f32_16x16x32_bf16 a[68:71], a[204:207], v[76:79], a[68:71]
    v_mul_f32 v46, v148, v46
    v_mul_f32 v47, v148, v47
    v_cvt_pk_bf16_f32 v40, v40, v41
    v_mfma_f32_16x16x32_bf16 a[72:75], a[208:211], v[72:75], a[72:75]
    v_cvt_pk_bf16_f32 v41, v42, v43
    v_cvt_pk_bf16_f32 v42, v44, v45
    v_mfma_f32_16x16x32_bf16 a[72:75], a[212:215], v[76:79], a[72:75]
    v_cvt_pk_bf16_f32 v43, v46, v47
    buffer_store_dwordx4 v[40:43], v11, s[20:23], s46 offen offset:3072 sc1
    ds_write_b128 v9, a[144:147] offset:16896
    v_mfma_f32_16x16x32_bf16 a[76:79], a[216:219], v[72:75], a[76:79]
    ds_write_b128 v9, a[148:151] offset:17920
    ds_write_b128 v9, a[152:155] offset:18944
    ds_write_b128 v9, a[156:159] offset:19968
    v_mfma_f32_16x16x32_bf16 a[76:79], a[220:223], v[76:79], a[76:79]
    v_accvgpr_read_b32 v49, a164
    v_accvgpr_read_b32 v55, a165
    v_add_f32 v49, v49, v55
    v_mfma_f32_16x16x32_bf16 a[80:83], a[224:227], v[72:75], a[80:83]
    s_add_u32 s46, s46, 140032
    v_rcp_f32 v150, v49
    v_accvgpr_read_b32 v16, a32
    v_mfma_f32_16x16x32_bf16 a[80:83], a[228:231], v[76:79], a[80:83]
    v_accvgpr_read_b32 v17, a33
    v_accvgpr_read_b32 v18, a34
    v_accvgpr_read_b32 v19, a35
    v_mfma_f32_16x16x32_bf16 a[84:87], a[232:235], v[72:75], a[84:87]
    v_accvgpr_read_b32 v20, a36
    v_accvgpr_read_b32 v21, a37
    v_mfma_f32_16x16x32_bf16 a[84:87], a[236:239], v[76:79], a[84:87]
    v_accvgpr_read_b32 v22, a38
    v_accvgpr_read_b32 v23, a39
    v_mul_f32 v16, v150, v16
    v_mfma_f32_16x16x32_bf16 a[88:91], a[240:243], v[72:75], a[88:91]
    v_mul_f32 v17, v150, v17
    v_mul_f32 v18, v150, v18
    v_mul_f32 v19, v150, v19
    v_mfma_f32_16x16x32_bf16 a[88:91], a[244:247], v[76:79], a[88:91]
    v_mul_f32 v20, v150, v20
    v_mul_f32 v21, v150, v21
    v_mul_f32 v22, v150, v22
    v_mfma_f32_16x16x32_bf16 a[92:95], a[248:251], v[72:75], a[92:95]
    v_mul_f32 v23, v150, v23
    v_cvt_pk_bf16_f32 v16, v16, v17
    v_cvt_pk_bf16_f32 v17, v18, v19
    v_mfma_f32_16x16x32_bf16 a[92:95], a[252:255], v[76:79], a[92:95]
    v_cvt_pk_bf16_f32 v18, v20, v21
    v_cvt_pk_bf16_f32 v19, v22, v23
    buffer_store_dwordx4 v[16:19], v11, s[20:23], s46 offen sc1
    v_mfma_f32_16x16x32_bf16 a[96:99], a[192:195], v[80:83], a[96:99]
    v_accvgpr_read_b32 v50, a168
    v_accvgpr_read_b32 v55, a169
    v_mfma_f32_16x16x32_bf16 a[96:99], a[196:199], v[84:87], a[96:99]
    v_add_f32 v50, v50, v55
    v_accvgpr_read_b32 v51, a172
    v_accvgpr_read_b32 v55, a173
    v_mfma_f32_16x16x32_bf16 a[100:103], a[200:203], v[80:83], a[100:103]
    s_lshl_b32 s47, s24, 10
    v_add_f32 v51, v51, v55
    v_accvgpr_read_b32 v52, a176
    v_mfma_f32_16x16x32_bf16 a[100:103], a[204:207], v[84:87], a[100:103]
    s_add_u32 s47, s47, 152064
    v_lshl_add_u32 v10, v0, 4, s47
    v_add_f32 v53, v48, v49
    v_mfma_f32_16x16x32_bf16 a[104:107], a[208:211], v[80:83], a[104:107]
    v_add_f32 v54, v50, v51
    v_add_f32 v53, v53, v52
    v_mfma_f32_16x16x32_bf16 a[104:107], a[212:215], v[84:87], a[104:107]
    v_add_f32 v53, v53, v54
    v_mov_b32 v54, 0x4f800000
    v_cmp_nlt_f32 vcc, v53, v54
    v_mfma_f32_16x16x32_bf16 a[108:111], a[216:219], v[80:83], a[108:111]
    v_mov_b32 v156, v52
    v_mov_b32 v157, v144
    v_mov_b32 v159, 0
    v_mfma_f32_16x16x32_bf16 a[108:111], a[220:223], v[84:87], a[108:111]
    v_cndmask_b32 v158, 0, 1, vcc
    ds_write_b128 v10, v[156:159]
    v_rcp_f32 v152, v50
    v_mfma_f32_16x16x32_bf16 a[112:115], a[224:227], v[80:83], a[112:115]
    v_rcp_f32 v154, v51
    v_accvgpr_read_b32 v24, a40
    v_mfma_f32_16x16x32_bf16 a[112:115], a[228:231], v[84:87], a[112:115]
    v_accvgpr_read_b32 v25, a41
    v_accvgpr_read_b32 v26, a42
    v_accvgpr_read_b32 v27, a43
    v_mfma_f32_16x16x32_bf16 a[116:119], a[232:235], v[80:83], a[116:119]
    v_accvgpr_read_b32 v28, a44
    v_accvgpr_read_b32 v29, a45
    v_accvgpr_read_b32 v30, a46
    v_mfma_f32_16x16x32_bf16 a[116:119], a[236:239], v[84:87], a[116:119]
    v_accvgpr_read_b32 v31, a47
    v_mul_f32 v24, v150, v24
    v_mul_f32 v25, v150, v25
    v_mfma_f32_16x16x32_bf16 a[120:123], a[240:243], v[80:83], a[120:123]
    v_mul_f32 v26, v150, v26
    v_mul_f32 v27, v150, v27
    v_mfma_f32_16x16x32_bf16 a[120:123], a[244:247], v[84:87], a[120:123]
    v_mul_f32 v28, v150, v28
    v_mul_f32 v29, v150, v29
    v_mul_f32 v30, v150, v30
    v_mfma_f32_16x16x32_bf16 a[124:127], a[248:251], v[80:83], a[124:127]
    v_mul_f32 v31, v150, v31
    v_cvt_pk_bf16_f32 v24, v24, v25
    v_cvt_pk_bf16_f32 v25, v26, v27
    v_mfma_f32_16x16x32_bf16 a[124:127], a[252:255], v[84:87], a[124:127]
    v_cvt_pk_bf16_f32 v26, v28, v29
    v_cvt_pk_bf16_f32 v27, v30, v31
    buffer_store_dwordx4 v[24:27], v11, s[20:23], s46 offen offset:1024 sc1
    s_waitcnt lgkmcnt(0)
    s_barrier
    s_and_b32 s47, s24, 2
    s_mul_i32 s47, s47, 4224
    s_mul_i32 s57, s25, 16896
    s_add_u32 s47, s47, s57
    s_add_u32 s47, s47, 118272
    v_lshl_add_u32 v9, v0, 4, s47
    s_and_b32 s47, s24, 2
    s_lshl_b32 s47, s47, 10
    v_lshl_add_u32 v10, v0, 4, s47
    v_xor_b32 v1, 2048, v10
    v_add_u32 v10, 152064, v10
    v_add_u32 v1, 152064, v1
    ds_read_b128 v[128:131], v10
    ds_read_b128 v[132:135], v10 offset:1024
    ds_read_b128 v[136:139], v1
    ds_read_b128 v[140:143], v1 offset:1024
    ds_read_b128 v[96:99], v9 offset:0
    ds_read_b128 v[100:103], v9 offset:1024
    ds_read_b128 v[104:107], v9 offset:2048
    ds_read_b128 v[108:111], v9 offset:3072
    ds_read_b128 v[112:115], v9 offset:4224
    ds_read_b128 v[116:119], v9 offset:5248
    ds_read_b128 v[120:123], v9 offset:6272
    ds_read_b128 v[124:127], v9 offset:7296
    v_accvgpr_read_b32 v32, a48
    v_accvgpr_read_b32 v33, a49
    v_accvgpr_read_b32 v34, a50
    v_accvgpr_read_b32 v35, a51
    v_accvgpr_read_b32 v36, a52
    v_accvgpr_read_b32 v37, a53
    v_accvgpr_read_b32 v38, a54
    v_accvgpr_read_b32 v39, a55
    v_pk_mul_f32 v[32:33], v[32:33], v[150:151] op_sel_hi:[1,0]
    v_pk_mul_f32 v[34:35], v[34:35], v[150:151] op_sel_hi:[1,0]
    v_pk_mul_f32 v[36:37], v[36:37], v[150:151] op_sel_hi:[1,0]
    v_pk_mul_f32 v[38:39], v[38:39], v[150:151] op_sel_hi:[1,0]
    v_cvt_pk_bf16_f32 v32, v32, v33
    v_cvt_pk_bf16_f32 v33, v34, v35
    v_cvt_pk_bf16_f32 v34, v36, v37
    v_cvt_pk_bf16_f32 v35, v38, v39
    buffer_store_dwordx4 v[32:35], v11, s[20:23], s46 offen offset:2048 sc1
    v_accvgpr_read_b32 v40, a56
    v_accvgpr_read_b32 v41, a57
    v_accvgpr_read_b32 v42, a58
    v_accvgpr_read_b32 v43, a59
    v_accvgpr_read_b32 v44, a60
    v_accvgpr_read_b32 v45, a61
    v_accvgpr_read_b32 v46, a62
    v_accvgpr_read_b32 v47, a63
    v_pk_mul_f32 v[40:41], v[40:41], v[150:151] op_sel_hi:[1,0]
    v_pk_mul_f32 v[42:43], v[42:43], v[150:151] op_sel_hi:[1,0]
    v_pk_mul_f32 v[44:45], v[44:45], v[150:151] op_sel_hi:[1,0]
    v_pk_mul_f32 v[46:47], v[46:47], v[150:151] op_sel_hi:[1,0]
    v_cvt_pk_bf16_f32 v40, v40, v41
    v_cvt_pk_bf16_f32 v41, v42, v43
    v_cvt_pk_bf16_f32 v42, v44, v45
    v_cvt_pk_bf16_f32 v43, v46, v47
    buffer_store_dwordx4 v[40:43], v11, s[20:23], s46 offen offset:3072 sc1
    s_waitcnt lgkmcnt(0)
    v_or3_b32 v144, v130, v134, v138
    v_or_b32 v144, v144, v142
    v_cmp_ne_u32 vcc, 0, v144
    v_min_f32 v145, v129, v133
    v_sub_f32 v129, v145, v129
    v_sub_f32 v133, v145, v133
    v_exp_f32 v129, v129
    v_exp_f32 v133, v133
    s_cmp_lg_u64 vcc, 0
    s_cselect_b32 s47, 1, 0
    s_cmp_gt_u32 s47, s59
    s_cbranch_scc1 L1_redo
    v_mul_f32 v145, v128, v129
    v_fmac_f32 v145, v132, v133
    v_rcp_f32 v145, v145
    s_lshr_b32 s47, s24, 1
    s_add_u32 s47, s47, s58
    s_add_u32 s47, s47, 16
    s_mul_i32 s47, s47, 140032
    s_add_u32 s47, s47, s53
    s_lshl_b32 s57, s25, 11
    s_add_u32 s47, s47, s57
    v_mul_f32 v129, v145, v129
    v_mul_f32 v133, v145, v133
    v_mul_f32 v96, v129, v96
    v_mul_f32 v97, v129, v97
    v_mul_f32 v98, v129, v98
    v_mul_f32 v99, v129, v99
    v_mul_f32 v100, v129, v100
    v_mul_f32 v101, v129, v101
    v_mul_f32 v102, v129, v102
    v_mul_f32 v103, v129, v103
    v_mul_f32 v104, v129, v104
    v_mul_f32 v105, v129, v105
    v_mul_f32 v106, v129, v106
    v_mul_f32 v107, v129, v107
    v_mul_f32 v108, v129, v108
    v_mul_f32 v109, v129, v109
    v_mul_f32 v110, v129, v110
    v_mul_f32 v111, v129, v111
    v_fmac_f32 v96, v133, v112
    v_fmac_f32 v97, v133, v113
    v_fmac_f32 v98, v133, v114
    v_fmac_f32 v99, v133, v115
    v_fmac_f32 v100, v133, v116
    v_fmac_f32 v101, v133, v117
    v_fmac_f32 v102, v133, v118
    v_fmac_f32 v103, v133, v119
    v_fmac_f32 v104, v133, v120
    v_fmac_f32 v105, v133, v121
    v_fmac_f32 v106, v133, v122
    v_fmac_f32 v107, v133, v123
    v_fmac_f32 v108, v133, v124
    v_fmac_f32 v109, v133, v125
    v_fmac_f32 v110, v133, v126
    v_fmac_f32 v111, v133, v127
    v_cvt_pk_bf16_f32 v80, v96, v97
    v_cvt_pk_bf16_f32 v81, v98, v99
    v_cvt_pk_bf16_f32 v82, v100, v101
    v_cvt_pk_bf16_f32 v83, v102, v103
    v_cvt_pk_bf16_f32 v84, v104, v105
    v_cvt_pk_bf16_f32 v85, v106, v107
    v_cvt_pk_bf16_f32 v86, v108, v109
    v_cvt_pk_bf16_f32 v87, v110, v111
    buffer_store_dwordx4 v[80:83], v11, s[20:23], s47 offen sc1
    buffer_store_dwordx4 v[84:87], v11, s[20:23], s47 offen offset:1024 sc1
    v_bfe_u32 v253, v0, 2, 3
    v_lshlrev_b32 v224, 7, v253
    v_bfe_u32 v253, v0, 3, 2
    v_xor_b32 v253, s24, v253
    v_lshl_add_u32 v224, v253, 5, v224
    v_lshl_add_u32 v224, v15, 3, v224
    v_lshrrev_b32 v253, 5, v0
    v_mul_u32_u24 v253, 1056, v253
    v_add_u32 v253, s88, v253
    v_xor_b32 v225, 32, v224
    v_xor_b32 v226, 64, v224
    v_xor_b32 v227, 96, v224
    v_add_u32 v224, v253, v224
    v_add_u32 v225, v253, v225
    v_add_u32 v226, v253, v226
    v_add_u32 v227, v253, v227
    v_add_u32 v228, 50688, v224
    v_add_u32 v229, 50688, v225
    v_add_u32 v230, 50688, v226
    v_add_u32 v231, 50688, v227
    v_add_u32 v232, 101376, v224
    v_add_u32 v233, 101376, v225
    v_add_u32 v234, 101376, v226
    v_add_u32 v235, 101376, v227
    s_waitcnt vmcnt(10)
    ds_read_b64_tr_b16 v[160:161], v224 offset:16896
    ds_read_b64_tr_b16 v[162:163], v224 offset:19008
    ds_read_b64_tr_b16 v[164:165], v225 offset:16896
    ds_read_b64_tr_b16 v[166:167], v225 offset:19008
    s_add_u32 s46, s46, 140032
    v_accvgpr_read_b32 v48, a64
    v_accvgpr_read_b32 v49, a65
    v_accvgpr_read_b32 v50, a66
    v_accvgpr_read_b32 v51, a67
    v_accvgpr_read_b32 v52, a68
    v_accvgpr_read_b32 v53, a69
    v_accvgpr_read_b32 v54, a70
    v_accvgpr_read_b32 v55, a71
    v_pk_mul_f32 v[48:49], v[48:49], v[152:153] op_sel_hi:[1,0]
    v_pk_mul_f32 v[50:51], v[50:51], v[152:153] op_sel_hi:[1,0]
    v_pk_mul_f32 v[52:53], v[52:53], v[152:153] op_sel_hi:[1,0]
    v_pk_mul_f32 v[54:55], v[54:55], v[152:153] op_sel_hi:[1,0]
    v_cvt_pk_bf16_f32 v48, v48, v49
    v_cvt_pk_bf16_f32 v49, v50, v51
    v_cvt_pk_bf16_f32 v50, v52, v53
    v_cvt_pk_bf16_f32 v51, v54, v55
    ds_read_b64_tr_b16 v[168:169], v226 offset:16896
    ds_read_b64_tr_b16 v[170:171], v226 offset:19008
    ds_read_b64_tr_b16 v[172:173], v227 offset:16896
    ds_read_b64_tr_b16 v[174:175], v227 offset:19008
    buffer_store_dwordx4 v[48:51], v11, s[20:23], s46 offen sc1
    v_accvgpr_read_b32 v56, a72
    v_accvgpr_read_b32 v57, a73
    v_accvgpr_read_b32 v58, a74
    v_accvgpr_read_b32 v59, a75
    v_accvgpr_read_b32 v60, a76
    v_accvgpr_read_b32 v61, a77
    v_accvgpr_read_b32 v62, a78
    v_accvgpr_read_b32 v63, a79
    v_pk_mul_f32 v[56:57], v[56:57], v[152:153] op_sel_hi:[1,0]
    v_pk_mul_f32 v[58:59], v[58:59], v[152:153] op_sel_hi:[1,0]
    v_pk_mul_f32 v[60:61], v[60:61], v[152:153] op_sel_hi:[1,0]
    v_pk_mul_f32 v[62:63], v[62:63], v[152:153] op_sel_hi:[1,0]
    v_cvt_pk_bf16_f32 v56, v56, v57
    v_cvt_pk_bf16_f32 v57, v58, v59
    v_cvt_pk_bf16_f32 v58, v60, v61
    v_cvt_pk_bf16_f32 v59, v62, v63
    ds_read_b64_tr_b16 v[176:177], v224 offset:33792
    ds_read_b64_tr_b16 v[178:179], v224 offset:35904
    ds_read_b64_tr_b16 v[180:181], v225 offset:33792
    ds_read_b64_tr_b16 v[182:183], v225 offset:35904
    buffer_store_dwordx4 v[56:59], v11, s[20:23], s46 offen offset:1024 sc1
    v_accvgpr_read_b32 v64, a80
    v_accvgpr_read_b32 v65, a81
    v_accvgpr_read_b32 v66, a82
    v_accvgpr_read_b32 v67, a83
    v_accvgpr_read_b32 v68, a84
    v_accvgpr_read_b32 v69, a85
    v_accvgpr_read_b32 v70, a86
    v_accvgpr_read_b32 v71, a87
    v_pk_mul_f32 v[64:65], v[64:65], v[152:153] op_sel_hi:[1,0]
    v_pk_mul_f32 v[66:67], v[66:67], v[152:153] op_sel_hi:[1,0]
    v_pk_mul_f32 v[68:69], v[68:69], v[152:153] op_sel_hi:[1,0]
    v_pk_mul_f32 v[70:71], v[70:71], v[152:153] op_sel_hi:[1,0]
    v_cvt_pk_bf16_f32 v64, v64, v65
    v_cvt_pk_bf16_f32 v65, v66, v67
    v_cvt_pk_bf16_f32 v66, v68, v69
    v_cvt_pk_bf16_f32 v67, v70, v71
    buffer_store_dwordx4 v[64:67], v11, s[20:23], s46 offen offset:2048 sc1
    ds_read_b64_tr_b16 v[184:185], v226 offset:33792
    ds_read_b64_tr_b16 v[186:187], v226 offset:35904
    ds_read_b64_tr_b16 v[188:189], v227 offset:33792
    ds_read_b64_tr_b16 v[190:191], v227 offset:35904
    v_accvgpr_read_b32 v72, a88
    v_accvgpr_read_b32 v73, a89
    v_accvgpr_read_b32 v74, a90
    v_accvgpr_read_b32 v75, a91
    v_accvgpr_read_b32 v76, a92
    v_accvgpr_read_b32 v77, a93
    v_accvgpr_read_b32 v78, a94
    v_accvgpr_read_b32 v79, a95
    v_pk_mul_f32 v[72:73], v[72:73], v[152:153] op_sel_hi:[1,0]
    v_pk_mul_f32 v[74:75], v[74:75], v[152:153] op_sel_hi:[1,0]
    v_pk_mul_f32 v[76:77], v[76:77], v[152:153] op_sel_hi:[1,0]
    v_pk_mul_f32 v[78:79], v[78:79], v[152:153] op_sel_hi:[1,0]
    v_cvt_pk_bf16_f32 v72, v72, v73
    v_cvt_pk_bf16_f32 v73, v74, v75
    v_cvt_pk_bf16_f32 v74, v76, v77
    v_cvt_pk_bf16_f32 v75, v78, v79
    buffer_store_dwordx4 v[72:75], v11, s[20:23], s46 offen offset:3072 sc1
    ds_read_b64_tr_b16 v[192:193], v228 offset:0
    ds_read_b64_tr_b16 v[194:195], v228 offset:2112
    ds_read_b64_tr_b16 v[196:197], v229 offset:0
    ds_read_b64_tr_b16 v[198:199], v229 offset:2112
    s_add_u32 s46, s46, 140032
    v_accvgpr_read_b32 v16, a96
    v_accvgpr_read_b32 v17, a97
    v_accvgpr_read_b32 v18, a98
    v_accvgpr_read_b32 v19, a99
    v_accvgpr_read_b32 v20, a100
    v_accvgpr_read_b32 v21, a101
    v_accvgpr_read_b32 v22, a102
    v_accvgpr_read_b32 v23, a103
    v_pk_mul_f32 v[16:17], v[16:17], v[154:155] op_sel_hi:[1,0]
    v_pk_mul_f32 v[18:19], v[18:19], v[154:155] op_sel_hi:[1,0]
    v_pk_mul_f32 v[20:21], v[20:21], v[154:155] op_sel_hi:[1,0]
    v_pk_mul_f32 v[22:23], v[22:23], v[154:155] op_sel_hi:[1,0]
    v_cvt_pk_bf16_f32 v16, v16, v17
    v_cvt_pk_bf16_f32 v17, v18, v19
    v_cvt_pk_bf16_f32 v18, v20, v21
    v_cvt_pk_bf16_f32 v19, v22, v23
    ds_read_b64_tr_b16 v[200:201], v230 offset:0
    ds_read_b64_tr_b16 v[202:203], v230 offset:2112
    ds_read_b64_tr_b16 v[204:205], v231 offset:0
    ds_read_b64_tr_b16 v[206:207], v231 offset:2112
    buffer_store_dwordx4 v[16:19], v11, s[20:23], s46 offen sc1
    v_accvgpr_read_b32 v24, a104
    v_accvgpr_read_b32 v25, a105
    v_accvgpr_read_b32 v26, a106
    v_accvgpr_read_b32 v27, a107
    v_accvgpr_read_b32 v28, a108
    v_accvgpr_read_b32 v29, a109
    v_accvgpr_read_b32 v30, a110
    v_accvgpr_read_b32 v31, a111
    v_pk_mul_f32 v[24:25], v[24:25], v[154:155] op_sel_hi:[1,0]
    v_pk_mul_f32 v[26:27], v[26:27], v[154:155] op_sel_hi:[1,0]
    v_pk_mul_f32 v[28:29], v[28:29], v[154:155] op_sel_hi:[1,0]
    v_pk_mul_f32 v[30:31], v[30:31], v[154:155] op_sel_hi:[1,0]
    v_cvt_pk_bf16_f32 v24, v24, v25
    v_cvt_pk_bf16_f32 v25, v26, v27
    v_cvt_pk_bf16_f32 v26, v28, v29
    v_cvt_pk_bf16_f32 v27, v30, v31
    buffer_store_dwordx4 v[24:27], v11, s[20:23], s46 offen offset:1024 sc1
    ds_read_b64_tr_b16 v[208:209], v228 offset:16896
    ds_read_b64_tr_b16 v[210:211], v228 offset:19008
    ds_read_b64_tr_b16 v[212:213], v229 offset:16896
    ds_read_b64_tr_b16 v[214:215], v229 offset:19008
    v_accvgpr_read_b32 v32, a112
    v_accvgpr_read_b32 v33, a113
    v_accvgpr_read_b32 v34, a114
    v_accvgpr_read_b32 v35, a115
    v_accvgpr_read_b32 v36, a116
    v_accvgpr_read_b32 v37, a117
    v_accvgpr_read_b32 v38, a118
    v_accvgpr_read_b32 v39, a119
    v_pk_mul_f32 v[32:33], v[32:33], v[154:155] op_sel_hi:[1,0]
    v_pk_mul_f32 v[34:35], v[34:35], v[154:155] op_sel_hi:[1,0]
    v_pk_mul_f32 v[36:37], v[36:37], v[154:155] op_sel_hi:[1,0]
    v_pk_mul_f32 v[38:39], v[38:39], v[154:155] op_sel_hi:[1,0]
    v_cvt_pk_bf16_f32 v32, v32, v33
    v_cvt_pk_bf16_f32 v33, v34, v35
    v_cvt_pk_bf16_f32 v34, v36, v37
    v_cvt_pk_bf16_f32 v35, v38, v39
    buffer_store_dwordx4 v[32:35], v11, s[20:23], s46 offen offset:2048 sc1
    ds_read_b64_tr_b16 v[216:217], v230 offset:16896
    ds_read_b64_tr_b16 v[218:219], v230 offset:19008
    ds_read_b64_tr_b16 v[220:221], v231 offset:16896
    ds_read_b64_tr_b16 v[222:223], v231 offset:19008
    v_accvgpr_read_b32 v40, a120
    v_accvgpr_read_b32 v41, a121
    v_accvgpr_read_b32 v42, a122
    v_accvgpr_read_b32 v43, a123
    v_accvgpr_read_b32 v44, a124
    v_accvgpr_read_b32 v45, a125
    v_accvgpr_read_b32 v46, a126
    v_accvgpr_read_b32 v47, a127
    v_pk_mul_f32 v[40:41], v[40:41], v[154:155] op_sel_hi:[1,0]
    v_pk_mul_f32 v[42:43], v[42:43], v[154:155] op_sel_hi:[1,0]
    v_pk_mul_f32 v[44:45], v[44:45], v[154:155] op_sel_hi:[1,0]
    v_pk_mul_f32 v[46:47], v[46:47], v[154:155] op_sel_hi:[1,0]
    v_cvt_pk_bf16_f32 v40, v40, v41
    v_cvt_pk_bf16_f32 v41, v42, v43
    v_cvt_pk_bf16_f32 v42, v44, v45
    v_cvt_pk_bf16_f32 v43, v46, v47
    buffer_store_dwordx4 v[40:43], v11, s[20:23], s46 offen offset:3072 sc1
    buffer_load_dword v5, v4, s[8:11], s100 offen sc1
    s_mul_i32 s32, s42, 840192
    s_mul_i32 s55, s24, 33920
    s_add_u32 s32, s32, s55
    s_add_u32 s33, s32, 140032
    s_add_u32 s34, s32, 280064
    s_add_u32 s35, s32, 420096
    s_add_u32 s36, s32, 560128
    s_add_u32 s37, s32, 700160
    v_mov_b32 v253, 1
    s_mov_b32 s49, 4194304
    s_waitcnt vmcnt(0) lgkmcnt(0)
    s_barrier
    v_readfirstlane_b32 s39, v5
    s_cmp_ge_u32 s2, 216
    s_cselect_b32 s39, 0, s39
    s_cmp_ge_u32 s39, 8
    s_cbranch_scc1 L3_fast
    s_cmp_lg_u32 s24, 0
    s_cbranch_scc1 L3_na1
    s_mov_b64 exec, 1
    buffer_atomic_add v253, v4, s[8:11], s89 offen sc1
    s_mov_b64 exec, -1
L3_na1:
    s_cmp_ge_u32 s2, 216
    s_cbranch_scc1 L3_done
    s_add_u32 s55, s45, 147456
    s_add_u32 m0, s88, 16896
    s_nop 0
    buffer_load_dwordx4 v246, s[84:87], s55 offen lds
    s_add_u32 m0, s88, 17952
    s_nop 0
    buffer_load_dwordx4 v247, s[84:87], s55 offen lds
    s_add_u32 m0, s88, 19008
    s_nop 0
    buffer_load_dwordx4 v248, s[84:87], s55 offen lds
    s_add_u32 m0, s88, 20064
    s_nop 0
    buffer_load_dwordx4 v249, s[84:87], s55 offen lds
    s_add_u32 s55, s45, 184320
    s_add_u32 m0, s88, 33792
    s_nop 0
    buffer_load_dwordx4 v246, s[84:87], s55 offen lds
    s_add_u32 m0, s88, 34848
    s_nop 0
    buffer_load_dwordx4 v247, s[84:87], s55 offen lds
    s_add_u32 m0, s88, 35904
    s_nop 0
    buffer_load_dwordx4 v248, s[84:87], s55 offen lds
    s_add_u32 m0, s88, 36960
    s_nop 0
    buffer_load_dwordx4 v249, s[84:87], s55 offen lds
    s_add_u32 s55, s45, 221184
    s_add_u32 m0, s88, 50688
    s_nop 0
    buffer_load_dwordx4 v246, s[84:87], s55 offen lds
    s_add_u32 m0, s88, 51744
    s_nop 0
    buffer_load_dwordx4 v247, s[84:87], s55 offen lds
    s_add_u32 m0, s88, 52800
    s_nop 0
    buffer_load_dwordx4 v248, s[84:87], s55 offen lds
    s_add_u32 m0, s88, 53856
    s_nop 0
    buffer_load_dwordx4 v249, s[84:87], s55 offen lds
    s_add_u32 s55, s45, 258048
    s_add_u32 m0, s88, 67584
    s_nop 0
    buffer_load_dwordx4 v246, s[84:87], s55 offen lds
    s_add_u32 m0, s88, 68640
    s_nop 0
    buffer_load_dwordx4 v247, s[84:87], s55 offen lds
    s_add_u32 m0, s88, 69696
    s_nop 0
    buffer_load_dwordx4 v248, s[84:87], s55 offen lds
    s_add_u32 m0, s88, 70752
    s_nop 0
    buffer_load_dwordx4 v249, s[84:87], s55 offen lds
    s_add_u32 s55, s45, 294912
    s_add_u32 m0, s88, 84480
    s_nop 0
    buffer_load_dwordx4 v246, s[84:87], s55 offen lds
    s_add_u32 m0, s88, 85536
    s_nop 0
    buffer_load_dwordx4 v247, s[84:87], s55 offen lds
    s_add_u32 m0, s88, 86592
    s_nop 0
    buffer_load_dwordx4 v248, s[84:87], s55 offen lds
    s_add_u32 m0, s88, 87648
    s_nop 0
    buffer_load_dwordx4 v249, s[84:87], s55 offen lds
    s_add_u32 s55, s45, 331776
    s_add_u32 m0, s88, 101376
    s_nop 0
    buffer_load_dwordx4 v246, s[84:87], s55 offen lds
    s_add_u32 m0, s88, 102432
    s_nop 0
    buffer_load_dwordx4 v247, s[84:87], s55 offen lds
    s_add_u32 m0, s88, 103488
    s_nop 0
    buffer_load_dwordx4 v248, s[84:87], s55 offen lds
    s_add_u32 m0, s88, 104544
    s_nop 0
    buffer_load_dwordx4 v249, s[84:87], s55 offen lds
    s_add_u32 s55, s45, 368640
    s_add_u32 m0, s88, 0
    s_nop 0
    buffer_load_dwordx4 v246, s[84:87], s55 offen lds
    s_add_u32 m0, s88, 1056
    s_nop 0
    buffer_load_dwordx4 v247, s[84:87], s55 offen lds
    s_add_u32 m0, s88, 2112
    s_nop 0
    buffer_load_dwordx4 v248, s[84:87], s55 offen lds
    s_add_u32 m0, s88, 3168
    s_nop 0
    buffer_load_dwordx4 v249, s[84:87], s55 offen lds
    s_add_u32 s55, s45, 405504
    s_add_u32 m0, s88, 118272
    s_nop 0
    buffer_load_dwordx4 v246, s[84:87], s55 offen lds
    s_add_u32 m0, s88, 119328
    s_nop 0
    buffer_load_dwordx4 v247, s[84:87], s55 offen lds
    s_add_u32 m0, s88, 120384
    s_nop 0
    buffer_load_dwordx4 v248, s[84:87], s55 offen lds
    s_add_u32 m0, s88, 121440
    s_nop 0
    buffer_load_dwordx4 v249, s[84:87], s55 offen lds
    s_add_u32 s55, s45, 442368
    s_add_u32 m0, s88, 135168
    s_nop 0
    buffer_load_dwordx4 v246, s[84:87], s55 offen lds
    s_add_u32 m0, s88, 136224
    s_nop 0
    buffer_load_dwordx4 v247, s[84:87], s55 offen lds
    s_add_u32 m0, s88, 137280
    s_nop 0
    buffer_load_dwordx4 v248, s[84:87], s55 offen lds
    s_add_u32 m0, s88, 138336
    s_nop 0
    buffer_load_dwordx4 v249, s[84:87], s55 offen lds
L3_poll:
    buffer_load_dword v254, v4, s[8:11], s100 offen sc1
    s_waitcnt vmcnt(0)
    v_readfirstlane_b32 s55, v254
    s_sub_u32 s49, s49, 1
    s_cbranch_scc1 L3_rdy
    s_cmp_ge_u32 s55, 8
    s_cbranch_scc1 L3_rdy
    s_sleep 4
    s_branch L3_poll
L3_rdy:
    buffer_load_dwordx4 a[0:3], v11, s[20:23], s32 offen sc1
    buffer_load_dwordx4 a[4:7], v11, s[20:23], s33 offen sc1
    buffer_load_dwordx4 a[8:11], v11, s[20:23], s34 offen sc1
    buffer_load_dwordx4 a[12:15], v11, s[20:23], s35 offen sc1
    buffer_load_dwordx4 a[16:19], v11, s[20:23], s36 offen sc1
    buffer_load_dwordx4 a[20:23], v11, s[20:23], s37 offen sc1
    buffer_load_dwordx4 a[24:27], v11, s[20:23], s32 offen offset:1024 sc1
    buffer_load_dwordx4 a[28:31], v11, s[20:23], s33 offen offset:1024 sc1
    buffer_load_dwordx4 a[32:35], v11, s[20:23], s34 offen offset:1024 sc1
    buffer_load_dwordx4 a[36:39], v11, s[20:23], s35 offen offset:1024 sc1
    buffer_load_dwordx4 a[40:43], v11, s[20:23], s36 offen offset:1024 sc1
    buffer_load_dwordx4 a[44:47], v11, s[20:23], s37 offen offset:1024 sc1
    buffer_load_dwordx4 a[48:51], v11, s[20:23], s32 offen offset:2048 sc1
    buffer_load_dwordx4 a[52:55], v11, s[20:23], s33 offen offset:2048 sc1
    buffer_load_dwordx4 a[56:59], v11, s[20:23], s34 offen offset:2048 sc1
    buffer_load_dwordx4 a[60:63], v11, s[20:23], s35 offen offset:2048 sc1
    buffer_load_dwordx4 a[128:131], v11, s[20:23], s36 offen offset:2048 sc1
    buffer_load_dwordx4 a[132:135], v11, s[20:23], s37 offen offset:2048 sc1
    buffer_load_dwordx4 a[136:139], v11, s[20:23], s32 offen offset:3072 sc1
    buffer_load_dwordx4 a[140:143], v11, s[20:23], s33 offen offset:3072 sc1
    buffer_load_dwordx4 a[144:147], v11, s[20:23], s34 offen offset:3072 sc1
    buffer_load_dwordx4 a[148:151], v11, s[20:23], s35 offen offset:3072 sc1
    buffer_load_dwordx4 a[152:155], v11, s[20:23], s36 offen offset:3072 sc1
    buffer_load_dwordx4 a[156:159], v11, s[20:23], s37 offen offset:3072 sc1
    s_branch L3_go
L3_fast:
    buffer_load_dwordx4 a[0:3], v11, s[20:23], s32 offen sc1
    buffer_load_dwordx4 a[4:7], v11, s[20:23], s33 offen sc1
    buffer_load_dwordx4 a[8:11], v11, s[20:23], s34 offen sc1
    buffer_load_dwordx4 a[12:15], v11, s[20:23], s35 offen sc1
    buffer_load_dwordx4 a[16:19], v11, s[20:23], s36 offen sc1
    buffer_load_dwordx4 a[20:23], v11, s[20:23], s37 offen sc1
    buffer_load_dwordx4 a[24:27], v11, s[20:23], s32 offen offset:1024 sc1
    buffer_load_dwordx4 a[28:31], v11, s[20:23], s33 offen offset:1024 sc1
    buffer_load_dwordx4 a[32:35], v11, s[20:23], s34 offen offset:1024 sc1
    buffer_load_dwordx4 a[36:39], v11, s[20:23], s35 offen offset:1024 sc1
    buffer_load_dwordx4 a[40:43], v11, s[20:23], s36 offen offset:1024 sc1
    buffer_load_dwordx4 a[44:47], v11, s[20:23], s37 offen offset:1024 sc1
    s_cmp_lg_u32 s24, 0
    s_cbranch_scc1 L3_na2
    s_mov_b64 exec, 1
    buffer_atomic_add v253, v4, s[8:11], s89 offen sc1
    s_mov_b64 exec, -1
L3_na2:
    buffer_load_dwordx4 a[48:51], v11, s[20:23], s32 offen offset:2048 sc1
    buffer_load_dwordx4 a[52:55], v11, s[20:23], s33 offen offset:2048 sc1
    buffer_load_dwordx4 a[56:59], v11, s[20:23], s34 offen offset:2048 sc1
    buffer_load_dwordx4 a[60:63], v11, s[20:23], s35 offen offset:2048 sc1
    buffer_load_dwordx4 a[128:131], v11, s[20:23], s36 offen offset:2048 sc1
    buffer_load_dwordx4 a[132:135], v11, s[20:23], s37 offen offset:2048 sc1
    buffer_load_dwordx4 a[136:139], v11, s[20:23], s32 offen offset:3072 sc1
    buffer_load_dwordx4 a[140:143], v11, s[20:23], s33 offen offset:3072 sc1
    buffer_load_dwordx4 a[144:147], v11, s[20:23], s34 offen offset:3072 sc1
    buffer_load_dwordx4 a[148:151], v11, s[20:23], s35 offen offset:3072 sc1
    buffer_load_dwordx4 a[152:155], v11, s[20:23], s36 offen offset:3072 sc1
    buffer_load_dwordx4 a[156:159], v11, s[20:23], s37 offen offset:3072 sc1
    s_add_u32 s55, s45, 147456
    s_add_u32 m0, s88, 16896
    s_nop 0
    buffer_load_dwordx4 v246, s[84:87], s55 offen lds
    s_add_u32 m0, s88, 17952
    s_nop 0
    buffer_load_dwordx4 v247, s[84:87], s55 offen lds
    s_add_u32 m0, s88, 19008
    s_nop 0
    buffer_load_dwordx4 v248, s[84:87], s55 offen lds
    s_add_u32 m0, s88, 20064
    s_nop 0
    buffer_load_dwordx4 v249, s[84:87], s55 offen lds
    s_add_u32 s55, s45, 184320
    s_add_u32 m0, s88, 33792
    s_nop 0
    buffer_load_dwordx4 v246, s[84:87], s55 offen lds
    s_add_u32 m0, s88, 34848
    s_nop 0
    buffer_load_dwordx4 v247, s[84:87], s55 offen lds
    s_add_u32 m0, s88, 35904
    s_nop 0
    buffer_load_dwordx4 v248, s[84:87], s55 offen lds
    s_add_u32 m0, s88, 36960
    s_nop 0
    buffer_load_dwordx4 v249, s[84:87], s55 offen lds
    s_add_u32 s55, s45, 221184
    s_add_u32 m0, s88, 50688
    s_nop 0
    buffer_load_dwordx4 v246, s[84:87], s55 offen lds
    s_add_u32 m0, s88, 51744
    s_nop 0
    buffer_load_dwordx4 v247, s[84:87], s55 offen lds
    s_add_u32 m0, s88, 52800
    s_nop 0
    buffer_load_dwordx4 v248, s[84:87], s55 offen lds
    s_add_u32 m0, s88, 53856
    s_nop 0
    buffer_load_dwordx4 v249, s[84:87], s55 offen lds
    s_add_u32 s55, s45, 258048
    s_add_u32 m0, s88, 67584
    s_nop 0
    buffer_load_dwordx4 v246, s[84:87], s55 offen lds
    s_add_u32 m0, s88, 68640
    s_nop 0
    buffer_load_dwordx4 v247, s[84:87], s55 offen lds
    s_add_u32 m0, s88, 69696
    s_nop 0
    buffer_load_dwordx4 v248, s[84:87], s55 offen lds
    s_add_u32 m0, s88, 70752
    s_nop 0
    buffer_load_dwordx4 v249, s[84:87], s55 offen lds
    s_add_u32 s55, s45, 294912
    s_add_u32 m0, s88, 84480
    s_nop 0
    buffer_load_dwordx4 v246, s[84:87], s55 offen lds
    s_add_u32 m0, s88, 85536
    s_nop 0
    buffer_load_dwordx4 v247, s[84:87], s55 offen lds
    s_add_u32 m0, s88, 86592
    s_nop 0
    buffer_load_dwordx4 v248, s[84:87], s55 offen lds
    s_add_u32 m0, s88, 87648
    s_nop 0
    buffer_load_dwordx4 v249, s[84:87], s55 offen lds
    s_add_u32 s55, s45, 331776
    s_add_u32 m0, s88, 101376
    s_nop 0
    buffer_load_dwordx4 v246, s[84:87], s55 offen lds
    s_add_u32 m0, s88, 102432
    s_nop 0
    buffer_load_dwordx4 v247, s[84:87], s55 offen lds
    s_add_u32 m0, s88, 103488
    s_nop 0
    buffer_load_dwordx4 v248, s[84:87], s55 offen lds
    s_add_u32 m0, s88, 104544
    s_nop 0
    buffer_load_dwordx4 v249, s[84:87], s55 offen lds
    s_add_u32 s55, s45, 368640
    s_add_u32 m0, s88, 0
    s_nop 0
    buffer_load_dwordx4 v246, s[84:87], s55 offen lds
    s_add_u32 m0, s88, 1056
    s_nop 0
    buffer_load_dwordx4 v247, s[84:87], s55 offen lds
    s_add_u32 m0, s88, 2112
    s_nop 0
    buffer_load_dwordx4 v248, s[84:87], s55 offen lds
    s_add_u32 m0, s88, 3168
    s_nop 0
    buffer_load_dwordx4 v249, s[84:87], s55 offen lds
    s_add_u32 s55, s45, 405504
    s_add_u32 m0, s88, 118272
    s_nop 0
    buffer_load_dwordx4 v246, s[84:87], s55 offen lds
    s_add_u32 m0, s88, 119328
    s_nop 0
    buffer_load_dwordx4 v247, s[84:87], s55 offen lds
    s_add_u32 m0, s88, 120384
    s_nop 0
    buffer_load_dwordx4 v248, s[84:87], s55 offen lds
    s_add_u32 m0, s88, 121440
    s_nop 0
    buffer_load_dwordx4 v249, s[84:87], s55 offen lds
    s_add_u32 s55, s45, 442368
    s_add_u32 m0, s88, 135168
    s_nop 0
    buffer_load_dwordx4 v246, s[84:87], s55 offen lds
    s_add_u32 m0, s88, 136224
    s_nop 0
    buffer_load_dwordx4 v247, s[84:87], s55 offen lds
    s_add_u32 m0, s88, 137280
    s_nop 0
    buffer_load_dwordx4 v248, s[84:87], s55 offen lds
    s_add_u32 m0, s88, 138336
    s_nop 0
    buffer_load_dwordx4 v249, s[84:87], s55 offen lds
L3_go:
    s_waitcnt vmcnt(18) lgkmcnt(0)
    v_mfma_f32_16x16x32_bf16 v[16:19], v[160:163], a[0:3], 0
    v_mfma_f32_16x16x32_bf16 v[20:23], v[160:163], a[4:7], 0
    v_mfma_f32_16x16x32_bf16 v[24:27], v[160:163], a[8:11], 0
    v_mfma_f32_16x16x32_bf16 v[28:31], v[160:163], a[12:15], 0
    v_mfma_f32_16x16x32_bf16 v[32:35], v[160:163], a[16:19], 0
    v_mfma_f32_16x16x32_bf16 v[36:39], v[160:163], a[20:23], 0
    v_mfma_f32_16x16x32_bf16 a[160:163], v[164:167], a[0:3], 0
    v_mfma_f32_16x16x32_bf16 a[164:167], v[164:167], a[4:7], 0
    v_mfma_f32_16x16x32_bf16 a[168:171], v[164:167], a[8:11], 0
    v_mfma_f32_16x16x32_bf16 a[172:175], v[164:167], a[12:15], 0
    v_mfma_f32_16x16x32_bf16 a[176:179], v[164:167], a[16:19], 0
    v_mfma_f32_16x16x32_bf16 a[180:183], v[164:167], a[20:23], 0
    v_mfma_f32_16x16x32_bf16 a[184:187], v[168:171], a[0:3], 0
    v_mfma_f32_16x16x32_bf16 a[188:191], v[168:171], a[4:7], 0
    v_mfma_f32_16x16x32_bf16 a[192:195], v[168:171], a[8:11], 0
    v_mfma_f32_16x16x32_bf16 a[196:199], v[168:171], a[12:15], 0
    v_mfma_f32_16x16x32_bf16 a[200:203], v[168:171], a[16:19], 0
    v_mfma_f32_16x16x32_bf16 a[204:207], v[168:171], a[20:23], 0
    v_mfma_f32_16x16x32_bf16 a[208:211], v[172:175], a[0:3], 0
    v_mfma_f32_16x16x32_bf16 a[212:215], v[172:175], a[4:7], 0
    v_mfma_f32_16x16x32_bf16 a[216:219], v[172:175], a[8:11], 0
    v_mfma_f32_16x16x32_bf16 a[220:223], v[172:175], a[12:15], 0
    v_mfma_f32_16x16x32_bf16 a[224:227], v[172:175], a[16:19], 0
    v_mfma_f32_16x16x32_bf16 a[228:231], v[172:175], a[20:23], 0
    s_waitcnt vmcnt(12) lgkmcnt(0)
    v_mfma_f32_16x16x32_bf16 v[16:19], v[176:179], a[24:27], v[16:19]
    v_mfma_f32_16x16x32_bf16 v[20:23], v[176:179], a[28:31], v[20:23]
    s_add_u32 s32, s32, 4096
    buffer_load_dwordx4 a[0:3], v11, s[20:23], s32 offen sc1
    v_mfma_f32_16x16x32_bf16 v[24:27], v[176:179], a[32:35], v[24:27]
    v_mfma_f32_16x16x32_bf16 v[28:31], v[176:179], a[36:39], v[28:31]
    s_add_u32 s33, s33, 4096
    buffer_load_dwordx4 a[4:7], v11, s[20:23], s33 offen sc1
    v_mfma_f32_16x16x32_bf16 v[32:35], v[176:179], a[40:43], v[32:35]
    v_mfma_f32_16x16x32_bf16 v[36:39], v[176:179], a[44:47], v[36:39]
    s_add_u32 s34, s34, 4096
    buffer_load_dwordx4 a[8:11], v11, s[20:23], s34 offen sc1
    v_mfma_f32_16x16x32_bf16 a[160:163], v[180:183], a[24:27], a[160:163]
    v_mfma_f32_16x16x32_bf16 a[164:167], v[180:183], a[28:31], a[164:167]
    s_add_u32 s35, s35, 4096
    buffer_load_dwordx4 a[12:15], v11, s[20:23], s35 offen sc1
    v_mfma_f32_16x16x32_bf16 a[168:171], v[180:183], a[32:35], a[168:171]
    v_mfma_f32_16x16x32_bf16 a[172:175], v[180:183], a[36:39], a[172:175]
    s_add_u32 s36, s36, 4096
    buffer_load_dwordx4 a[16:19], v11, s[20:23], s36 offen sc1
    v_mfma_f32_16x16x32_bf16 a[176:179], v[180:183], a[40:43], a[176:179]
    v_mfma_f32_16x16x32_bf16 a[180:183], v[180:183], a[44:47], a[180:183]
    s_add_u32 s37, s37, 4096
    buffer_load_dwordx4 a[20:23], v11, s[20:23], s37 offen sc1
    v_mfma_f32_16x16x32_bf16 a[184:187], v[184:187], a[24:27], a[184:187]
    v_mfma_f32_16x16x32_bf16 a[188:191], v[184:187], a[28:31], a[188:191]
    v_mfma_f32_16x16x32_bf16 a[192:195], v[184:187], a[32:35], a[192:195]
    v_mfma_f32_16x16x32_bf16 a[196:199], v[184:187], a[36:39], a[196:199]
    v_mfma_f32_16x16x32_bf16 a[200:203], v[184:187], a[40:43], a[200:203]
    v_mfma_f32_16x16x32_bf16 a[204:207], v[184:187], a[44:47], a[204:207]
    v_mfma_f32_16x16x32_bf16 a[208:211], v[188:191], a[24:27], a[208:211]
    v_mfma_f32_16x16x32_bf16 a[212:215], v[188:191], a[28:31], a[212:215]
    v_mfma_f32_16x16x32_bf16 a[216:219], v[188:191], a[32:35], a[216:219]
    v_mfma_f32_16x16x32_bf16 a[220:223], v[188:191], a[36:39], a[220:223]
    v_mfma_f32_16x16x32_bf16 a[224:227], v[188:191], a[40:43], a[224:227]
    v_mfma_f32_16x16x32_bf16 a[228:231], v[188:191], a[44:47], a[228:231]
    s_waitcnt vmcnt(12) lgkmcnt(0)
    v_mfma_f32_16x16x32_bf16 v[16:19], v[192:195], a[48:51], v[16:19]
    v_mfma_f32_16x16x32_bf16 v[20:23], v[192:195], a[52:55], v[20:23]
    buffer_load_dwordx4 a[24:27], v11, s[20:23], s32 offen offset:1024 sc1
    v_mfma_f32_16x16x32_bf16 v[24:27], v[192:195], a[56:59], v[24:27]
    v_mfma_f32_16x16x32_bf16 v[28:31], v[192:195], a[60:63], v[28:31]
    buffer_load_dwordx4 a[28:31], v11, s[20:23], s33 offen offset:1024 sc1
    v_mfma_f32_16x16x32_bf16 v[32:35], v[192:195], a[128:131], v[32:35]
    v_mfma_f32_16x16x32_bf16 v[36:39], v[192:195], a[132:135], v[36:39]
    buffer_load_dwordx4 a[32:35], v11, s[20:23], s34 offen offset:1024 sc1
    v_mfma_f32_16x16x32_bf16 a[160:163], v[196:199], a[48:51], a[160:163]
    v_mfma_f32_16x16x32_bf16 a[164:167], v[196:199], a[52:55], a[164:167]
    buffer_load_dwordx4 a[36:39], v11, s[20:23], s35 offen offset:1024 sc1
    v_mfma_f32_16x16x32_bf16 a[168:171], v[196:199], a[56:59], a[168:171]
    v_mfma_f32_16x16x32_bf16 a[172:175], v[196:199], a[60:63], a[172:175]
    buffer_load_dwordx4 a[40:43], v11, s[20:23], s36 offen offset:1024 sc1
    v_mfma_f32_16x16x32_bf16 a[176:179], v[196:199], a[128:131], a[176:179]
    v_mfma_f32_16x16x32_bf16 a[180:183], v[196:199], a[132:135], a[180:183]
    buffer_load_dwordx4 a[44:47], v11, s[20:23], s37 offen offset:1024 sc1
    v_mfma_f32_16x16x32_bf16 a[184:187], v[200:203], a[48:51], a[184:187]
    v_mfma_f32_16x16x32_bf16 a[188:191], v[200:203], a[52:55], a[188:191]
    v_mfma_f32_16x16x32_bf16 a[192:195], v[200:203], a[56:59], a[192:195]
    v_mfma_f32_16x16x32_bf16 a[196:199], v[200:203], a[60:63], a[196:199]
    v_mfma_f32_16x16x32_bf16 a[200:203], v[200:203], a[128:131], a[200:203]
    v_mfma_f32_16x16x32_bf16 a[204:207], v[200:203], a[132:135], a[204:207]
    v_mfma_f32_16x16x32_bf16 a[208:211], v[204:207], a[48:51], a[208:211]
    v_mfma_f32_16x16x32_bf16 a[212:215], v[204:207], a[52:55], a[212:215]
    v_mfma_f32_16x16x32_bf16 a[216:219], v[204:207], a[56:59], a[216:219]
    v_mfma_f32_16x16x32_bf16 a[220:223], v[204:207], a[60:63], a[220:223]
    v_mfma_f32_16x16x32_bf16 a[224:227], v[204:207], a[128:131], a[224:227]
    v_mfma_f32_16x16x32_bf16 a[228:231], v[204:207], a[132:135], a[228:231]
    s_waitcnt vmcnt(12) lgkmcnt(0)
    v_mfma_f32_16x16x32_bf16 v[16:19], v[208:211], a[136:139], v[16:19]
    ds_read_b64_tr_b16 v[112:113], v224 offset:16896
    v_mfma_f32_16x16x32_bf16 v[20:23], v[208:211], a[140:143], v[20:23]
    buffer_load_dwordx4 a[48:51], v11, s[20:23], s32 offen offset:2048 sc1
    v_mfma_f32_16x16x32_bf16 v[24:27], v[208:211], a[144:147], v[24:27]
    ds_read_b64_tr_b16 v[114:115], v224 offset:19008
    v_mfma_f32_16x16x32_bf16 v[28:31], v[208:211], a[148:151], v[28:31]
    buffer_load_dwordx4 a[52:55], v11, s[20:23], s33 offen offset:2048 sc1
    v_mfma_f32_16x16x32_bf16 v[32:35], v[208:211], a[152:155], v[32:35]
    ds_read_b64_tr_b16 v[116:117], v225 offset:16896
    v_mfma_f32_16x16x32_bf16 v[36:39], v[208:211], a[156:159], v[36:39]
    buffer_load_dwordx4 a[56:59], v11, s[20:23], s34 offen offset:2048 sc1
    v_mfma_f32_16x16x32_bf16 a[160:163], v[212:215], a[136:139], a[160:163]
    ds_read_b64_tr_b16 v[118:119], v225 offset:19008
    v_mfma_f32_16x16x32_bf16 a[164:167], v[212:215], a[140:143], a[164:167]
    buffer_load_dwordx4 a[60:63], v11, s[20:23], s35 offen offset:2048 sc1
    v_mfma_f32_16x16x32_bf16 a[168:171], v[212:215], a[144:147], a[168:171]
    ds_read_b64_tr_b16 v[120:121], v226 offset:16896
    v_mfma_f32_16x16x32_bf16 a[172:175], v[212:215], a[148:151], a[172:175]
    buffer_load_dwordx4 a[128:131], v11, s[20:23], s36 offen offset:2048 sc1
    v_mfma_f32_16x16x32_bf16 a[176:179], v[212:215], a[152:155], a[176:179]
    ds_read_b64_tr_b16 v[122:123], v226 offset:19008
    v_mfma_f32_16x16x32_bf16 a[180:183], v[212:215], a[156:159], a[180:183]
    buffer_load_dwordx4 a[132:135], v11, s[20:23], s37 offen offset:2048 sc1
    v_mfma_f32_16x16x32_bf16 a[184:187], v[216:219], a[136:139], a[184:187]
    ds_read_b64_tr_b16 v[124:125], v227 offset:16896
    v_mfma_f32_16x16x32_bf16 a[188:191], v[216:219], a[140:143], a[188:191]
    v_mfma_f32_16x16x32_bf16 a[192:195], v[216:219], a[144:147], a[192:195]
    ds_read_b64_tr_b16 v[126:127], v227 offset:19008
    v_mfma_f32_16x16x32_bf16 a[196:199], v[216:219], a[148:151], a[196:199]
    v_mfma_f32_16x16x32_bf16 a[200:203], v[216:219], a[152:155], a[200:203]
    v_mfma_f32_16x16x32_bf16 a[204:207], v[216:219], a[156:159], a[204:207]
    v_mfma_f32_16x16x32_bf16 a[208:211], v[220:223], a[136:139], a[208:211]
    v_mfma_f32_16x16x32_bf16 a[212:215], v[220:223], a[140:143], a[212:215]
    v_mfma_f32_16x16x32_bf16 a[216:219], v[220:223], a[144:147], a[216:219]
    v_mfma_f32_16x16x32_bf16 a[220:223], v[220:223], a[148:151], a[220:223]
    v_mfma_f32_16x16x32_bf16 a[224:227], v[220:223], a[152:155], a[224:227]
    v_mfma_f32_16x16x32_bf16 a[228:231], v[220:223], a[156:159], a[228:231]
    s_waitcnt vmcnt(12) lgkmcnt(0)
    v_mfma_f32_16x16x32_bf16 v[16:19], v[112:115], a[0:3], v[16:19]
    ds_read_b64_tr_b16 v[128:129], v224 offset:33792
    v_mfma_f32_16x16x32_bf16 v[20:23], v[112:115], a[4:7], v[20:23]
    s_add_u32 s55, s45, 479232
    s_add_u32 m0, s88, 16896
    s_nop 0
    buffer_load_dwordx4 v246, s[84:87], s55 offen lds
    v_mfma_f32_16x16x32_bf16 v[24:27], v[112:115], a[8:11], v[24:27]
    ds_read_b64_tr_b16 v[130:131], v224 offset:35904
    v_mfma_f32_16x16x32_bf16 v[28:31], v[112:115], a[12:15], v[28:31]
    s_add_u32 m0, s88, 17952
    s_nop 0
    buffer_load_dwordx4 v247, s[84:87], s55 offen lds
    v_mfma_f32_16x16x32_bf16 v[32:35], v[112:115], a[16:19], v[32:35]
    ds_read_b64_tr_b16 v[132:133], v225 offset:33792
    v_mfma_f32_16x16x32_bf16 v[36:39], v[112:115], a[20:23], v[36:39]
    s_add_u32 m0, s88, 19008
    s_nop 0
    buffer_load_dwordx4 v248, s[84:87], s55 offen lds
    v_mfma_f32_16x16x32_bf16 a[160:163], v[116:119], a[0:3], a[160:163]
    ds_read_b64_tr_b16 v[134:135], v225 offset:35904
    v_mfma_f32_16x16x32_bf16 a[164:167], v[116:119], a[4:7], a[164:167]
    s_add_u32 m0, s88, 20064
    s_nop 0
    buffer_load_dwordx4 v249, s[84:87], s55 offen lds
    v_mfma_f32_16x16x32_bf16 a[168:171], v[116:119], a[8:11], a[168:171]
    ds_read_b64_tr_b16 v[136:137], v226 offset:33792
    v_mfma_f32_16x16x32_bf16 a[172:175], v[116:119], a[12:15], a[172:175]
    buffer_load_dwordx4 a[136:139], v11, s[20:23], s32 offen offset:3072 sc1
    v_mfma_f32_16x16x32_bf16 a[176:179], v[116:119], a[16:19], a[176:179]
    ds_read_b64_tr_b16 v[138:139], v226 offset:35904
    v_mfma_f32_16x16x32_bf16 a[180:183], v[116:119], a[20:23], a[180:183]
    buffer_load_dwordx4 a[140:143], v11, s[20:23], s33 offen offset:3072 sc1
    v_mfma_f32_16x16x32_bf16 a[184:187], v[120:123], a[0:3], a[184:187]
    ds_read_b64_tr_b16 v[140:141], v227 offset:33792
    v_mfma_f32_16x16x32_bf16 a[188:191], v[120:123], a[4:7], a[188:191]
    buffer_load_dwordx4 a[144:147], v11, s[20:23], s34 offen offset:3072 sc1
    v_mfma_f32_16x16x32_bf16 a[192:195], v[120:123], a[8:11], a[192:195]
    ds_read_b64_tr_b16 v[142:143], v227 offset:35904
    v_mfma_f32_16x16x32_bf16 a[196:199], v[120:123], a[12:15], a[196:199]
    buffer_load_dwordx4 a[148:151], v11, s[20:23], s35 offen offset:3072 sc1
    v_mfma_f32_16x16x32_bf16 a[200:203], v[120:123], a[16:19], a[200:203]
    v_mfma_f32_16x16x32_bf16 a[204:207], v[120:123], a[20:23], a[204:207]
    buffer_load_dwordx4 a[152:155], v11, s[20:23], s36 offen offset:3072 sc1
    v_mfma_f32_16x16x32_bf16 a[208:211], v[124:127], a[0:3], a[208:211]
    v_mfma_f32_16x16x32_bf16 a[212:215], v[124:127], a[4:7], a[212:215]
    buffer_load_dwordx4 a[156:159], v11, s[20:23], s37 offen offset:3072 sc1
    v_mfma_f32_16x16x32_bf16 a[216:219], v[124:127], a[8:11], a[216:219]
    v_mfma_f32_16x16x32_bf16 a[220:223], v[124:127], a[12:15], a[220:223]
    v_mfma_f32_16x16x32_bf16 a[224:227], v[124:127], a[16:19], a[224:227]
    v_mfma_f32_16x16x32_bf16 a[228:231], v[124:127], a[20:23], a[228:231]
    s_waitcnt vmcnt(16) lgkmcnt(0)
    v_mfma_f32_16x16x32_bf16 v[16:19], v[128:131], a[24:27], v[16:19]
    ds_read_b64_tr_b16 v[112:113], v228 offset:0
    v_mfma_f32_16x16x32_bf16 v[20:23], v[128:131], a[28:31], v[20:23]
    s_add_u32 s55, s45, 516096
    s_add_u32 m0, s88, 33792
    s_nop 0
    buffer_load_dwordx4 v246, s[84:87], s55 offen lds
    v_mfma_f32_16x16x32_bf16 v[24:27], v[128:131], a[32:35], v[24:27]
    ds_read_b64_tr_b16 v[114:115], v228 offset:2112
    v_mfma_f32_16x16x32_bf16 v[28:31], v[128:131], a[36:39], v[28:31]
    s_add_u32 m0, s88, 34848
    s_nop 0
    buffer_load_dwordx4 v247, s[84:87], s55 offen lds
    v_mfma_f32_16x16x32_bf16 v[32:35], v[128:131], a[40:43], v[32:35]
    ds_read_b64_tr_b16 v[116:117], v229 offset:0
    v_mfma_f32_16x16x32_bf16 v[36:39], v[128:131], a[44:47], v[36:39]
    s_add_u32 m0, s88, 35904
    s_nop 0
    buffer_load_dwordx4 v248, s[84:87], s55 offen lds
    v_mfma_f32_16x16x32_bf16 a[160:163], v[132:135], a[24:27], a[160:163]
    ds_read_b64_tr_b16 v[118:119], v229 offset:2112
    v_mfma_f32_16x16x32_bf16 a[164:167], v[132:135], a[28:31], a[164:167]
    s_add_u32 m0, s88, 36960
    s_nop 0
    buffer_load_dwordx4 v249, s[84:87], s55 offen lds
    v_mfma_f32_16x16x32_bf16 a[168:171], v[132:135], a[32:35], a[168:171]
    ds_read_b64_tr_b16 v[120:121], v230 offset:0
    v_mfma_f32_16x16x32_bf16 a[172:175], v[132:135], a[36:39], a[172:175]
    s_add_u32 s32, s32, 4096
    buffer_load_dwordx4 a[0:3], v11, s[20:23], s32 offen sc1
    v_mfma_f32_16x16x32_bf16 a[176:179], v[132:135], a[40:43], a[176:179]
    ds_read_b64_tr_b16 v[122:123], v230 offset:2112
    v_mfma_f32_16x16x32_bf16 a[180:183], v[132:135], a[44:47], a[180:183]
    s_add_u32 s33, s33, 4096
    buffer_load_dwordx4 a[4:7], v11, s[20:23], s33 offen sc1
    v_mfma_f32_16x16x32_bf16 a[184:187], v[136:139], a[24:27], a[184:187]
    ds_read_b64_tr_b16 v[124:125], v231 offset:0
    v_mfma_f32_16x16x32_bf16 a[188:191], v[136:139], a[28:31], a[188:191]
    s_add_u32 s34, s34, 4096
    buffer_load_dwordx4 a[8:11], v11, s[20:23], s34 offen sc1
    v_mfma_f32_16x16x32_bf16 a[192:195], v[136:139], a[32:35], a[192:195]
    ds_read_b64_tr_b16 v[126:127], v231 offset:2112
    v_mfma_f32_16x16x32_bf16 a[196:199], v[136:139], a[36:39], a[196:199]
    s_add_u32 s35, s35, 4096
    buffer_load_dwordx4 a[12:15], v11, s[20:23], s35 offen sc1
    v_mfma_f32_16x16x32_bf16 a[200:203], v[136:139], a[40:43], a[200:203]
    v_mfma_f32_16x16x32_bf16 a[204:207], v[136:139], a[44:47], a[204:207]
    s_add_u32 s36, s36, 4096
    buffer_load_dwordx4 a[16:19], v11, s[20:23], s36 offen sc1
    v_mfma_f32_16x16x32_bf16 a[208:211], v[140:143], a[24:27], a[208:211]
    v_mfma_f32_16x16x32_bf16 a[212:215], v[140:143], a[28:31], a[212:215]
    s_add_u32 s37, s37, 4096
    buffer_load_dwordx4 a[20:23], v11, s[20:23], s37 offen sc1
    v_mfma_f32_16x16x32_bf16 a[216:219], v[140:143], a[32:35], a[216:219]
    v_mfma_f32_16x16x32_bf16 a[220:223], v[140:143], a[36:39], a[220:223]
    v_mfma_f32_16x16x32_bf16 a[224:227], v[140:143], a[40:43], a[224:227]
    v_mfma_f32_16x16x32_bf16 a[228:231], v[140:143], a[44:47], a[228:231]
    s_waitcnt vmcnt(20) lgkmcnt(0)
    v_mfma_f32_16x16x32_bf16 v[16:19], v[112:115], a[48:51], v[16:19]
    ds_read_b64_tr_b16 v[128:129], v228 offset:16896
    v_mfma_f32_16x16x32_bf16 v[20:23], v[112:115], a[52:55], v[20:23]
    s_add_u32 s55, s45, 552960
    s_add_u32 m0, s88, 50688
    s_nop 0
    buffer_load_dwordx4 v246, s[84:87], s55 offen lds
    v_mfma_f32_16x16x32_bf16 v[24:27], v[112:115], a[56:59], v[24:27]
    ds_read_b64_tr_b16 v[130:131], v228 offset:19008
    v_mfma_f32_16x16x32_bf16 v[28:31], v[112:115], a[60:63], v[28:31]
    s_add_u32 m0, s88, 51744
    s_nop 0
    buffer_load_dwordx4 v247, s[84:87], s55 offen lds
    v_mfma_f32_16x16x32_bf16 v[32:35], v[112:115], a[128:131], v[32:35]
    ds_read_b64_tr_b16 v[132:133], v229 offset:16896
    v_mfma_f32_16x16x32_bf16 v[36:39], v[112:115], a[132:135], v[36:39]
    s_add_u32 m0, s88, 52800
    s_nop 0
    buffer_load_dwordx4 v248, s[84:87], s55 offen lds
    v_mfma_f32_16x16x32_bf16 a[160:163], v[116:119], a[48:51], a[160:163]
    ds_read_b64_tr_b16 v[134:135], v229 offset:19008
    v_mfma_f32_16x16x32_bf16 a[164:167], v[116:119], a[52:55], a[164:167]
    s_add_u32 m0, s88, 53856
    s_nop 0
    buffer_load_dwordx4 v249, s[84:87], s55 offen lds
    v_mfma_f32_16x16x32_bf16 a[168:171], v[116:119], a[56:59], a[168:171]
    ds_read_b64_tr_b16 v[136:137], v230 offset:16896
    v_mfma_f32_16x16x32_bf16 a[172:175], v[116:119], a[60:63], a[172:175]
    buffer_load_dwordx4 a[24:27], v11, s[20:23], s32 offen offset:1024 sc1
    v_mfma_f32_16x16x32_bf16 a[176:179], v[116:119], a[128:131], a[176:179]
    ds_read_b64_tr_b16 v[138:139], v230 offset:19008
    v_mfma_f32_16x16x32_bf16 a[180:183], v[116:119], a[132:135], a[180:183]
    buffer_load_dwordx4 a[28:31], v11, s[20:23], s33 offen offset:1024 sc1
    v_mfma_f32_16x16x32_bf16 a[184:187], v[120:123], a[48:51], a[184:187]
    ds_read_b64_tr_b16 v[140:141], v231 offset:16896
    v_mfma_f32_16x16x32_bf16 a[188:191], v[120:123], a[52:55], a[188:191]
    buffer_load_dwordx4 a[32:35], v11, s[20:23], s34 offen offset:1024 sc1
    v_mfma_f32_16x16x32_bf16 a[192:195], v[120:123], a[56:59], a[192:195]
    ds_read_b64_tr_b16 v[142:143], v231 offset:19008
    v_mfma_f32_16x16x32_bf16 a[196:199], v[120:123], a[60:63], a[196:199]
    buffer_load_dwordx4 a[36:39], v11, s[20:23], s35 offen offset:1024 sc1
    v_mfma_f32_16x16x32_bf16 a[200:203], v[120:123], a[128:131], a[200:203]
    v_mfma_f32_16x16x32_bf16 a[204:207], v[120:123], a[132:135], a[204:207]
    buffer_load_dwordx4 a[40:43], v11, s[20:23], s36 offen offset:1024 sc1
    v_mfma_f32_16x16x32_bf16 a[208:211], v[124:127], a[48:51], a[208:211]
    v_mfma_f32_16x16x32_bf16 a[212:215], v[124:127], a[52:55], a[212:215]
    buffer_load_dwordx4 a[44:47], v11, s[20:23], s37 offen offset:1024 sc1
    v_mfma_f32_16x16x32_bf16 a[216:219], v[124:127], a[56:59], a[216:219]
    v_mfma_f32_16x16x32_bf16 a[220:223], v[124:127], a[60:63], a[220:223]
    v_mfma_f32_16x16x32_bf16 a[224:227], v[124:127], a[128:131], a[224:227]
    v_mfma_f32_16x16x32_bf16 a[228:231], v[124:127], a[132:135], a[228:231]
    s_waitcnt vmcnt(20) lgkmcnt(0)
    v_mfma_f32_16x16x32_bf16 v[16:19], v[128:131], a[136:139], v[16:19]
    ds_read_b64_tr_b16 v[112:113], v228 offset:33792
    v_mfma_f32_16x16x32_bf16 v[20:23], v[128:131], a[140:143], v[20:23]
    s_add_u32 s55, s45, 589824
    s_add_u32 m0, s88, 67584
    s_nop 0
    buffer_load_dwordx4 v246, s[84:87], s55 offen lds
    v_mfma_f32_16x16x32_bf16 v[24:27], v[128:131], a[144:147], v[24:27]
    ds_read_b64_tr_b16 v[114:115], v228 offset:35904
    v_mfma_f32_16x16x32_bf16 v[28:31], v[128:131], a[148:151], v[28:31]
    s_add_u32 m0, s88, 68640
    s_nop 0
    buffer_load_dwordx4 v247, s[84:87], s55 offen lds
    v_mfma_f32_16x16x32_bf16 v[32:35], v[128:131], a[152:155], v[32:35]
    ds_read_b64_tr_b16 v[116:117], v229 offset:33792
    v_mfma_f32_16x16x32_bf16 v[36:39], v[128:131], a[156:159], v[36:39]
    s_add_u32 m0, s88, 69696
    s_nop 0
    buffer_load_dwordx4 v248, s[84:87], s55 offen lds
    v_mfma_f32_16x16x32_bf16 a[160:163], v[132:135], a[136:139], a[160:163]
    ds_read_b64_tr_b16 v[118:119], v229 offset:35904
    v_mfma_f32_16x16x32_bf16 a[164:167], v[132:135], a[140:143], a[164:167]
    s_add_u32 m0, s88, 70752
    s_nop 0
    buffer_load_dwordx4 v249, s[84:87], s55 offen lds
    v_mfma_f32_16x16x32_bf16 a[168:171], v[132:135], a[144:147], a[168:171]
    ds_read_b64_tr_b16 v[120:121], v230 offset:33792
    v_mfma_f32_16x16x32_bf16 a[172:175], v[132:135], a[148:151], a[172:175]
    buffer_load_dwordx4 a[48:51], v11, s[20:23], s32 offen offset:2048 sc1
    v_mfma_f32_16x16x32_bf16 a[176:179], v[132:135], a[152:155], a[176:179]
    ds_read_b64_tr_b16 v[122:123], v230 offset:35904
    v_mfma_f32_16x16x32_bf16 a[180:183], v[132:135], a[156:159], a[180:183]
    buffer_load_dwordx4 a[52:55], v11, s[20:23], s33 offen offset:2048 sc1
    v_mfma_f32_16x16x32_bf16 a[184:187], v[136:139], a[136:139], a[184:187]
    ds_read_b64_tr_b16 v[124:125], v231 offset:33792
    v_mfma_f32_16x16x32_bf16 a[188:191], v[136:139], a[140:143], a[188:191]
    buffer_load_dwordx4 a[56:59], v11, s[20:23], s34 offen offset:2048 sc1
    v_mfma_f32_16x16x32_bf16 a[192:195], v[136:139], a[144:147], a[192:195]
    ds_read_b64_tr_b16 v[126:127], v231 offset:35904
    v_mfma_f32_16x16x32_bf16 a[196:199], v[136:139], a[148:151], a[196:199]
    buffer_load_dwordx4 a[60:63], v11, s[20:23], s35 offen offset:2048 sc1
    v_mfma_f32_16x16x32_bf16 a[200:203], v[136:139], a[152:155], a[200:203]
    v_mfma_f32_16x16x32_bf16 a[204:207], v[136:139], a[156:159], a[204:207]
    buffer_load_dwordx4 a[128:131], v11, s[20:23], s36 offen offset:2048 sc1
    v_mfma_f32_16x16x32_bf16 a[208:211], v[140:143], a[136:139], a[208:211]
    v_mfma_f32_16x16x32_bf16 a[212:215], v[140:143], a[140:143], a[212:215]
    buffer_load_dwordx4 a[132:135], v11, s[20:23], s37 offen offset:2048 sc1
    v_mfma_f32_16x16x32_bf16 a[216:219], v[140:143], a[144:147], a[216:219]
    v_mfma_f32_16x16x32_bf16 a[220:223], v[140:143], a[148:151], a[220:223]
    v_mfma_f32_16x16x32_bf16 a[224:227], v[140:143], a[152:155], a[224:227]
    v_mfma_f32_16x16x32_bf16 a[228:231], v[140:143], a[156:159], a[228:231]
    s_waitcnt vmcnt(20) lgkmcnt(0)
    v_mfma_f32_16x16x32_bf16 v[16:19], v[112:115], a[0:3], v[16:19]
    ds_read_b64_tr_b16 v[128:129], v232 offset:0
    v_mfma_f32_16x16x32_bf16 v[20:23], v[112:115], a[4:7], v[20:23]
    s_add_u32 s55, s45, 626688
    s_add_u32 m0, s88, 84480
    s_nop 0
    buffer_load_dwordx4 v246, s[84:87], s55 offen lds
    v_mfma_f32_16x16x32_bf16 v[24:27], v[112:115], a[8:11], v[24:27]
    ds_read_b64_tr_b16 v[130:131], v232 offset:2112
    v_mfma_f32_16x16x32_bf16 v[28:31], v[112:115], a[12:15], v[28:31]
    s_add_u32 m0, s88, 85536
    s_nop 0
    buffer_load_dwordx4 v247, s[84:87], s55 offen lds
    v_mfma_f32_16x16x32_bf16 v[32:35], v[112:115], a[16:19], v[32:35]
    ds_read_b64_tr_b16 v[132:133], v233 offset:0
    v_mfma_f32_16x16x32_bf16 v[36:39], v[112:115], a[20:23], v[36:39]
    s_add_u32 m0, s88, 86592
    s_nop 0
    buffer_load_dwordx4 v248, s[84:87], s55 offen lds
    v_mfma_f32_16x16x32_bf16 a[160:163], v[116:119], a[0:3], a[160:163]
    ds_read_b64_tr_b16 v[134:135], v233 offset:2112
    v_mfma_f32_16x16x32_bf16 a[164:167], v[116:119], a[4:7], a[164:167]
    s_add_u32 m0, s88, 87648
    s_nop 0
    buffer_load_dwordx4 v249, s[84:87], s55 offen lds
    v_mfma_f32_16x16x32_bf16 a[168:171], v[116:119], a[8:11], a[168:171]
    ds_read_b64_tr_b16 v[136:137], v234 offset:0
    v_mfma_f32_16x16x32_bf16 a[172:175], v[116:119], a[12:15], a[172:175]
    buffer_load_dwordx4 a[136:139], v11, s[20:23], s32 offen offset:3072 sc1
    v_mfma_f32_16x16x32_bf16 a[176:179], v[116:119], a[16:19], a[176:179]
    ds_read_b64_tr_b16 v[138:139], v234 offset:2112
    v_mfma_f32_16x16x32_bf16 a[180:183], v[116:119], a[20:23], a[180:183]
    buffer_load_dwordx4 a[140:143], v11, s[20:23], s33 offen offset:3072 sc1
    v_mfma_f32_16x16x32_bf16 a[184:187], v[120:123], a[0:3], a[184:187]
    ds_read_b64_tr_b16 v[140:141], v235 offset:0
    v_mfma_f32_16x16x32_bf16 a[188:191], v[120:123], a[4:7], a[188:191]
    buffer_load_dwordx4 a[144:147], v11, s[20:23], s34 offen offset:3072 sc1
    v_mfma_f32_16x16x32_bf16 a[192:195], v[120:123], a[8:11], a[192:195]
    ds_read_b64_tr_b16 v[142:143], v235 offset:2112
    v_mfma_f32_16x16x32_bf16 a[196:199], v[120:123], a[12:15], a[196:199]
    buffer_load_dwordx4 a[148:151], v11, s[20:23], s35 offen offset:3072 sc1
    v_mfma_f32_16x16x32_bf16 a[200:203], v[120:123], a[16:19], a[200:203]
    v_mfma_f32_16x16x32_bf16 a[204:207], v[120:123], a[20:23], a[204:207]
    buffer_load_dwordx4 a[152:155], v11, s[20:23], s36 offen offset:3072 sc1
    v_mfma_f32_16x16x32_bf16 a[208:211], v[124:127], a[0:3], a[208:211]
    v_mfma_f32_16x16x32_bf16 a[212:215], v[124:127], a[4:7], a[212:215]
    buffer_load_dwordx4 a[156:159], v11, s[20:23], s37 offen offset:3072 sc1
    v_mfma_f32_16x16x32_bf16 a[216:219], v[124:127], a[8:11], a[216:219]
    v_mfma_f32_16x16x32_bf16 a[220:223], v[124:127], a[12:15], a[220:223]
    v_mfma_f32_16x16x32_bf16 a[224:227], v[124:127], a[16:19], a[224:227]
    v_mfma_f32_16x16x32_bf16 a[228:231], v[124:127], a[20:23], a[228:231]
    s_waitcnt vmcnt(20) lgkmcnt(0)
    v_mfma_f32_16x16x32_bf16 v[16:19], v[128:131], a[24:27], v[16:19]
    ds_read_b64_tr_b16 v[112:113], v224 offset:0
    v_mfma_f32_16x16x32_bf16 v[20:23], v[128:131], a[28:31], v[20:23]
    s_add_u32 s55, s45, 663552
    s_add_u32 m0, s88, 101376
    s_nop 0
    buffer_load_dwordx4 v246, s[84:87], s55 offen lds
    v_mfma_f32_16x16x32_bf16 v[24:27], v[128:131], a[32:35], v[24:27]
    ds_read_b64_tr_b16 v[114:115], v224 offset:2112
    v_mfma_f32_16x16x32_bf16 v[28:31], v[128:131], a[36:39], v[28:31]
    s_add_u32 m0, s88, 102432
    s_nop 0
    buffer_load_dwordx4 v247, s[84:87], s55 offen lds
    v_mfma_f32_16x16x32_bf16 v[32:35], v[128:131], a[40:43], v[32:35]
    ds_read_b64_tr_b16 v[116:117], v225 offset:0
    v_mfma_f32_16x16x32_bf16 v[36:39], v[128:131], a[44:47], v[36:39]
    s_add_u32 m0, s88, 103488
    s_nop 0
    buffer_load_dwordx4 v248, s[84:87], s55 offen lds
    v_mfma_f32_16x16x32_bf16 a[160:163], v[132:135], a[24:27], a[160:163]
    ds_read_b64_tr_b16 v[118:119], v225 offset:2112
    v_mfma_f32_16x16x32_bf16 a[164:167], v[132:135], a[28:31], a[164:167]
    s_add_u32 m0, s88, 104544
    s_nop 0
    buffer_load_dwordx4 v249, s[84:87], s55 offen lds
    v_mfma_f32_16x16x32_bf16 a[168:171], v[132:135], a[32:35], a[168:171]
    ds_read_b64_tr_b16 v[120:121], v226 offset:0
    v_mfma_f32_16x16x32_bf16 a[172:175], v[132:135], a[36:39], a[172:175]
    s_add_u32 s32, s32, 4096
    buffer_load_dwordx4 a[0:3], v11, s[20:23], s32 offen sc1
    v_mfma_f32_16x16x32_bf16 a[176:179], v[132:135], a[40:43], a[176:179]
    ds_read_b64_tr_b16 v[122:123], v226 offset:2112
    v_mfma_f32_16x16x32_bf16 a[180:183], v[132:135], a[44:47], a[180:183]
    s_add_u32 s33, s33, 4096
    buffer_load_dwordx4 a[4:7], v11, s[20:23], s33 offen sc1
    v_mfma_f32_16x16x32_bf16 a[184:187], v[136:139], a[24:27], a[184:187]
    ds_read_b64_tr_b16 v[124:125], v227 offset:0
    v_mfma_f32_16x16x32_bf16 a[188:191], v[136:139], a[28:31], a[188:191]
    s_add_u32 s34, s34, 4096
    buffer_load_dwordx4 a[8:11], v11, s[20:23], s34 offen sc1
    v_mfma_f32_16x16x32_bf16 a[192:195], v[136:139], a[32:35], a[192:195]
    ds_read_b64_tr_b16 v[126:127], v227 offset:2112
    v_mfma_f32_16x16x32_bf16 a[196:199], v[136:139], a[36:39], a[196:199]
    s_add_u32 s35, s35, 4096
    buffer_load_dwordx4 a[12:15], v11, s[20:23], s35 offen sc1
    v_mfma_f32_16x16x32_bf16 a[200:203], v[136:139], a[40:43], a[200:203]
    v_mfma_f32_16x16x32_bf16 a[204:207], v[136:139], a[44:47], a[204:207]
    s_add_u32 s36, s36, 4096
    buffer_load_dwordx4 a[16:19], v11, s[20:23], s36 offen sc1
    v_mfma_f32_16x16x32_bf16 a[208:211], v[140:143], a[24:27], a[208:211]
    v_mfma_f32_16x16x32_bf16 a[212:215], v[140:143], a[28:31], a[212:215]
    s_add_u32 s37, s37, 4096
    buffer_load_dwordx4 a[20:23], v11, s[20:23], s37 offen sc1
    v_mfma_f32_16x16x32_bf16 a[216:219], v[140:143], a[32:35], a[216:219]
    v_mfma_f32_16x16x32_bf16 a[220:223], v[140:143], a[36:39], a[220:223]
    v_mfma_f32_16x16x32_bf16 a[224:227], v[140:143], a[40:43], a[224:227]
    v_mfma_f32_16x16x32_bf16 a[228:231], v[140:143], a[44:47], a[228:231]
    s_waitcnt vmcnt(20) lgkmcnt(0)
    v_mfma_f32_16x16x32_bf16 v[16:19], v[112:115], a[48:51], v[16:19]
    ds_read_b64_tr_b16 v[128:129], v232 offset:16896
    v_mfma_f32_16x16x32_bf16 v[20:23], v[112:115], a[52:55], v[20:23]
    s_add_u32 s55, s45, 700416
    s_add_u32 m0, s88, 0
    s_nop 0
    buffer_load_dwordx4 v246, s[84:87], s55 offen lds
    v_mfma_f32_16x16x32_bf16 v[24:27], v[112:115], a[56:59], v[24:27]
    ds_read_b64_tr_b16 v[130:131], v232 offset:19008
    v_mfma_f32_16x16x32_bf16 v[28:31], v[112:115], a[60:63], v[28:31]
    s_add_u32 m0, s88, 1056
    s_nop 0
    buffer_load_dwordx4 v247, s[84:87], s55 offen lds
    v_mfma_f32_16x16x32_bf16 v[32:35], v[112:115], a[128:131], v[32:35]
    ds_read_b64_tr_b16 v[132:133], v233 offset:16896
    v_mfma_f32_16x16x32_bf16 v[36:39], v[112:115], a[132:135], v[36:39]
    s_add_u32 m0, s88, 2112
    s_nop 0
    buffer_load_dwordx4 v248, s[84:87], s55 offen lds
    v_mfma_f32_16x16x32_bf16 a[160:163], v[116:119], a[48:51], a[160:163]
    ds_read_b64_tr_b16 v[134:135], v233 offset:19008
    v_mfma_f32_16x16x32_bf16 a[164:167], v[116:119], a[52:55], a[164:167]
    s_add_u32 m0, s88, 3168
    s_nop 0
    buffer_load_dwordx4 v249, s[84:87], s55 offen lds
    v_mfma_f32_16x16x32_bf16 a[168:171], v[116:119], a[56:59], a[168:171]
    ds_read_b64_tr_b16 v[136:137], v234 offset:16896
    v_mfma_f32_16x16x32_bf16 a[172:175], v[116:119], a[60:63], a[172:175]
    buffer_load_dwordx4 a[24:27], v11, s[20:23], s32 offen offset:1024 sc1
    v_mfma_f32_16x16x32_bf16 a[176:179], v[116:119], a[128:131], a[176:179]
    ds_read_b64_tr_b16 v[138:139], v234 offset:19008
    v_mfma_f32_16x16x32_bf16 a[180:183], v[116:119], a[132:135], a[180:183]
    buffer_load_dwordx4 a[28:31], v11, s[20:23], s33 offen offset:1024 sc1
    v_mfma_f32_16x16x32_bf16 a[184:187], v[120:123], a[48:51], a[184:187]
    ds_read_b64_tr_b16 v[140:141], v235 offset:16896
    v_mfma_f32_16x16x32_bf16 a[188:191], v[120:123], a[52:55], a[188:191]
    buffer_load_dwordx4 a[32:35], v11, s[20:23], s34 offen offset:1024 sc1
    v_mfma_f32_16x16x32_bf16 a[192:195], v[120:123], a[56:59], a[192:195]
    ds_read_b64_tr_b16 v[142:143], v235 offset:19008
    v_mfma_f32_16x16x32_bf16 a[196:199], v[120:123], a[60:63], a[196:199]
    buffer_load_dwordx4 a[36:39], v11, s[20:23], s35 offen offset:1024 sc1
    v_mfma_f32_16x16x32_bf16 a[200:203], v[120:123], a[128:131], a[200:203]
    v_mfma_f32_16x16x32_bf16 a[204:207], v[120:123], a[132:135], a[204:207]
    buffer_load_dwordx4 a[40:43], v11, s[20:23], s36 offen offset:1024 sc1
    v_mfma_f32_16x16x32_bf16 a[208:211], v[124:127], a[48:51], a[208:211]
    v_mfma_f32_16x16x32_bf16 a[212:215], v[124:127], a[52:55], a[212:215]
    buffer_load_dwordx4 a[44:47], v11, s[20:23], s37 offen offset:1024 sc1
    v_mfma_f32_16x16x32_bf16 a[216:219], v[124:127], a[56:59], a[216:219]
    v_mfma_f32_16x16x32_bf16 a[220:223], v[124:127], a[60:63], a[220:223]
    v_mfma_f32_16x16x32_bf16 a[224:227], v[124:127], a[128:131], a[224:227]
    v_mfma_f32_16x16x32_bf16 a[228:231], v[124:127], a[132:135], a[228:231]
    s_waitcnt vmcnt(20) lgkmcnt(0)
    v_mfma_f32_16x16x32_bf16 v[16:19], v[128:131], a[136:139], v[16:19]
    ds_read_b64_tr_b16 v[112:113], v232 offset:33792
    v_mfma_f32_16x16x32_bf16 v[20:23], v[128:131], a[140:143], v[20:23]
    s_add_u32 s55, s45, 737280
    s_add_u32 m0, s88, 118272
    s_nop 0
    buffer_load_dwordx4 v246, s[84:87], s55 offen lds
    v_mfma_f32_16x16x32_bf16 v[24:27], v[128:131], a[144:147], v[24:27]
    ds_read_b64_tr_b16 v[114:115], v232 offset:35904
    v_mfma_f32_16x16x32_bf16 v[28:31], v[128:131], a[148:151], v[28:31]
    s_add_u32 m0, s88, 119328
    s_nop 0
    buffer_load_dwordx4 v247, s[84:87], s55 offen lds
    v_mfma_f32_16x16x32_bf16 v[32:35], v[128:131], a[152:155], v[32:35]
    ds_read_b64_tr_b16 v[116:117], v233 offset:33792
    v_mfma_f32_16x16x32_bf16 v[36:39], v[128:131], a[156:159], v[36:39]
    s_add_u32 m0, s88, 120384
    s_nop 0
    buffer_load_dwordx4 v248, s[84:87], s55 offen lds
    v_mfma_f32_16x16x32_bf16 a[160:163], v[132:135], a[136:139], a[160:163]
    ds_read_b64_tr_b16 v[118:119], v233 offset:35904
    v_mfma_f32_16x16x32_bf16 a[164:167], v[132:135], a[140:143], a[164:167]
    s_add_u32 m0, s88, 121440
    s_nop 0
    buffer_load_dwordx4 v249, s[84:87], s55 offen lds
    v_mfma_f32_16x16x32_bf16 a[168:171], v[132:135], a[144:147], a[168:171]
    ds_read_b64_tr_b16 v[120:121], v234 offset:33792
    v_mfma_f32_16x16x32_bf16 a[172:175], v[132:135], a[148:151], a[172:175]
    buffer_load_dwordx4 a[48:51], v11, s[20:23], s32 offen offset:2048 sc1
    v_mfma_f32_16x16x32_bf16 a[176:179], v[132:135], a[152:155], a[176:179]
    ds_read_b64_tr_b16 v[122:123], v234 offset:35904
    v_mfma_f32_16x16x32_bf16 a[180:183], v[132:135], a[156:159], a[180:183]
    buffer_load_dwordx4 a[52:55], v11, s[20:23], s33 offen offset:2048 sc1
    v_mfma_f32_16x16x32_bf16 a[184:187], v[136:139], a[136:139], a[184:187]
    ds_read_b64_tr_b16 v[124:125], v235 offset:33792
    v_mfma_f32_16x16x32_bf16 a[188:191], v[136:139], a[140:143], a[188:191]
    buffer_load_dwordx4 a[56:59], v11, s[20:23], s34 offen offset:2048 sc1
    v_mfma_f32_16x16x32_bf16 a[192:195], v[136:139], a[144:147], a[192:195]
    ds_read_b64_tr_b16 v[126:127], v235 offset:35904
    v_mfma_f32_16x16x32_bf16 a[196:199], v[136:139], a[148:151], a[196:199]
    buffer_load_dwordx4 a[60:63], v11, s[20:23], s35 offen offset:2048 sc1
    v_mfma_f32_16x16x32_bf16 a[200:203], v[136:139], a[152:155], a[200:203]
    v_mfma_f32_16x16x32_bf16 a[204:207], v[136:139], a[156:159], a[204:207]
    buffer_load_dwordx4 a[128:131], v11, s[20:23], s36 offen offset:2048 sc1
    v_mfma_f32_16x16x32_bf16 a[208:211], v[140:143], a[136:139], a[208:211]
    v_mfma_f32_16x16x32_bf16 a[212:215], v[140:143], a[140:143], a[212:215]
    buffer_load_dwordx4 a[132:135], v11, s[20:23], s37 offen offset:2048 sc1
    v_mfma_f32_16x16x32_bf16 a[216:219], v[140:143], a[144:147], a[216:219]
    v_mfma_f32_16x16x32_bf16 a[220:223], v[140:143], a[148:151], a[220:223]
    v_mfma_f32_16x16x32_bf16 a[224:227], v[140:143], a[152:155], a[224:227]
    v_mfma_f32_16x16x32_bf16 a[228:231], v[140:143], a[156:159], a[228:231]
    s_waitcnt vmcnt(20) lgkmcnt(0)
    v_mfma_f32_16x16x32_bf16 v[16:19], v[112:115], a[0:3], v[16:19]
    ds_read_b64_tr_b16 v[128:129], v224 offset:16896
    v_mfma_f32_16x16x32_bf16 v[20:23], v[112:115], a[4:7], v[20:23]
    s_add_u32 s55, s45, 774144
    s_add_u32 m0, s88, 135168
    s_nop 0
    buffer_load_dwordx4 v246, s[84:87], s55 offen lds
    v_mfma_f32_16x16x32_bf16 v[24:27], v[112:115], a[8:11], v[24:27]
    ds_read_b64_tr_b16 v[130:131], v224 offset:19008
    v_mfma_f32_16x16x32_bf16 v[28:31], v[112:115], a[12:15], v[28:31]
    s_add_u32 m0, s88, 136224
    s_nop 0
    buffer_load_dwordx4 v247, s[84:87], s55 offen lds
    v_mfma_f32_16x16x32_bf16 v[32:35], v[112:115], a[16:19], v[32:35]
    ds_read_b64_tr_b16 v[132:133], v225 offset:16896
    v_mfma_f32_16x16x32_bf16 v[36:39], v[112:115], a[20:23], v[36:39]
    s_add_u32 m0, s88, 137280
    s_nop 0
    buffer_load_dwordx4 v248, s[84:87], s55 offen lds
    v_mfma_f32_16x16x32_bf16 a[160:163], v[116:119], a[0:3], a[160:163]
    ds_read_b64_tr_b16 v[134:135], v225 offset:19008
    v_mfma_f32_16x16x32_bf16 a[164:167], v[116:119], a[4:7], a[164:167]
    s_add_u32 m0, s88, 138336
    s_nop 0
    buffer_load_dwordx4 v249, s[84:87], s55 offen lds
    v_mfma_f32_16x16x32_bf16 a[168:171], v[116:119], a[8:11], a[168:171]
    ds_read_b64_tr_b16 v[136:137], v226 offset:16896
    v_mfma_f32_16x16x32_bf16 a[172:175], v[116:119], a[12:15], a[172:175]
    buffer_load_dwordx4 a[136:139], v11, s[20:23], s32 offen offset:3072 sc1
    v_mfma_f32_16x16x32_bf16 a[176:179], v[116:119], a[16:19], a[176:179]
    ds_read_b64_tr_b16 v[138:139], v226 offset:19008
    v_mfma_f32_16x16x32_bf16 a[180:183], v[116:119], a[20:23], a[180:183]
    buffer_load_dwordx4 a[140:143], v11, s[20:23], s33 offen offset:3072 sc1
    v_mfma_f32_16x16x32_bf16 a[184:187], v[120:123], a[0:3], a[184:187]
    ds_read_b64_tr_b16 v[140:141], v227 offset:16896
    v_mfma_f32_16x16x32_bf16 a[188:191], v[120:123], a[4:7], a[188:191]
    buffer_load_dwordx4 a[144:147], v11, s[20:23], s34 offen offset:3072 sc1
    v_mfma_f32_16x16x32_bf16 a[192:195], v[120:123], a[8:11], a[192:195]
    ds_read_b64_tr_b16 v[142:143], v227 offset:19008
    v_mfma_f32_16x16x32_bf16 a[196:199], v[120:123], a[12:15], a[196:199]
    buffer_load_dwordx4 a[148:151], v11, s[20:23], s35 offen offset:3072 sc1
    v_mfma_f32_16x16x32_bf16 a[200:203], v[120:123], a[16:19], a[200:203]
    v_mfma_f32_16x16x32_bf16 a[204:207], v[120:123], a[20:23], a[204:207]
    buffer_load_dwordx4 a[152:155], v11, s[20:23], s36 offen offset:3072 sc1
    v_mfma_f32_16x16x32_bf16 a[208:211], v[124:127], a[0:3], a[208:211]
    v_mfma_f32_16x16x32_bf16 a[212:215], v[124:127], a[4:7], a[212:215]
    buffer_load_dwordx4 a[156:159], v11, s[20:23], s37 offen offset:3072 sc1
    v_mfma_f32_16x16x32_bf16 a[216:219], v[124:127], a[8:11], a[216:219]
    v_mfma_f32_16x16x32_bf16 a[220:223], v[124:127], a[12:15], a[220:223]
    v_mfma_f32_16x16x32_bf16 a[224:227], v[124:127], a[16:19], a[224:227]
    v_mfma_f32_16x16x32_bf16 a[228:231], v[124:127], a[20:23], a[228:231]
    s_waitcnt vmcnt(20) lgkmcnt(0)
    v_mfma_f32_16x16x32_bf16 v[16:19], v[128:131], a[24:27], v[16:19]
    ds_read_b64_tr_b16 v[112:113], v224 offset:33792
    v_mfma_f32_16x16x32_bf16 v[20:23], v[128:131], a[28:31], v[20:23]
    s_add_u32 s55, s45, 811008
    s_add_u32 m0, s88, 16896
    s_nop 0
    buffer_load_dwordx4 v246, s[84:87], s55 offen lds
    v_mfma_f32_16x16x32_bf16 v[24:27], v[128:131], a[32:35], v[24:27]
    ds_read_b64_tr_b16 v[114:115], v224 offset:35904
    v_mfma_f32_16x16x32_bf16 v[28:31], v[128:131], a[36:39], v[28:31]
    s_add_u32 m0, s88, 17952
    s_nop 0
    buffer_load_dwordx4 v247, s[84:87], s55 offen lds
    v_mfma_f32_16x16x32_bf16 v[32:35], v[128:131], a[40:43], v[32:35]
    ds_read_b64_tr_b16 v[116:117], v225 offset:33792
    v_mfma_f32_16x16x32_bf16 v[36:39], v[128:131], a[44:47], v[36:39]
    s_add_u32 m0, s88, 19008
    s_nop 0
    buffer_load_dwordx4 v248, s[84:87], s55 offen lds
    v_mfma_f32_16x16x32_bf16 a[160:163], v[132:135], a[24:27], a[160:163]
    ds_read_b64_tr_b16 v[118:119], v225 offset:35904
    v_mfma_f32_16x16x32_bf16 a[164:167], v[132:135], a[28:31], a[164:167]
    s_add_u32 m0, s88, 20064
    s_nop 0
    buffer_load_dwordx4 v249, s[84:87], s55 offen lds
    v_mfma_f32_16x16x32_bf16 a[168:171], v[132:135], a[32:35], a[168:171]
    ds_read_b64_tr_b16 v[120:121], v226 offset:33792
    v_mfma_f32_16x16x32_bf16 a[172:175], v[132:135], a[36:39], a[172:175]
    s_add_u32 s32, s32, 4096
    buffer_load_dwordx4 a[0:3], v11, s[20:23], s32 offen sc1
    v_mfma_f32_16x16x32_bf16 a[176:179], v[132:135], a[40:43], a[176:179]
    ds_read_b64_tr_b16 v[122:123], v226 offset:35904
    v_mfma_f32_16x16x32_bf16 a[180:183], v[132:135], a[44:47], a[180:183]
    s_add_u32 s33, s33, 4096
    buffer_load_dwordx4 a[4:7], v11, s[20:23], s33 offen sc1
    v_mfma_f32_16x16x32_bf16 a[184:187], v[136:139], a[24:27], a[184:187]
    ds_read_b64_tr_b16 v[124:125], v227 offset:33792
    v_mfma_f32_16x16x32_bf16 a[188:191], v[136:139], a[28:31], a[188:191]
    s_add_u32 s34, s34, 4096
    buffer_load_dwordx4 a[8:11], v11, s[20:23], s34 offen sc1
    v_mfma_f32_16x16x32_bf16 a[192:195], v[136:139], a[32:35], a[192:195]
    ds_read_b64_tr_b16 v[126:127], v227 offset:35904
    v_mfma_f32_16x16x32_bf16 a[196:199], v[136:139], a[36:39], a[196:199]
    s_add_u32 s35, s35, 4096
    buffer_load_dwordx4 a[12:15], v11, s[20:23], s35 offen sc1
    v_mfma_f32_16x16x32_bf16 a[200:203], v[136:139], a[40:43], a[200:203]
    v_mfma_f32_16x16x32_bf16 a[204:207], v[136:139], a[44:47], a[204:207]
    s_add_u32 s36, s36, 4096
    buffer_load_dwordx4 a[16:19], v11, s[20:23], s36 offen sc1
    v_mfma_f32_16x16x32_bf16 a[208:211], v[140:143], a[24:27], a[208:211]
    v_mfma_f32_16x16x32_bf16 a[212:215], v[140:143], a[28:31], a[212:215]
    s_add_u32 s37, s37, 4096
    buffer_load_dwordx4 a[20:23], v11, s[20:23], s37 offen sc1
    v_mfma_f32_16x16x32_bf16 a[216:219], v[140:143], a[32:35], a[216:219]
    v_mfma_f32_16x16x32_bf16 a[220:223], v[140:143], a[36:39], a[220:223]
    v_mfma_f32_16x16x32_bf16 a[224:227], v[140:143], a[40:43], a[224:227]
    v_mfma_f32_16x16x32_bf16 a[228:231], v[140:143], a[44:47], a[228:231]
    s_waitcnt vmcnt(20) lgkmcnt(0)
    v_mfma_f32_16x16x32_bf16 v[16:19], v[112:115], a[48:51], v[16:19]
    ds_read_b64_tr_b16 v[128:129], v228 offset:0
    v_mfma_f32_16x16x32_bf16 v[20:23], v[112:115], a[52:55], v[20:23]
    s_add_u32 s55, s45, 847872
    s_add_u32 m0, s88, 33792
    s_nop 0
    buffer_load_dwordx4 v246, s[84:87], s55 offen lds
    v_mfma_f32_16x16x32_bf16 v[24:27], v[112:115], a[56:59], v[24:27]
    ds_read_b64_tr_b16 v[130:131], v228 offset:2112
    v_mfma_f32_16x16x32_bf16 v[28:31], v[112:115], a[60:63], v[28:31]
    s_add_u32 m0, s88, 34848
    s_nop 0
    buffer_load_dwordx4 v247, s[84:87], s55 offen lds
    v_mfma_f32_16x16x32_bf16 v[32:35], v[112:115], a[128:131], v[32:35]
    ds_read_b64_tr_b16 v[132:133], v229 offset:0
    v_mfma_f32_16x16x32_bf16 v[36:39], v[112:115], a[132:135], v[36:39]
    s_add_u32 m0, s88, 35904
    s_nop 0
    buffer_load_dwordx4 v248, s[84:87], s55 offen lds
    v_mfma_f32_16x16x32_bf16 a[160:163], v[116:119], a[48:51], a[160:163]
    ds_read_b64_tr_b16 v[134:135], v229 offset:2112
    v_mfma_f32_16x16x32_bf16 a[164:167], v[116:119], a[52:55], a[164:167]
    s_add_u32 m0, s88, 36960
    s_nop 0
    buffer_load_dwordx4 v249, s[84:87], s55 offen lds
    v_mfma_f32_16x16x32_bf16 a[168:171], v[116:119], a[56:59], a[168:171]
    ds_read_b64_tr_b16 v[136:137], v230 offset:0
    v_mfma_f32_16x16x32_bf16 a[172:175], v[116:119], a[60:63], a[172:175]
    buffer_load_dwordx4 a[24:27], v11, s[20:23], s32 offen offset:1024 sc1
    v_mfma_f32_16x16x32_bf16 a[176:179], v[116:119], a[128:131], a[176:179]
    ds_read_b64_tr_b16 v[138:139], v230 offset:2112
    v_mfma_f32_16x16x32_bf16 a[180:183], v[116:119], a[132:135], a[180:183]
    buffer_load_dwordx4 a[28:31], v11, s[20:23], s33 offen offset:1024 sc1
    v_mfma_f32_16x16x32_bf16 a[184:187], v[120:123], a[48:51], a[184:187]
    ds_read_b64_tr_b16 v[140:141], v231 offset:0
    v_mfma_f32_16x16x32_bf16 a[188:191], v[120:123], a[52:55], a[188:191]
    buffer_load_dwordx4 a[32:35], v11, s[20:23], s34 offen offset:1024 sc1
    v_mfma_f32_16x16x32_bf16 a[192:195], v[120:123], a[56:59], a[192:195]
    ds_read_b64_tr_b16 v[142:143], v231 offset:2112
    v_mfma_f32_16x16x32_bf16 a[196:199], v[120:123], a[60:63], a[196:199]
    buffer_load_dwordx4 a[36:39], v11, s[20:23], s35 offen offset:1024 sc1
    v_mfma_f32_16x16x32_bf16 a[200:203], v[120:123], a[128:131], a[200:203]
    v_mfma_f32_16x16x32_bf16 a[204:207], v[120:123], a[132:135], a[204:207]
    buffer_load_dwordx4 a[40:43], v11, s[20:23], s36 offen offset:1024 sc1
    v_mfma_f32_16x16x32_bf16 a[208:211], v[124:127], a[48:51], a[208:211]
    v_mfma_f32_16x16x32_bf16 a[212:215], v[124:127], a[52:55], a[212:215]
    buffer_load_dwordx4 a[44:47], v11, s[20:23], s37 offen offset:1024 sc1
    v_mfma_f32_16x16x32_bf16 a[216:219], v[124:127], a[56:59], a[216:219]
    v_mfma_f32_16x16x32_bf16 a[220:223], v[124:127], a[60:63], a[220:223]
    v_mfma_f32_16x16x32_bf16 a[224:227], v[124:127], a[128:131], a[224:227]
    v_mfma_f32_16x16x32_bf16 a[228:231], v[124:127], a[132:135], a[228:231]
    s_waitcnt vmcnt(20) lgkmcnt(0)
    v_mfma_f32_16x16x32_bf16 v[16:19], v[128:131], a[136:139], v[16:19]
    ds_read_b64_tr_b16 v[112:113], v228 offset:16896
    v_mfma_f32_16x16x32_bf16 v[20:23], v[128:131], a[140:143], v[20:23]
    s_add_u32 s55, s45, 884736
    s_add_u32 m0, s88, 50688
    s_nop 0
    buffer_load_dwordx4 v246, s[84:87], s55 offen lds
    v_mfma_f32_16x16x32_bf16 v[24:27], v[128:131], a[144:147], v[24:27]
    ds_read_b64_tr_b16 v[114:115], v228 offset:19008
    v_mfma_f32_16x16x32_bf16 v[28:31], v[128:131], a[148:151], v[28:31]
    s_add_u32 m0, s88, 51744
    s_nop 0
    buffer_load_dwordx4 v247, s[84:87], s55 offen lds
    v_mfma_f32_16x16x32_bf16 v[32:35], v[128:131], a[152:155], v[32:35]
    ds_read_b64_tr_b16 v[116:117], v229 offset:16896
    v_mfma_f32_16x16x32_bf16 v[36:39], v[128:131], a[156:159], v[36:39]
    s_add_u32 m0, s88, 52800
    s_nop 0
    buffer_load_dwordx4 v248, s[84:87], s55 offen lds
    v_mfma_f32_16x16x32_bf16 a[160:163], v[132:135], a[136:139], a[160:163]
    ds_read_b64_tr_b16 v[118:119], v229 offset:19008
    v_mfma_f32_16x16x32_bf16 a[164:167], v[132:135], a[140:143], a[164:167]
    s_add_u32 m0, s88, 53856
    s_nop 0
    buffer_load_dwordx4 v249, s[84:87], s55 offen lds
    v_mfma_f32_16x16x32_bf16 a[168:171], v[132:135], a[144:147], a[168:171]
    ds_read_b64_tr_b16 v[120:121], v230 offset:16896
    v_mfma_f32_16x16x32_bf16 a[172:175], v[132:135], a[148:151], a[172:175]
    buffer_load_dwordx4 a[48:51], v11, s[20:23], s32 offen offset:2048 sc1
    v_mfma_f32_16x16x32_bf16 a[176:179], v[132:135], a[152:155], a[176:179]
    ds_read_b64_tr_b16 v[122:123], v230 offset:19008
    v_mfma_f32_16x16x32_bf16 a[180:183], v[132:135], a[156:159], a[180:183]
    buffer_load_dwordx4 a[52:55], v11, s[20:23], s33 offen offset:2048 sc1
    v_mfma_f32_16x16x32_bf16 a[184:187], v[136:139], a[136:139], a[184:187]
    ds_read_b64_tr_b16 v[124:125], v231 offset:16896
    v_mfma_f32_16x16x32_bf16 a[188:191], v[136:139], a[140:143], a[188:191]
    buffer_load_dwordx4 a[56:59], v11, s[20:23], s34 offen offset:2048 sc1
    v_mfma_f32_16x16x32_bf16 a[192:195], v[136:139], a[144:147], a[192:195]
    ds_read_b64_tr_b16 v[126:127], v231 offset:19008
    v_mfma_f32_16x16x32_bf16 a[196:199], v[136:139], a[148:151], a[196:199]
    buffer_load_dwordx4 a[60:63], v11, s[20:23], s35 offen offset:2048 sc1
    v_mfma_f32_16x16x32_bf16 a[200:203], v[136:139], a[152:155], a[200:203]
    v_mfma_f32_16x16x32_bf16 a[204:207], v[136:139], a[156:159], a[204:207]
    buffer_load_dwordx4 a[128:131], v11, s[20:23], s36 offen offset:2048 sc1
    v_mfma_f32_16x16x32_bf16 a[208:211], v[140:143], a[136:139], a[208:211]
    v_mfma_f32_16x16x32_bf16 a[212:215], v[140:143], a[140:143], a[212:215]
    buffer_load_dwordx4 a[132:135], v11, s[20:23], s37 offen offset:2048 sc1
    v_mfma_f32_16x16x32_bf16 a[216:219], v[140:143], a[144:147], a[216:219]
    v_mfma_f32_16x16x32_bf16 a[220:223], v[140:143], a[148:151], a[220:223]
    v_mfma_f32_16x16x32_bf16 a[224:227], v[140:143], a[152:155], a[224:227]
    v_mfma_f32_16x16x32_bf16 a[228:231], v[140:143], a[156:159], a[228:231]
    s_waitcnt vmcnt(20) lgkmcnt(0)
    v_mfma_f32_16x16x32_bf16 v[16:19], v[112:115], a[0:3], v[16:19]
    ds_read_b64_tr_b16 v[128:129], v228 offset:33792
    v_mfma_f32_16x16x32_bf16 v[20:23], v[112:115], a[4:7], v[20:23]
    s_add_u32 s55, s45, 921600
    s_add_u32 m0, s88, 67584
    s_nop 0
    buffer_load_dwordx4 v246, s[84:87], s55 offen lds
    v_mfma_f32_16x16x32_bf16 v[24:27], v[112:115], a[8:11], v[24:27]
    ds_read_b64_tr_b16 v[130:131], v228 offset:35904
    v_mfma_f32_16x16x32_bf16 v[28:31], v[112:115], a[12:15], v[28:31]
    s_add_u32 m0, s88, 68640
    s_nop 0
    buffer_load_dwordx4 v247, s[84:87], s55 offen lds
    v_mfma_f32_16x16x32_bf16 v[32:35], v[112:115], a[16:19], v[32:35]
    ds_read_b64_tr_b16 v[132:133], v229 offset:33792
    v_mfma_f32_16x16x32_bf16 v[36:39], v[112:115], a[20:23], v[36:39]
    s_add_u32 m0, s88, 69696
    s_nop 0
    buffer_load_dwordx4 v248, s[84:87], s55 offen lds
    v_mfma_f32_16x16x32_bf16 a[160:163], v[116:119], a[0:3], a[160:163]
    ds_read_b64_tr_b16 v[134:135], v229 offset:35904
    v_mfma_f32_16x16x32_bf16 a[164:167], v[116:119], a[4:7], a[164:167]
    s_add_u32 m0, s88, 70752
    s_nop 0
    buffer_load_dwordx4 v249, s[84:87], s55 offen lds
    v_mfma_f32_16x16x32_bf16 a[168:171], v[116:119], a[8:11], a[168:171]
    ds_read_b64_tr_b16 v[136:137], v230 offset:33792
    v_mfma_f32_16x16x32_bf16 a[172:175], v[116:119], a[12:15], a[172:175]
    buffer_load_dwordx4 a[136:139], v11, s[20:23], s32 offen offset:3072 sc1
    v_mfma_f32_16x16x32_bf16 a[176:179], v[116:119], a[16:19], a[176:179]
    ds_read_b64_tr_b16 v[138:139], v230 offset:35904
    v_mfma_f32_16x16x32_bf16 a[180:183], v[116:119], a[20:23], a[180:183]
    buffer_load_dwordx4 a[140:143], v11, s[20:23], s33 offen offset:3072 sc1
    v_mfma_f32_16x16x32_bf16 a[184:187], v[120:123], a[0:3], a[184:187]
    ds_read_b64_tr_b16 v[140:141], v231 offset:33792
    v_mfma_f32_16x16x32_bf16 a[188:191], v[120:123], a[4:7], a[188:191]
    buffer_load_dwordx4 a[144:147], v11, s[20:23], s34 offen offset:3072 sc1
    v_mfma_f32_16x16x32_bf16 a[192:195], v[120:123], a[8:11], a[192:195]
    ds_read_b64_tr_b16 v[142:143], v231 offset:35904
    v_mfma_f32_16x16x32_bf16 a[196:199], v[120:123], a[12:15], a[196:199]
    buffer_load_dwordx4 a[148:151], v11, s[20:23], s35 offen offset:3072 sc1
    v_mfma_f32_16x16x32_bf16 a[200:203], v[120:123], a[16:19], a[200:203]
    v_mfma_f32_16x16x32_bf16 a[204:207], v[120:123], a[20:23], a[204:207]
    buffer_load_dwordx4 a[152:155], v11, s[20:23], s36 offen offset:3072 sc1
    v_mfma_f32_16x16x32_bf16 a[208:211], v[124:127], a[0:3], a[208:211]
    v_mfma_f32_16x16x32_bf16 a[212:215], v[124:127], a[4:7], a[212:215]
    buffer_load_dwordx4 a[156:159], v11, s[20:23], s37 offen offset:3072 sc1
    v_mfma_f32_16x16x32_bf16 a[216:219], v[124:127], a[8:11], a[216:219]
    v_mfma_f32_16x16x32_bf16 a[220:223], v[124:127], a[12:15], a[220:223]
    v_mfma_f32_16x16x32_bf16 a[224:227], v[124:127], a[16:19], a[224:227]
    v_mfma_f32_16x16x32_bf16 a[228:231], v[124:127], a[20:23], a[228:231]
    s_waitcnt vmcnt(20) lgkmcnt(0)
    v_mfma_f32_16x16x32_bf16 v[16:19], v[128:131], a[24:27], v[16:19]
    ds_read_b64_tr_b16 v[112:113], v232 offset:0
    v_mfma_f32_16x16x32_bf16 v[20:23], v[128:131], a[28:31], v[20:23]
    s_add_u32 s55, s45, 958464
    s_add_u32 m0, s88, 84480
    s_nop 0
    buffer_load_dwordx4 v246, s[84:87], s55 offen lds
    v_mfma_f32_16x16x32_bf16 v[24:27], v[128:131], a[32:35], v[24:27]
    ds_read_b64_tr_b16 v[114:115], v232 offset:2112
    v_mfma_f32_16x16x32_bf16 v[28:31], v[128:131], a[36:39], v[28:31]
    s_add_u32 m0, s88, 85536
    s_nop 0
    buffer_load_dwordx4 v247, s[84:87], s55 offen lds
    v_mfma_f32_16x16x32_bf16 v[32:35], v[128:131], a[40:43], v[32:35]
    ds_read_b64_tr_b16 v[116:117], v233 offset:0
    v_mfma_f32_16x16x32_bf16 v[36:39], v[128:131], a[44:47], v[36:39]
    s_add_u32 m0, s88, 86592
    s_nop 0
    buffer_load_dwordx4 v248, s[84:87], s55 offen lds
    v_mfma_f32_16x16x32_bf16 a[160:163], v[132:135], a[24:27], a[160:163]
    ds_read_b64_tr_b16 v[118:119], v233 offset:2112
    v_mfma_f32_16x16x32_bf16 a[164:167], v[132:135], a[28:31], a[164:167]
    s_add_u32 m0, s88, 87648
    s_nop 0
    buffer_load_dwordx4 v249, s[84:87], s55 offen lds
    v_mfma_f32_16x16x32_bf16 a[168:171], v[132:135], a[32:35], a[168:171]
    ds_read_b64_tr_b16 v[120:121], v234 offset:0
    v_mfma_f32_16x16x32_bf16 a[172:175], v[132:135], a[36:39], a[172:175]
    s_add_u32 s32, s32, 4096
    buffer_load_dwordx4 a[0:3], v11, s[20:23], s32 offen sc1
    v_mfma_f32_16x16x32_bf16 a[176:179], v[132:135], a[40:43], a[176:179]
    ds_read_b64_tr_b16 v[122:123], v234 offset:2112
    v_mfma_f32_16x16x32_bf16 a[180:183], v[132:135], a[44:47], a[180:183]
    s_add_u32 s33, s33, 4096
    buffer_load_dwordx4 a[4:7], v11, s[20:23], s33 offen sc1
    v_mfma_f32_16x16x32_bf16 a[184:187], v[136:139], a[24:27], a[184:187]
    ds_read_b64_tr_b16 v[124:125], v235 offset:0
    v_mfma_f32_16x16x32_bf16 a[188:191], v[136:139], a[28:31], a[188:191]
    s_add_u32 s34, s34, 4096
    buffer_load_dwordx4 a[8:11], v11, s[20:23], s34 offen sc1
    v_mfma_f32_16x16x32_bf16 a[192:195], v[136:139], a[32:35], a[192:195]
    ds_read_b64_tr_b16 v[126:127], v235 offset:2112
    v_mfma_f32_16x16x32_bf16 a[196:199], v[136:139], a[36:39], a[196:199]
    s_add_u32 s35, s35, 4096
    buffer_load_dwordx4 a[12:15], v11, s[20:23], s35 offen sc1
    v_mfma_f32_16x16x32_bf16 a[200:203], v[136:139], a[40:43], a[200:203]
    v_mfma_f32_16x16x32_bf16 a[204:207], v[136:139], a[44:47], a[204:207]
    s_add_u32 s36, s36, 4096
    buffer_load_dwordx4 a[16:19], v11, s[20:23], s36 offen sc1
    v_mfma_f32_16x16x32_bf16 a[208:211], v[140:143], a[24:27], a[208:211]
    v_mfma_f32_16x16x32_bf16 a[212:215], v[140:143], a[28:31], a[212:215]
    s_add_u32 s37, s37, 4096
    buffer_load_dwordx4 a[20:23], v11, s[20:23], s37 offen sc1
    v_mfma_f32_16x16x32_bf16 a[216:219], v[140:143], a[32:35], a[216:219]
    v_mfma_f32_16x16x32_bf16 a[220:223], v[140:143], a[36:39], a[220:223]
    v_mfma_f32_16x16x32_bf16 a[224:227], v[140:143], a[40:43], a[224:227]
    v_mfma_f32_16x16x32_bf16 a[228:231], v[140:143], a[44:47], a[228:231]
    s_waitcnt vmcnt(20) lgkmcnt(0)
    v_mfma_f32_16x16x32_bf16 v[16:19], v[112:115], a[48:51], v[16:19]
    ds_read_b64_tr_b16 v[128:129], v224 offset:0
    v_mfma_f32_16x16x32_bf16 v[20:23], v[112:115], a[52:55], v[20:23]
    s_add_u32 s55, s45, 995328
    s_add_u32 m0, s88, 101376
    s_nop 0
    buffer_load_dwordx4 v246, s[84:87], s55 offen lds
    v_mfma_f32_16x16x32_bf16 v[24:27], v[112:115], a[56:59], v[24:27]
    ds_read_b64_tr_b16 v[130:131], v224 offset:2112
    v_mfma_f32_16x16x32_bf16 v[28:31], v[112:115], a[60:63], v[28:31]
    s_add_u32 m0, s88, 102432
    s_nop 0
    buffer_load_dwordx4 v247, s[84:87], s55 offen lds
    v_mfma_f32_16x16x32_bf16 v[32:35], v[112:115], a[128:131], v[32:35]
    ds_read_b64_tr_b16 v[132:133], v225 offset:0
    v_mfma_f32_16x16x32_bf16 v[36:39], v[112:115], a[132:135], v[36:39]
    s_add_u32 m0, s88, 103488
    s_nop 0
    buffer_load_dwordx4 v248, s[84:87], s55 offen lds
    v_mfma_f32_16x16x32_bf16 a[160:163], v[116:119], a[48:51], a[160:163]
    ds_read_b64_tr_b16 v[134:135], v225 offset:2112
    v_mfma_f32_16x16x32_bf16 a[164:167], v[116:119], a[52:55], a[164:167]
    s_add_u32 m0, s88, 104544
    s_nop 0
    buffer_load_dwordx4 v249, s[84:87], s55 offen lds
    v_mfma_f32_16x16x32_bf16 a[168:171], v[116:119], a[56:59], a[168:171]
    ds_read_b64_tr_b16 v[136:137], v226 offset:0
    v_mfma_f32_16x16x32_bf16 a[172:175], v[116:119], a[60:63], a[172:175]
    buffer_load_dwordx4 a[24:27], v11, s[20:23], s32 offen offset:1024 sc1
    v_mfma_f32_16x16x32_bf16 a[176:179], v[116:119], a[128:131], a[176:179]
    ds_read_b64_tr_b16 v[138:139], v226 offset:2112
    v_mfma_f32_16x16x32_bf16 a[180:183], v[116:119], a[132:135], a[180:183]
    buffer_load_dwordx4 a[28:31], v11, s[20:23], s33 offen offset:1024 sc1
    v_mfma_f32_16x16x32_bf16 a[184:187], v[120:123], a[48:51], a[184:187]
    ds_read_b64_tr_b16 v[140:141], v227 offset:0
    v_mfma_f32_16x16x32_bf16 a[188:191], v[120:123], a[52:55], a[188:191]
    buffer_load_dwordx4 a[32:35], v11, s[20:23], s34 offen offset:1024 sc1
    v_mfma_f32_16x16x32_bf16 a[192:195], v[120:123], a[56:59], a[192:195]
    ds_read_b64_tr_b16 v[142:143], v227 offset:2112
    v_mfma_f32_16x16x32_bf16 a[196:199], v[120:123], a[60:63], a[196:199]
    buffer_load_dwordx4 a[36:39], v11, s[20:23], s35 offen offset:1024 sc1
    v_mfma_f32_16x16x32_bf16 a[200:203], v[120:123], a[128:131], a[200:203]
    v_mfma_f32_16x16x32_bf16 a[204:207], v[120:123], a[132:135], a[204:207]
    buffer_load_dwordx4 a[40:43], v11, s[20:23], s36 offen offset:1024 sc1
    v_mfma_f32_16x16x32_bf16 a[208:211], v[124:127], a[48:51], a[208:211]
    v_mfma_f32_16x16x32_bf16 a[212:215], v[124:127], a[52:55], a[212:215]
    buffer_load_dwordx4 a[44:47], v11, s[20:23], s37 offen offset:1024 sc1
    v_mfma_f32_16x16x32_bf16 a[216:219], v[124:127], a[56:59], a[216:219]
    v_mfma_f32_16x16x32_bf16 a[220:223], v[124:127], a[60:63], a[220:223]
    v_mfma_f32_16x16x32_bf16 a[224:227], v[124:127], a[128:131], a[224:227]
    v_mfma_f32_16x16x32_bf16 a[228:231], v[124:127], a[132:135], a[228:231]
    s_waitcnt vmcnt(20) lgkmcnt(0)
    v_mfma_f32_16x16x32_bf16 v[16:19], v[128:131], a[136:139], v[16:19]
    ds_read_b64_tr_b16 v[112:113], v232 offset:16896
    v_mfma_f32_16x16x32_bf16 v[20:23], v[128:131], a[140:143], v[20:23]
    s_add_u32 s55, s45, 1032192
    s_add_u32 m0, s88, 0
    s_nop 0
    buffer_load_dwordx4 v246, s[84:87], s55 offen lds
    v_mfma_f32_16x16x32_bf16 v[24:27], v[128:131], a[144:147], v[24:27]
    ds_read_b64_tr_b16 v[114:115], v232 offset:19008
    v_mfma_f32_16x16x32_bf16 v[28:31], v[128:131], a[148:151], v[28:31]
    s_add_u32 m0, s88, 1056
    s_nop 0
    buffer_load_dwordx4 v247, s[84:87], s55 offen lds
    v_mfma_f32_16x16x32_bf16 v[32:35], v[128:131], a[152:155], v[32:35]
    ds_read_b64_tr_b16 v[116:117], v233 offset:16896
    v_mfma_f32_16x16x32_bf16 v[36:39], v[128:131], a[156:159], v[36:39]
    s_add_u32 m0, s88, 2112
    s_nop 0
    buffer_load_dwordx4 v248, s[84:87], s55 offen lds
    v_mfma_f32_16x16x32_bf16 a[160:163], v[132:135], a[136:139], a[160:163]
    ds_read_b64_tr_b16 v[118:119], v233 offset:19008
    v_mfma_f32_16x16x32_bf16 a[164:167], v[132:135], a[140:143], a[164:167]
    s_add_u32 m0, s88, 3168
    s_nop 0
    buffer_load_dwordx4 v249, s[84:87], s55 offen lds
    v_mfma_f32_16x16x32_bf16 a[168:171], v[132:135], a[144:147], a[168:171]
    ds_read_b64_tr_b16 v[120:121], v234 offset:16896
    v_mfma_f32_16x16x32_bf16 a[172:175], v[132:135], a[148:151], a[172:175]
    buffer_load_dwordx4 a[48:51], v11, s[20:23], s32 offen offset:2048 sc1
    v_mfma_f32_16x16x32_bf16 a[176:179], v[132:135], a[152:155], a[176:179]
    ds_read_b64_tr_b16 v[122:123], v234 offset:19008
    v_mfma_f32_16x16x32_bf16 a[180:183], v[132:135], a[156:159], a[180:183]
    buffer_load_dwordx4 a[52:55], v11, s[20:23], s33 offen offset:2048 sc1
    v_mfma_f32_16x16x32_bf16 a[184:187], v[136:139], a[136:139], a[184:187]
    ds_read_b64_tr_b16 v[124:125], v235 offset:16896
    v_mfma_f32_16x16x32_bf16 a[188:191], v[136:139], a[140:143], a[188:191]
    buffer_load_dwordx4 a[56:59], v11, s[20:23], s34 offen offset:2048 sc1
    v_mfma_f32_16x16x32_bf16 a[192:195], v[136:139], a[144:147], a[192:195]
    ds_read_b64_tr_b16 v[126:127], v235 offset:19008
    v_mfma_f32_16x16x32_bf16 a[196:199], v[136:139], a[148:151], a[196:199]
    buffer_load_dwordx4 a[60:63], v11, s[20:23], s35 offen offset:2048 sc1
    v_mfma_f32_16x16x32_bf16 a[200:203], v[136:139], a[152:155], a[200:203]
    v_mfma_f32_16x16x32_bf16 a[204:207], v[136:139], a[156:159], a[204:207]
    buffer_load_dwordx4 a[128:131], v11, s[20:23], s36 offen offset:2048 sc1
    v_mfma_f32_16x16x32_bf16 a[208:211], v[140:143], a[136:139], a[208:211]
    v_mfma_f32_16x16x32_bf16 a[212:215], v[140:143], a[140:143], a[212:215]
    buffer_load_dwordx4 a[132:135], v11, s[20:23], s37 offen offset:2048 sc1
    v_mfma_f32_16x16x32_bf16 a[216:219], v[140:143], a[144:147], a[216:219]
    v_mfma_f32_16x16x32_bf16 a[220:223], v[140:143], a[148:151], a[220:223]
    v_mfma_f32_16x16x32_bf16 a[224:227], v[140:143], a[152:155], a[224:227]
    v_mfma_f32_16x16x32_bf16 a[228:231], v[140:143], a[156:159], a[228:231]
    s_waitcnt vmcnt(20) lgkmcnt(0)
    v_mfma_f32_16x16x32_bf16 v[16:19], v[112:115], a[0:3], v[16:19]
    ds_read_b64_tr_b16 v[128:129], v232 offset:33792
    v_mfma_f32_16x16x32_bf16 v[20:23], v[112:115], a[4:7], v[20:23]
    s_add_u32 s55, s45, 1069056
    s_add_u32 m0, s88, 118272
    s_nop 0
    buffer_load_dwordx4 v246, s[84:87], s55 offen lds
    v_mfma_f32_16x16x32_bf16 v[24:27], v[112:115], a[8:11], v[24:27]
    ds_read_b64_tr_b16 v[130:131], v232 offset:35904
    v_mfma_f32_16x16x32_bf16 v[28:31], v[112:115], a[12:15], v[28:31]
    s_add_u32 m0, s88, 119328
    s_nop 0
    buffer_load_dwordx4 v247, s[84:87], s55 offen lds
    v_mfma_f32_16x16x32_bf16 v[32:35], v[112:115], a[16:19], v[32:35]
    ds_read_b64_tr_b16 v[132:133], v233 offset:33792
    v_mfma_f32_16x16x32_bf16 v[36:39], v[112:115], a[20:23], v[36:39]
    s_add_u32 m0, s88, 120384
    s_nop 0
    buffer_load_dwordx4 v248, s[84:87], s55 offen lds
    v_mfma_f32_16x16x32_bf16 a[160:163], v[116:119], a[0:3], a[160:163]
    ds_read_b64_tr_b16 v[134:135], v233 offset:35904
    v_mfma_f32_16x16x32_bf16 a[164:167], v[116:119], a[4:7], a[164:167]
    s_add_u32 m0, s88, 121440
    s_nop 0
    buffer_load_dwordx4 v249, s[84:87], s55 offen lds
    v_mfma_f32_16x16x32_bf16 a[168:171], v[116:119], a[8:11], a[168:171]
    ds_read_b64_tr_b16 v[136:137], v234 offset:33792
    v_mfma_f32_16x16x32_bf16 a[172:175], v[116:119], a[12:15], a[172:175]
    buffer_load_dwordx4 a[136:139], v11, s[20:23], s32 offen offset:3072 sc1
    v_mfma_f32_16x16x32_bf16 a[176:179], v[116:119], a[16:19], a[176:179]
    ds_read_b64_tr_b16 v[138:139], v234 offset:35904
    v_mfma_f32_16x16x32_bf16 a[180:183], v[116:119], a[20:23], a[180:183]
    buffer_load_dwordx4 a[140:143], v11, s[20:23], s33 offen offset:3072 sc1
    v_mfma_f32_16x16x32_bf16 a[184:187], v[120:123], a[0:3], a[184:187]
    ds_read_b64_tr_b16 v[140:141], v235 offset:33792
    v_mfma_f32_16x16x32_bf16 a[188:191], v[120:123], a[4:7], a[188:191]
    buffer_load_dwordx4 a[144:147], v11, s[20:23], s34 offen offset:3072 sc1
    v_mfma_f32_16x16x32_bf16 a[192:195], v[120:123], a[8:11], a[192:195]
    ds_read_b64_tr_b16 v[142:143], v235 offset:35904
    v_mfma_f32_16x16x32_bf16 a[196:199], v[120:123], a[12:15], a[196:199]
    buffer_load_dwordx4 a[148:151], v11, s[20:23], s35 offen offset:3072 sc1
    v_mfma_f32_16x16x32_bf16 a[200:203], v[120:123], a[16:19], a[200:203]
    v_mfma_f32_16x16x32_bf16 a[204:207], v[120:123], a[20:23], a[204:207]
    buffer_load_dwordx4 a[152:155], v11, s[20:23], s36 offen offset:3072 sc1
    v_mfma_f32_16x16x32_bf16 a[208:211], v[124:127], a[0:3], a[208:211]
    v_mfma_f32_16x16x32_bf16 a[212:215], v[124:127], a[4:7], a[212:215]
    buffer_load_dwordx4 a[156:159], v11, s[20:23], s37 offen offset:3072 sc1
    v_mfma_f32_16x16x32_bf16 a[216:219], v[124:127], a[8:11], a[216:219]
    v_mfma_f32_16x16x32_bf16 a[220:223], v[124:127], a[12:15], a[220:223]
    v_mfma_f32_16x16x32_bf16 a[224:227], v[124:127], a[16:19], a[224:227]
    v_mfma_f32_16x16x32_bf16 a[228:231], v[124:127], a[20:23], a[228:231]
    s_waitcnt vmcnt(20) lgkmcnt(0)
    v_mfma_f32_16x16x32_bf16 v[16:19], v[128:131], a[24:27], v[16:19]
    ds_read_b64_tr_b16 v[112:113], v224 offset:16896
    v_mfma_f32_16x16x32_bf16 v[20:23], v[128:131], a[28:31], v[20:23]
    s_add_u32 s55, s45, 1105920
    s_add_u32 m0, s88, 135168
    s_nop 0
    buffer_load_dwordx4 v246, s[84:87], s55 offen lds
    v_mfma_f32_16x16x32_bf16 v[24:27], v[128:131], a[32:35], v[24:27]
    ds_read_b64_tr_b16 v[114:115], v224 offset:19008
    v_mfma_f32_16x16x32_bf16 v[28:31], v[128:131], a[36:39], v[28:31]
    s_add_u32 m0, s88, 136224
    s_nop 0
    buffer_load_dwordx4 v247, s[84:87], s55 offen lds
    v_mfma_f32_16x16x32_bf16 v[32:35], v[128:131], a[40:43], v[32:35]
    ds_read_b64_tr_b16 v[116:117], v225 offset:16896
    v_mfma_f32_16x16x32_bf16 v[36:39], v[128:131], a[44:47], v[36:39]
    s_add_u32 m0, s88, 137280
    s_nop 0
    buffer_load_dwordx4 v248, s[84:87], s55 offen lds
    v_mfma_f32_16x16x32_bf16 a[160:163], v[132:135], a[24:27], a[160:163]
    ds_read_b64_tr_b16 v[118:119], v225 offset:19008
    v_mfma_f32_16x16x32_bf16 a[164:167], v[132:135], a[28:31], a[164:167]
    s_add_u32 m0, s88, 138336
    s_nop 0
    buffer_load_dwordx4 v249, s[84:87], s55 offen lds
    v_mfma_f32_16x16x32_bf16 a[168:171], v[132:135], a[32:35], a[168:171]
    ds_read_b64_tr_b16 v[120:121], v226 offset:16896
    v_mfma_f32_16x16x32_bf16 a[172:175], v[132:135], a[36:39], a[172:175]
    s_add_u32 s32, s32, 4096
    buffer_load_dwordx4 a[0:3], v11, s[20:23], s32 offen sc1
    v_mfma_f32_16x16x32_bf16 a[176:179], v[132:135], a[40:43], a[176:179]
    ds_read_b64_tr_b16 v[122:123], v226 offset:19008
    v_mfma_f32_16x16x32_bf16 a[180:183], v[132:135], a[44:47], a[180:183]
    s_add_u32 s33, s33, 4096
    buffer_load_dwordx4 a[4:7], v11, s[20:23], s33 offen sc1
    v_mfma_f32_16x16x32_bf16 a[184:187], v[136:139], a[24:27], a[184:187]
    ds_read_b64_tr_b16 v[124:125], v227 offset:16896
    v_mfma_f32_16x16x32_bf16 a[188:191], v[136:139], a[28:31], a[188:191]
    s_add_u32 s34, s34, 4096
    buffer_load_dwordx4 a[8:11], v11, s[20:23], s34 offen sc1
    v_mfma_f32_16x16x32_bf16 a[192:195], v[136:139], a[32:35], a[192:195]
    ds_read_b64_tr_b16 v[126:127], v227 offset:19008
    v_mfma_f32_16x16x32_bf16 a[196:199], v[136:139], a[36:39], a[196:199]
    s_add_u32 s35, s35, 4096
    buffer_load_dwordx4 a[12:15], v11, s[20:23], s35 offen sc1
    v_mfma_f32_16x16x32_bf16 a[200:203], v[136:139], a[40:43], a[200:203]
    v_mfma_f32_16x16x32_bf16 a[204:207], v[136:139], a[44:47], a[204:207]
    s_add_u32 s36, s36, 4096
    buffer_load_dwordx4 a[16:19], v11, s[20:23], s36 offen sc1
    v_mfma_f32_16x16x32_bf16 a[208:211], v[140:143], a[24:27], a[208:211]
    v_mfma_f32_16x16x32_bf16 a[212:215], v[140:143], a[28:31], a[212:215]
    s_add_u32 s37, s37, 4096
    buffer_load_dwordx4 a[20:23], v11, s[20:23], s37 offen sc1
    v_mfma_f32_16x16x32_bf16 a[216:219], v[140:143], a[32:35], a[216:219]
    v_mfma_f32_16x16x32_bf16 a[220:223], v[140:143], a[36:39], a[220:223]
    v_mfma_f32_16x16x32_bf16 a[224:227], v[140:143], a[40:43], a[224:227]
    v_mfma_f32_16x16x32_bf16 a[228:231], v[140:143], a[44:47], a[228:231]
    s_waitcnt vmcnt(20) lgkmcnt(0)
    v_mfma_f32_16x16x32_bf16 v[16:19], v[112:115], a[48:51], v[16:19]
    ds_read_b64_tr_b16 v[128:129], v224 offset:33792
    v_mfma_f32_16x16x32_bf16 v[20:23], v[112:115], a[52:55], v[20:23]
    s_add_u32 s55, s45, 1142784
    s_add_u32 m0, s88, 16896
    s_nop 0
    buffer_load_dwordx4 v246, s[84:87], s55 offen lds
    v_mfma_f32_16x16x32_bf16 v[24:27], v[112:115], a[56:59], v[24:27]
    ds_read_b64_tr_b16 v[130:131], v224 offset:35904
    v_mfma_f32_16x16x32_bf16 v[28:31], v[112:115], a[60:63], v[28:31]
    s_add_u32 m0, s88, 17952
    s_nop 0
    buffer_load_dwordx4 v247, s[84:87], s55 offen lds
    v_mfma_f32_16x16x32_bf16 v[32:35], v[112:115], a[128:131], v[32:35]
    ds_read_b64_tr_b16 v[132:133], v225 offset:33792
    v_mfma_f32_16x16x32_bf16 v[36:39], v[112:115], a[132:135], v[36:39]
    s_add_u32 m0, s88, 19008
    s_nop 0
    buffer_load_dwordx4 v248, s[84:87], s55 offen lds
    v_mfma_f32_16x16x32_bf16 a[160:163], v[116:119], a[48:51], a[160:163]
    ds_read_b64_tr_b16 v[134:135], v225 offset:35904
    v_mfma_f32_16x16x32_bf16 a[164:167], v[116:119], a[52:55], a[164:167]
    s_add_u32 m0, s88, 20064
    s_nop 0
    buffer_load_dwordx4 v249, s[84:87], s55 offen lds
    v_mfma_f32_16x16x32_bf16 a[168:171], v[116:119], a[56:59], a[168:171]
    ds_read_b64_tr_b16 v[136:137], v226 offset:33792
    v_mfma_f32_16x16x32_bf16 a[172:175], v[116:119], a[60:63], a[172:175]
    buffer_load_dwordx4 a[24:27], v11, s[20:23], s32 offen offset:1024 sc1
    v_mfma_f32_16x16x32_bf16 a[176:179], v[116:119], a[128:131], a[176:179]
    ds_read_b64_tr_b16 v[138:139], v226 offset:35904
    v_mfma_f32_16x16x32_bf16 a[180:183], v[116:119], a[132:135], a[180:183]
    buffer_load_dwordx4 a[28:31], v11, s[20:23], s33 offen offset:1024 sc1
    v_mfma_f32_16x16x32_bf16 a[184:187], v[120:123], a[48:51], a[184:187]
    ds_read_b64_tr_b16 v[140:141], v227 offset:33792
    v_mfma_f32_16x16x32_bf16 a[188:191], v[120:123], a[52:55], a[188:191]
    buffer_load_dwordx4 a[32:35], v11, s[20:23], s34 offen offset:1024 sc1
    v_mfma_f32_16x16x32_bf16 a[192:195], v[120:123], a[56:59], a[192:195]
    ds_read_b64_tr_b16 v[142:143], v227 offset:35904
    v_mfma_f32_16x16x32_bf16 a[196:199], v[120:123], a[60:63], a[196:199]
    buffer_load_dwordx4 a[36:39], v11, s[20:23], s35 offen offset:1024 sc1
    v_mfma_f32_16x16x32_bf16 a[200:203], v[120:123], a[128:131], a[200:203]
    v_mfma_f32_16x16x32_bf16 a[204:207], v[120:123], a[132:135], a[204:207]
    buffer_load_dwordx4 a[40:43], v11, s[20:23], s36 offen offset:1024 sc1
    v_mfma_f32_16x16x32_bf16 a[208:211], v[124:127], a[48:51], a[208:211]
    v_mfma_f32_16x16x32_bf16 a[212:215], v[124:127], a[52:55], a[212:215]
    buffer_load_dwordx4 a[44:47], v11, s[20:23], s37 offen offset:1024 sc1
    v_mfma_f32_16x16x32_bf16 a[216:219], v[124:127], a[56:59], a[216:219]
    v_mfma_f32_16x16x32_bf16 a[220:223], v[124:127], a[60:63], a[220:223]
    v_mfma_f32_16x16x32_bf16 a[224:227], v[124:127], a[128:131], a[224:227]
    v_mfma_f32_16x16x32_bf16 a[228:231], v[124:127], a[132:135], a[228:231]
    s_waitcnt vmcnt(20) lgkmcnt(0)
    v_mfma_f32_16x16x32_bf16 v[16:19], v[128:131], a[136:139], v[16:19]
    ds_read_b64_tr_b16 v[112:113], v228 offset:0
    v_mfma_f32_16x16x32_bf16 v[20:23], v[128:131], a[140:143], v[20:23]
    buffer_load_dwordx4 a[48:51], v11, s[20:23], s32 offen offset:2048 sc1
    v_mfma_f32_16x16x32_bf16 v[24:27], v[128:131], a[144:147], v[24:27]
    ds_read_b64_tr_b16 v[114:115], v228 offset:2112
    v_mfma_f32_16x16x32_bf16 v[28:31], v[128:131], a[148:151], v[28:31]
    buffer_load_dwordx4 a[52:55], v11, s[20:23], s33 offen offset:2048 sc1
    v_mfma_f32_16x16x32_bf16 v[32:35], v[128:131], a[152:155], v[32:35]
    ds_read_b64_tr_b16 v[116:117], v229 offset:0
    v_mfma_f32_16x16x32_bf16 v[36:39], v[128:131], a[156:159], v[36:39]
    buffer_load_dwordx4 a[56:59], v11, s[20:23], s34 offen offset:2048 sc1
    v_mfma_f32_16x16x32_bf16 a[160:163], v[132:135], a[136:139], a[160:163]
    ds_read_b64_tr_b16 v[118:119], v229 offset:2112
    v_mfma_f32_16x16x32_bf16 a[164:167], v[132:135], a[140:143], a[164:167]
    buffer_load_dwordx4 a[60:63], v11, s[20:23], s35 offen offset:2048 sc1
    v_mfma_f32_16x16x32_bf16 a[168:171], v[132:135], a[144:147], a[168:171]
    ds_read_b64_tr_b16 v[120:121], v230 offset:0
    v_mfma_f32_16x16x32_bf16 a[172:175], v[132:135], a[148:151], a[172:175]
    buffer_load_dwordx4 a[128:131], v11, s[20:23], s36 offen offset:2048 sc1
    v_mfma_f32_16x16x32_bf16 a[176:179], v[132:135], a[152:155], a[176:179]
    ds_read_b64_tr_b16 v[122:123], v230 offset:2112
    v_mfma_f32_16x16x32_bf16 a[180:183], v[132:135], a[156:159], a[180:183]
    buffer_load_dwordx4 a[132:135], v11, s[20:23], s37 offen offset:2048 sc1
    v_mfma_f32_16x16x32_bf16 a[184:187], v[136:139], a[136:139], a[184:187]
    ds_read_b64_tr_b16 v[124:125], v231 offset:0
    v_mfma_f32_16x16x32_bf16 a[188:191], v[136:139], a[140:143], a[188:191]
    v_mfma_f32_16x16x32_bf16 a[192:195], v[136:139], a[144:147], a[192:195]
    ds_read_b64_tr_b16 v[126:127], v231 offset:2112
    v_mfma_f32_16x16x32_bf16 a[196:199], v[136:139], a[148:151], a[196:199]
    v_mfma_f32_16x16x32_bf16 a[200:203], v[136:139], a[152:155], a[200:203]
    v_mfma_f32_16x16x32_bf16 a[204:207], v[136:139], a[156:159], a[204:207]
    v_mfma_f32_16x16x32_bf16 a[208:211], v[140:143], a[136:139], a[208:211]
    v_mfma_f32_16x16x32_bf16 a[212:215], v[140:143], a[140:143], a[212:215]
    v_mfma_f32_16x16x32_bf16 a[216:219], v[140:143], a[144:147], a[216:219]
    v_mfma_f32_16x16x32_bf16 a[220:223], v[140:143], a[148:151], a[220:223]
    v_mfma_f32_16x16x32_bf16 a[224:227], v[140:143], a[152:155], a[224:227]
    v_mfma_f32_16x16x32_bf16 a[228:231], v[140:143], a[156:159], a[228:231]
    s_waitcnt vmcnt(16) lgkmcnt(0)
    v_mfma_f32_16x16x32_bf16 v[16:19], v[112:115], a[0:3], v[16:19]
    ds_read_b64_tr_b16 v[128:129], v228 offset:16896
    v_mfma_f32_16x16x32_bf16 v[20:23], v[112:115], a[4:7], v[20:23]
    buffer_load_dwordx4 a[136:139], v11, s[20:23], s32 offen offset:3072 sc1
    v_mfma_f32_16x16x32_bf16 v[24:27], v[112:115], a[8:11], v[24:27]
    ds_read_b64_tr_b16 v[130:131], v228 offset:19008
    v_mfma_f32_16x16x32_bf16 v[28:31], v[112:115], a[12:15], v[28:31]
    buffer_load_dwordx4 a[140:143], v11, s[20:23], s33 offen offset:3072 sc1
    v_mfma_f32_16x16x32_bf16 v[32:35], v[112:115], a[16:19], v[32:35]
    ds_read_b64_tr_b16 v[132:133], v229 offset:16896
    v_mfma_f32_16x16x32_bf16 v[36:39], v[112:115], a[20:23], v[36:39]
    buffer_load_dwordx4 a[144:147], v11, s[20:23], s34 offen offset:3072 sc1
    v_mfma_f32_16x16x32_bf16 a[160:163], v[116:119], a[0:3], a[160:163]
    ds_read_b64_tr_b16 v[134:135], v229 offset:19008
    v_mfma_f32_16x16x32_bf16 a[164:167], v[116:119], a[4:7], a[164:167]
    buffer_load_dwordx4 a[148:151], v11, s[20:23], s35 offen offset:3072 sc1
    v_mfma_f32_16x16x32_bf16 a[168:171], v[116:119], a[8:11], a[168:171]
    ds_read_b64_tr_b16 v[136:137], v230 offset:16896
    v_mfma_f32_16x16x32_bf16 a[172:175], v[116:119], a[12:15], a[172:175]
    buffer_load_dwordx4 a[152:155], v11, s[20:23], s36 offen offset:3072 sc1
    v_mfma_f32_16x16x32_bf16 a[176:179], v[116:119], a[16:19], a[176:179]
    ds_read_b64_tr_b16 v[138:139], v230 offset:19008
    v_mfma_f32_16x16x32_bf16 a[180:183], v[116:119], a[20:23], a[180:183]
    buffer_load_dwordx4 a[156:159], v11, s[20:23], s37 offen offset:3072 sc1
    v_mfma_f32_16x16x32_bf16 a[184:187], v[120:123], a[0:3], a[184:187]
    ds_read_b64_tr_b16 v[140:141], v231 offset:16896
    v_mfma_f32_16x16x32_bf16 a[188:191], v[120:123], a[4:7], a[188:191]
    v_mfma_f32_16x16x32_bf16 a[192:195], v[120:123], a[8:11], a[192:195]
    ds_read_b64_tr_b16 v[142:143], v231 offset:19008
    v_mfma_f32_16x16x32_bf16 a[196:199], v[120:123], a[12:15], a[196:199]
    v_mfma_f32_16x16x32_bf16 a[200:203], v[120:123], a[16:19], a[200:203]
    v_mfma_f32_16x16x32_bf16 a[204:207], v[120:123], a[20:23], a[204:207]
    v_mfma_f32_16x16x32_bf16 a[208:211], v[124:127], a[0:3], a[208:211]
    v_mfma_f32_16x16x32_bf16 a[212:215], v[124:127], a[4:7], a[212:215]
    v_mfma_f32_16x16x32_bf16 a[216:219], v[124:127], a[8:11], a[216:219]
    v_mfma_f32_16x16x32_bf16 a[220:223], v[124:127], a[12:15], a[220:223]
    v_mfma_f32_16x16x32_bf16 a[224:227], v[124:127], a[16:19], a[224:227]
    v_mfma_f32_16x16x32_bf16 a[228:231], v[124:127], a[20:23], a[228:231]
    s_waitcnt vmcnt(12) lgkmcnt(0)
    v_mfma_f32_16x16x32_bf16 v[16:19], v[128:131], a[24:27], v[16:19]
    ds_read_b64_tr_b16 v[112:113], v228 offset:33792
    v_mfma_f32_16x16x32_bf16 v[20:23], v[128:131], a[28:31], v[20:23]
    s_add_u32 s32, s32, 4096
    buffer_load_dwordx4 a[0:3], v11, s[20:23], s32 offen sc1
    v_mfma_f32_16x16x32_bf16 v[24:27], v[128:131], a[32:35], v[24:27]
    ds_read_b64_tr_b16 v[114:115], v228 offset:35904
    v_mfma_f32_16x16x32_bf16 v[28:31], v[128:131], a[36:39], v[28:31]
    s_add_u32 s33, s33, 4096
    buffer_load_dwordx4 a[4:7], v11, s[20:23], s33 offen sc1
    v_mfma_f32_16x16x32_bf16 v[32:35], v[128:131], a[40:43], v[32:35]
    ds_read_b64_tr_b16 v[116:117], v229 offset:33792
    v_mfma_f32_16x16x32_bf16 v[36:39], v[128:131], a[44:47], v[36:39]
    s_add_u32 s34, s34, 4096
    buffer_load_dwordx4 a[8:11], v11, s[20:23], s34 offen sc1
    v_mfma_f32_16x16x32_bf16 a[160:163], v[132:135], a[24:27], a[160:163]
    ds_read_b64_tr_b16 v[118:119], v229 offset:35904
    v_mfma_f32_16x16x32_bf16 a[164:167], v[132:135], a[28:31], a[164:167]
    s_add_u32 s35, s35, 4096
    buffer_load_dwordx4 a[12:15], v11, s[20:23], s35 offen sc1
    v_mfma_f32_16x16x32_bf16 a[168:171], v[132:135], a[32:35], a[168:171]
    ds_read_b64_tr_b16 v[120:121], v230 offset:33792
    v_mfma_f32_16x16x32_bf16 a[172:175], v[132:135], a[36:39], a[172:175]
    s_add_u32 s36, s36, 4096
    buffer_load_dwordx4 a[16:19], v11, s[20:23], s36 offen sc1
    v_mfma_f32_16x16x32_bf16 a[176:179], v[132:135], a[40:43], a[176:179]
    ds_read_b64_tr_b16 v[122:123], v230 offset:35904
    v_mfma_f32_16x16x32_bf16 a[180:183], v[132:135], a[44:47], a[180:183]
    s_add_u32 s37, s37, 4096
    buffer_load_dwordx4 a[20:23], v11, s[20:23], s37 offen sc1
    v_mfma_f32_16x16x32_bf16 a[184:187], v[136:139], a[24:27], a[184:187]
    ds_read_b64_tr_b16 v[124:125], v231 offset:33792
    v_mfma_f32_16x16x32_bf16 a[188:191], v[136:139], a[28:31], a[188:191]
    v_mfma_f32_16x16x32_bf16 a[192:195], v[136:139], a[32:35], a[192:195]
    ds_read_b64_tr_b16 v[126:127], v231 offset:35904
    v_mfma_f32_16x16x32_bf16 a[196:199], v[136:139], a[36:39], a[196:199]
    v_mfma_f32_16x16x32_bf16 a[200:203], v[136:139], a[40:43], a[200:203]
    v_mfma_f32_16x16x32_bf16 a[204:207], v[136:139], a[44:47], a[204:207]
    v_mfma_f32_16x16x32_bf16 a[208:211], v[140:143], a[24:27], a[208:211]
    v_mfma_f32_16x16x32_bf16 a[212:215], v[140:143], a[28:31], a[212:215]
    v_mfma_f32_16x16x32_bf16 a[216:219], v[140:143], a[32:35], a[216:219]
    v_mfma_f32_16x16x32_bf16 a[220:223], v[140:143], a[36:39], a[220:223]
    v_mfma_f32_16x16x32_bf16 a[224:227], v[140:143], a[40:43], a[224:227]
    v_mfma_f32_16x16x32_bf16 a[228:231], v[140:143], a[44:47], a[228:231]
    s_waitcnt vmcnt(12) lgkmcnt(0)
    v_mfma_f32_16x16x32_bf16 v[16:19], v[112:115], a[48:51], v[16:19]
    ds_read_b64_tr_b16 v[128:129], v232 offset:0
    v_mfma_f32_16x16x32_bf16 v[20:23], v[112:115], a[52:55], v[20:23]
    buffer_load_dwordx4 a[24:27], v11, s[20:23], s32 offen offset:1024 sc1
    v_mfma_f32_16x16x32_bf16 v[24:27], v[112:115], a[56:59], v[24:27]
    ds_read_b64_tr_b16 v[130:131], v232 offset:2112
    v_mfma_f32_16x16x32_bf16 v[28:31], v[112:115], a[60:63], v[28:31]
    buffer_load_dwordx4 a[28:31], v11, s[20:23], s33 offen offset:1024 sc1
    v_mfma_f32_16x16x32_bf16 v[32:35], v[112:115], a[128:131], v[32:35]
    ds_read_b64_tr_b16 v[132:133], v233 offset:0
    v_mfma_f32_16x16x32_bf16 v[36:39], v[112:115], a[132:135], v[36:39]
    buffer_load_dwordx4 a[32:35], v11, s[20:23], s34 offen offset:1024 sc1
    v_mfma_f32_16x16x32_bf16 a[160:163], v[116:119], a[48:51], a[160:163]
    ds_read_b64_tr_b16 v[134:135], v233 offset:2112
    v_mfma_f32_16x16x32_bf16 a[164:167], v[116:119], a[52:55], a[164:167]
    buffer_load_dwordx4 a[36:39], v11, s[20:23], s35 offen offset:1024 sc1
    v_mfma_f32_16x16x32_bf16 a[168:171], v[116:119], a[56:59], a[168:171]
    ds_read_b64_tr_b16 v[136:137], v234 offset:0
    v_mfma_f32_16x16x32_bf16 a[172:175], v[116:119], a[60:63], a[172:175]
    buffer_load_dwordx4 a[40:43], v11, s[20:23], s36 offen offset:1024 sc1
    v_mfma_f32_16x16x32_bf16 a[176:179], v[116:119], a[128:131], a[176:179]
    ds_read_b64_tr_b16 v[138:139], v234 offset:2112
    v_mfma_f32_16x16x32_bf16 a[180:183], v[116:119], a[132:135], a[180:183]
    buffer_load_dwordx4 a[44:47], v11, s[20:23], s37 offen offset:1024 sc1
    v_mfma_f32_16x16x32_bf16 a[184:187], v[120:123], a[48:51], a[184:187]
    ds_read_b64_tr_b16 v[140:141], v235 offset:0
    v_mfma_f32_16x16x32_bf16 a[188:191], v[120:123], a[52:55], a[188:191]
    v_mfma_f32_16x16x32_bf16 a[192:195], v[120:123], a[56:59], a[192:195]
    ds_read_b64_tr_b16 v[142:143], v235 offset:2112
    v_mfma_f32_16x16x32_bf16 a[196:199], v[120:123], a[60:63], a[196:199]
    v_mfma_f32_16x16x32_bf16 a[200:203], v[120:123], a[128:131], a[200:203]
    v_mfma_f32_16x16x32_bf16 a[204:207], v[120:123], a[132:135], a[204:207]
    v_mfma_f32_16x16x32_bf16 a[208:211], v[124:127], a[48:51], a[208:211]
    v_mfma_f32_16x16x32_bf16 a[212:215], v[124:127], a[52:55], a[212:215]
    v_mfma_f32_16x16x32_bf16 a[216:219], v[124:127], a[56:59], a[216:219]
    v_mfma_f32_16x16x32_bf16 a[220:223], v[124:127], a[60:63], a[220:223]
    v_mfma_f32_16x16x32_bf16 a[224:227], v[124:127], a[128:131], a[224:227]
    v_mfma_f32_16x16x32_bf16 a[228:231], v[124:127], a[132:135], a[228:231]
    s_waitcnt vmcnt(12) lgkmcnt(0)
    v_mfma_f32_16x16x32_bf16 v[16:19], v[128:131], a[136:139], v[16:19]
    ds_read_b64_tr_b16 v[112:113], v224 offset:0
    v_mfma_f32_16x16x32_bf16 v[20:23], v[128:131], a[140:143], v[20:23]
    buffer_load_dwordx4 a[48:51], v11, s[20:23], s32 offen offset:2048 sc1
    v_mfma_f32_16x16x32_bf16 v[24:27], v[128:131], a[144:147], v[24:27]
    ds_read_b64_tr_b16 v[114:115], v224 offset:2112
    v_mfma_f32_16x16x32_bf16 v[28:31], v[128:131], a[148:151], v[28:31]
    buffer_load_dwordx4 a[52:55], v11, s[20:23], s33 offen offset:2048 sc1
    v_mfma_f32_16x16x32_bf16 v[32:35], v[128:131], a[152:155], v[32:35]
    ds_read_b64_tr_b16 v[116:117], v225 offset:0
    v_mfma_f32_16x16x32_bf16 v[36:39], v[128:131], a[156:159], v[36:39]
    buffer_load_dwordx4 a[56:59], v11, s[20:23], s34 offen offset:2048 sc1
    v_mfma_f32_16x16x32_bf16 a[160:163], v[132:135], a[136:139], a[160:163]
    ds_read_b64_tr_b16 v[118:119], v225 offset:2112
    v_mfma_f32_16x16x32_bf16 a[164:167], v[132:135], a[140:143], a[164:167]
    buffer_load_dwordx4 a[60:63], v11, s[20:23], s35 offen offset:2048 sc1
    v_mfma_f32_16x16x32_bf16 a[168:171], v[132:135], a[144:147], a[168:171]
    ds_read_b64_tr_b16 v[120:121], v226 offset:0
    v_mfma_f32_16x16x32_bf16 a[172:175], v[132:135], a[148:151], a[172:175]
    buffer_load_dwordx4 a[128:131], v11, s[20:23], s36 offen offset:2048 sc1
    v_mfma_f32_16x16x32_bf16 a[176:179], v[132:135], a[152:155], a[176:179]
    ds_read_b64_tr_b16 v[122:123], v226 offset:2112
    v_mfma_f32_16x16x32_bf16 a[180:183], v[132:135], a[156:159], a[180:183]
    buffer_load_dwordx4 a[132:135], v11, s[20:23], s37 offen offset:2048 sc1
    v_mfma_f32_16x16x32_bf16 a[184:187], v[136:139], a[136:139], a[184:187]
    ds_read_b64_tr_b16 v[124:125], v227 offset:0
    v_mfma_f32_16x16x32_bf16 a[188:191], v[136:139], a[140:143], a[188:191]
    v_mfma_f32_16x16x32_bf16 a[192:195], v[136:139], a[144:147], a[192:195]
    ds_read_b64_tr_b16 v[126:127], v227 offset:2112
    v_mfma_f32_16x16x32_bf16 a[196:199], v[136:139], a[148:151], a[196:199]
    v_mfma_f32_16x16x32_bf16 a[200:203], v[136:139], a[152:155], a[200:203]
    v_mfma_f32_16x16x32_bf16 a[204:207], v[136:139], a[156:159], a[204:207]
    v_mfma_f32_16x16x32_bf16 a[208:211], v[140:143], a[136:139], a[208:211]
    v_mfma_f32_16x16x32_bf16 a[212:215], v[140:143], a[140:143], a[212:215]
    v_mfma_f32_16x16x32_bf16 a[216:219], v[140:143], a[144:147], a[216:219]
    v_mfma_f32_16x16x32_bf16 a[220:223], v[140:143], a[148:151], a[220:223]
    v_mfma_f32_16x16x32_bf16 a[224:227], v[140:143], a[152:155], a[224:227]
    v_mfma_f32_16x16x32_bf16 a[228:231], v[140:143], a[156:159], a[228:231]
    s_waitcnt vmcnt(12) lgkmcnt(0)
    v_mfma_f32_16x16x32_bf16 v[16:19], v[112:115], a[0:3], v[16:19]
    ds_read_b64_tr_b16 v[128:129], v232 offset:16896
    v_mfma_f32_16x16x32_bf16 v[20:23], v[112:115], a[4:7], v[20:23]
    buffer_load_dwordx4 a[136:139], v11, s[20:23], s32 offen offset:3072 sc1
    v_mfma_f32_16x16x32_bf16 v[24:27], v[112:115], a[8:11], v[24:27]
    ds_read_b64_tr_b16 v[130:131], v232 offset:19008
    v_mfma_f32_16x16x32_bf16 v[28:31], v[112:115], a[12:15], v[28:31]
    buffer_load_dwordx4 a[140:143], v11, s[20:23], s33 offen offset:3072 sc1
    v_mfma_f32_16x16x32_bf16 v[32:35], v[112:115], a[16:19], v[32:35]
    ds_read_b64_tr_b16 v[132:133], v233 offset:16896
    v_mfma_f32_16x16x32_bf16 v[36:39], v[112:115], a[20:23], v[36:39]
    buffer_load_dwordx4 a[144:147], v11, s[20:23], s34 offen offset:3072 sc1
    v_mfma_f32_16x16x32_bf16 a[160:163], v[116:119], a[0:3], a[160:163]
    ds_read_b64_tr_b16 v[134:135], v233 offset:19008
    v_mfma_f32_16x16x32_bf16 a[164:167], v[116:119], a[4:7], a[164:167]
    buffer_load_dwordx4 a[148:151], v11, s[20:23], s35 offen offset:3072 sc1
    v_mfma_f32_16x16x32_bf16 a[168:171], v[116:119], a[8:11], a[168:171]
    ds_read_b64_tr_b16 v[136:137], v234 offset:16896
    v_mfma_f32_16x16x32_bf16 a[172:175], v[116:119], a[12:15], a[172:175]
    buffer_load_dwordx4 a[152:155], v11, s[20:23], s36 offen offset:3072 sc1
    v_mfma_f32_16x16x32_bf16 a[176:179], v[116:119], a[16:19], a[176:179]
    ds_read_b64_tr_b16 v[138:139], v234 offset:19008
    v_mfma_f32_16x16x32_bf16 a[180:183], v[116:119], a[20:23], a[180:183]
    buffer_load_dwordx4 a[156:159], v11, s[20:23], s37 offen offset:3072 sc1
    v_mfma_f32_16x16x32_bf16 a[184:187], v[120:123], a[0:3], a[184:187]
    ds_read_b64_tr_b16 v[140:141], v235 offset:16896
    v_mfma_f32_16x16x32_bf16 a[188:191], v[120:123], a[4:7], a[188:191]
    v_mfma_f32_16x16x32_bf16 a[192:195], v[120:123], a[8:11], a[192:195]
    ds_read_b64_tr_b16 v[142:143], v235 offset:19008
    v_mfma_f32_16x16x32_bf16 a[196:199], v[120:123], a[12:15], a[196:199]
    v_mfma_f32_16x16x32_bf16 a[200:203], v[120:123], a[16:19], a[200:203]
    v_mfma_f32_16x16x32_bf16 a[204:207], v[120:123], a[20:23], a[204:207]
    v_mfma_f32_16x16x32_bf16 a[208:211], v[124:127], a[0:3], a[208:211]
    v_mfma_f32_16x16x32_bf16 a[212:215], v[124:127], a[4:7], a[212:215]
    v_mfma_f32_16x16x32_bf16 a[216:219], v[124:127], a[8:11], a[216:219]
    v_mfma_f32_16x16x32_bf16 a[220:223], v[124:127], a[12:15], a[220:223]
    v_mfma_f32_16x16x32_bf16 a[224:227], v[124:127], a[16:19], a[224:227]
    v_mfma_f32_16x16x32_bf16 a[228:231], v[124:127], a[20:23], a[228:231]
    s_waitcnt vmcnt(12) lgkmcnt(0)
    v_mfma_f32_16x16x32_bf16 v[16:19], v[128:131], a[24:27], v[16:19]
    ds_read_b64_tr_b16 v[112:113], v232 offset:33792
    v_mfma_f32_16x16x32_bf16 v[20:23], v[128:131], a[28:31], v[20:23]
    v_mfma_f32_16x16x32_bf16 v[24:27], v[128:131], a[32:35], v[24:27]
    ds_read_b64_tr_b16 v[114:115], v232 offset:35904
    v_mfma_f32_16x16x32_bf16 v[28:31], v[128:131], a[36:39], v[28:31]
    v_mfma_f32_16x16x32_bf16 v[32:35], v[128:131], a[40:43], v[32:35]
    ds_read_b64_tr_b16 v[116:117], v233 offset:33792
    v_mfma_f32_16x16x32_bf16 v[36:39], v[128:131], a[44:47], v[36:39]
    v_mfma_f32_16x16x32_bf16 a[160:163], v[132:135], a[24:27], a[160:163]
    ds_read_b64_tr_b16 v[118:119], v233 offset:35904
    v_mfma_f32_16x16x32_bf16 a[164:167], v[132:135], a[28:31], a[164:167]
    v_mfma_f32_16x16x32_bf16 a[168:171], v[132:135], a[32:35], a[168:171]
    ds_read_b64_tr_b16 v[120:121], v234 offset:33792
    v_mfma_f32_16x16x32_bf16 a[172:175], v[132:135], a[36:39], a[172:175]
    v_mfma_f32_16x16x32_bf16 a[176:179], v[132:135], a[40:43], a[176:179]
    ds_read_b64_tr_b16 v[122:123], v234 offset:35904
    v_mfma_f32_16x16x32_bf16 a[180:183], v[132:135], a[44:47], a[180:183]
    v_mfma_f32_16x16x32_bf16 a[184:187], v[136:139], a[24:27], a[184:187]
    ds_read_b64_tr_b16 v[124:125], v235 offset:33792
    v_mfma_f32_16x16x32_bf16 a[188:191], v[136:139], a[28:31], a[188:191]
    v_mfma_f32_16x16x32_bf16 a[192:195], v[136:139], a[32:35], a[192:195]
    ds_read_b64_tr_b16 v[126:127], v235 offset:35904
    v_mfma_f32_16x16x32_bf16 a[196:199], v[136:139], a[36:39], a[196:199]
    v_mfma_f32_16x16x32_bf16 a[200:203], v[136:139], a[40:43], a[200:203]
    v_mfma_f32_16x16x32_bf16 a[204:207], v[136:139], a[44:47], a[204:207]
    v_mfma_f32_16x16x32_bf16 a[208:211], v[140:143], a[24:27], a[208:211]
    v_mfma_f32_16x16x32_bf16 a[212:215], v[140:143], a[28:31], a[212:215]
    v_mfma_f32_16x16x32_bf16 a[216:219], v[140:143], a[32:35], a[216:219]
    v_mfma_f32_16x16x32_bf16 a[220:223], v[140:143], a[36:39], a[220:223]
    v_mfma_f32_16x16x32_bf16 a[224:227], v[140:143], a[40:43], a[224:227]
    v_mfma_f32_16x16x32_bf16 a[228:231], v[140:143], a[44:47], a[228:231]
    s_waitcnt vmcnt(6) lgkmcnt(0)
    v_mfma_f32_16x16x32_bf16 v[16:19], v[112:115], a[48:51], v[16:19]
    ds_read_b64_tr_b16 v[128:129], v224 offset:16896
    v_mfma_f32_16x16x32_bf16 v[20:23], v[112:115], a[52:55], v[20:23]
    v_lshl_add_u32 v40, v0, 4, s88
    v_add_u32 v41, 33792, v40
    v_add_u32 v42, 67584, v40
    v_mfma_f32_16x16x32_bf16 v[24:27], v[112:115], a[56:59], v[24:27]
    ds_read_b64_tr_b16 v[130:131], v224 offset:19008
    v_mfma_f32_16x16x32_bf16 v[28:31], v[112:115], a[60:63], v[28:31]
    s_xor_b32 s46, s24, 1
    s_mul_i32 s46, s46, 4224
    s_add_u32 s46, s46, 0
    v_mfma_f32_16x16x32_bf16 v[32:35], v[112:115], a[128:131], v[32:35]
    ds_read_b64_tr_b16 v[132:133], v225 offset:16896
    v_mfma_f32_16x16x32_bf16 v[36:39], v[112:115], a[132:135], v[36:39]
    v_lshl_add_u32 v43, v0, 4, s46
    s_xor_b32 s46, s24, 2
    s_mul_i32 s46, s46, 4224
    v_mfma_f32_16x16x32_bf16 a[160:163], v[116:119], a[48:51], a[160:163]
    ds_read_b64_tr_b16 v[134:135], v225 offset:19008
    v_mfma_f32_16x16x32_bf16 a[164:167], v[116:119], a[52:55], a[164:167]
    s_add_u32 s46, s46, 33792
    v_lshl_add_u32 v44, v0, 4, s46
    s_xor_b32 s46, s24, 3
    v_mfma_f32_16x16x32_bf16 a[168:171], v[116:119], a[56:59], a[168:171]
    ds_read_b64_tr_b16 v[136:137], v226 offset:16896
    v_mfma_f32_16x16x32_bf16 a[172:175], v[116:119], a[60:63], a[172:175]
    s_mul_i32 s46, s46, 4224
    s_add_u32 s46, s46, 67584
    v_lshl_add_u32 v45, v0, 4, s46
    v_mfma_f32_16x16x32_bf16 a[176:179], v[116:119], a[128:131], a[176:179]
    ds_read_b64_tr_b16 v[138:139], v226 offset:19008
    v_mfma_f32_16x16x32_bf16 a[180:183], v[116:119], a[132:135], a[180:183]
    v_bfe_u32 v10, v0, 4, 1
    v_lshl_add_u32 v9, v10, 4, v13
    v_mul_u32_u24 v9, 1152, v9
    v_mfma_f32_16x16x32_bf16 a[184:187], v[120:123], a[48:51], a[184:187]
    ds_read_b64_tr_b16 v[140:141], v227 offset:16896
    v_mfma_f32_16x16x32_bf16 a[188:191], v[120:123], a[52:55], a[188:191]
    v_lshrrev_b32 v10, 5, v0
    v_lshl_add_u32 v9, v10, 4, v9
    s_mul_i32 s47, s42, 110592
    v_mfma_f32_16x16x32_bf16 a[192:195], v[120:123], a[56:59], a[192:195]
    ds_read_b64_tr_b16 v[142:143], v227 offset:19008
    v_mfma_f32_16x16x32_bf16 a[196:199], v[120:123], a[60:63], a[196:199]
    s_lshl_b32 s46, s43, 7
    s_add_u32 s47, s47, s46
    s_lshl_b32 s46, s24, 5
    v_mfma_f32_16x16x32_bf16 a[200:203], v[120:123], a[128:131], a[200:203]
    v_mfma_f32_16x16x32_bf16 a[204:207], v[120:123], a[132:135], a[204:207]
    s_add_u32 s47, s47, s46
    v_mfma_f32_16x16x32_bf16 a[208:211], v[124:127], a[48:51], a[208:211]
    v_mfma_f32_16x16x32_bf16 a[212:215], v[124:127], a[52:55], a[212:215]
    v_mfma_f32_16x16x32_bf16 a[216:219], v[124:127], a[56:59], a[216:219]
    v_mfma_f32_16x16x32_bf16 a[220:223], v[124:127], a[60:63], a[220:223]
    v_mfma_f32_16x16x32_bf16 a[224:227], v[124:127], a[128:131], a[224:227]
    v_mfma_f32_16x16x32_bf16 a[228:231], v[124:127], a[132:135], a[228:231]
    s_waitcnt vmcnt(0) lgkmcnt(0)
    v_mfma_f32_16x16x32_bf16 a[160:163], v[132:135], a[136:139], a[160:163]
    v_mfma_f32_16x16x32_bf16 a[164:167], v[132:135], a[140:143], a[164:167]
    v_mfma_f32_16x16x32_bf16 a[168:171], v[132:135], a[144:147], a[168:171]
    v_mfma_f32_16x16x32_bf16 a[172:175], v[132:135], a[148:151], a[172:175]
    v_mfma_f32_16x16x32_bf16 a[176:179], v[132:135], a[152:155], a[176:179]
    v_mfma_f32_16x16x32_bf16 a[180:183], v[132:135], a[156:159], a[180:183]
    v_mfma_f32_16x16x32_bf16 a[184:187], v[136:139], a[136:139], a[184:187]
    v_mfma_f32_16x16x32_bf16 a[188:191], v[136:139], a[140:143], a[188:191]
    v_mfma_f32_16x16x32_bf16 a[192:195], v[136:139], a[144:147], a[192:195]
    ds_write_b128 v40, a[160:163] offset:0
    v_mfma_f32_16x16x32_bf16 a[196:199], v[136:139], a[148:151], a[196:199]
    ds_write_b128 v40, a[164:167] offset:1024
    v_mfma_f32_16x16x32_bf16 a[200:203], v[136:139], a[152:155], a[200:203]
    ds_write_b128 v40, a[168:171] offset:2048
    v_mfma_f32_16x16x32_bf16 a[204:207], v[136:139], a[156:159], a[204:207]
    ds_write_b128 v40, a[172:175] offset:16896
    v_mfma_f32_16x16x32_bf16 a[208:211], v[140:143], a[136:139], a[208:211]
    ds_write_b128 v40, a[176:179] offset:17920
    v_mfma_f32_16x16x32_bf16 a[212:215], v[140:143], a[140:143], a[212:215]
    ds_write_b128 v40, a[180:183] offset:18944
    v_mfma_f32_16x16x32_bf16 a[216:219], v[140:143], a[144:147], a[216:219]
    ds_write_b128 v41, a[184:187] offset:0
    v_mfma_f32_16x16x32_bf16 a[220:223], v[140:143], a[148:151], a[220:223]
    ds_write_b128 v41, a[188:191] offset:1024
    v_mfma_f32_16x16x32_bf16 a[224:227], v[140:143], a[152:155], a[224:227]
    ds_write_b128 v41, a[192:195] offset:2048
    v_mfma_f32_16x16x32_bf16 a[228:231], v[140:143], a[156:159], a[228:231]
    ds_write_b128 v41, a[196:199] offset:16896
    v_mfma_f32_16x16x32_bf16 v[16:19], v[128:131], a[136:139], v[16:19]
    ds_write_b128 v41, a[200:203] offset:17920
    v_mfma_f32_16x16x32_bf16 v[20:23], v[128:131], a[140:143], v[20:23]
    ds_write_b128 v41, a[204:207] offset:18944
    v_mfma_f32_16x16x32_bf16 v[24:27], v[128:131], a[144:147], v[24:27]
    ds_write_b128 v42, a[208:211] offset:0
    v_mfma_f32_16x16x32_bf16 v[28:31], v[128:131], a[148:151], v[28:31]
    ds_write_b128 v42, a[212:215] offset:1024
    v_mfma_f32_16x16x32_bf16 v[32:35], v[128:131], a[152:155], v[32:35]
    ds_write_b128 v42, a[216:219] offset:2048
    v_mfma_f32_16x16x32_bf16 v[36:39], v[128:131], a[156:159], v[36:39]
    ds_write_b128 v42, a[220:223] offset:16896
    ds_write_b128 v42, a[224:227] offset:17920
    ds_write_b128 v42, a[228:231] offset:18944
    s_waitcnt lgkmcnt(0)
    s_barrier
    ds_read_b128 v[48:51], v43 offset:0
    ds_read_b128 v[52:55], v44 offset:0
    ds_read_b128 v[56:59], v45 offset:0
    ds_read_b128 v[60:63], v43 offset:1024
    ds_read_b128 v[64:67], v44 offset:1024
    ds_read_b128 v[68:71], v45 offset:1024
    ds_read_b128 v[72:75], v43 offset:2048
    ds_read_b128 v[76:79], v44 offset:2048
    ds_read_b128 v[80:83], v45 offset:2048
    ds_read_b128 v[84:87], v43 offset:16896
    ds_read_b128 v[88:91], v44 offset:16896
    ds_read_b128 v[92:95], v45 offset:16896
    ds_read_b128 v[96:99], v43 offset:17920
    ds_read_b128 v[100:103], v44 offset:17920
    ds_read_b128 v[104:107], v45 offset:17920
    ds_read_b128 v[108:111], v43 offset:18944
    ds_read_b128 v[112:115], v44 offset:18944
    ds_read_b128 v[116:119], v45 offset:18944
    s_waitcnt lgkmcnt(12)
    v_add_f32 v16, v16, v48
    v_add_f32 v52, v52, v56
    v_add_f32 v17, v17, v49
    v_add_f32 v53, v53, v57
    v_add_f32 v18, v18, v50
    v_add_f32 v54, v54, v58
    v_add_f32 v19, v19, v51
    v_add_f32 v55, v55, v59
    v_add_f32 v16, v16, v52
    v_add_f32 v17, v17, v53
    v_add_f32 v18, v18, v54
    v_add_f32 v19, v19, v55
    v_add_f32 v20, v20, v60
    v_add_f32 v64, v64, v68
    v_add_f32 v21, v21, v61
    v_add_f32 v65, v65, v69
    v_add_f32 v22, v22, v62
    v_add_f32 v66, v66, v70
    v_add_f32 v23, v23, v63
    v_add_f32 v67, v67, v71
    v_add_f32 v20, v20, v64
    v_add_f32 v21, v21, v65
    v_add_f32 v22, v22, v66
    v_add_f32 v23, v23, v67
    v_cvt_pk_bf16_f32 v124, v16, v17
    v_cvt_pk_bf16_f32 v125, v18, v19
    v_cvt_pk_bf16_f32 v126, v20, v21
    v_cvt_pk_bf16_f32 v127, v22, v23
    s_nop 1
    v_permlane16_swap_b32 v124, v126
    v_permlane16_swap_b32 v125, v127
    buffer_store_dwordx4 v[124:127], v9, s[4:7], s47 offen
    s_add_u32 s47, s47, 36864
    s_waitcnt lgkmcnt(6)
    v_add_f32 v24, v24, v72
    v_add_f32 v76, v76, v80
    v_add_f32 v25, v25, v73
    v_add_f32 v77, v77, v81
    v_add_f32 v26, v26, v74
    v_add_f32 v78, v78, v82
    v_add_f32 v27, v27, v75
    v_add_f32 v79, v79, v83
    v_add_f32 v24, v24, v76
    v_add_f32 v25, v25, v77
    v_add_f32 v26, v26, v78
    v_add_f32 v27, v27, v79
    v_add_f32 v28, v28, v84
    v_add_f32 v88, v88, v92
    v_add_f32 v29, v29, v85
    v_add_f32 v89, v89, v93
    v_add_f32 v30, v30, v86
    v_add_f32 v90, v90, v94
    v_add_f32 v31, v31, v87
    v_add_f32 v91, v91, v95
    v_add_f32 v28, v28, v88
    v_add_f32 v29, v29, v89
    v_add_f32 v30, v30, v90
    v_add_f32 v31, v31, v91
    v_cvt_pk_bf16_f32 v128, v24, v25
    v_cvt_pk_bf16_f32 v129, v26, v27
    v_cvt_pk_bf16_f32 v130, v28, v29
    v_cvt_pk_bf16_f32 v131, v30, v31
    s_nop 1
    v_permlane16_swap_b32 v128, v130
    v_permlane16_swap_b32 v129, v131
    buffer_store_dwordx4 v[128:131], v9, s[4:7], s47 offen
    s_add_u32 s47, s47, 36864
    s_waitcnt lgkmcnt(0)
    v_add_f32 v32, v32, v96
    v_add_f32 v100, v100, v104
    v_add_f32 v33, v33, v97
    v_add_f32 v101, v101, v105
    v_add_f32 v34, v34, v98
    v_add_f32 v102, v102, v106
    v_add_f32 v35, v35, v99
    v_add_f32 v103, v103, v107
    v_add_f32 v32, v32, v100
    v_add_f32 v33, v33, v101
    v_add_f32 v34, v34, v102
    v_add_f32 v35, v35, v103
    v_add_f32 v36, v36, v108
    v_add_f32 v112, v112, v116
    v_add_f32 v37, v37, v109
    v_add_f32 v113, v113, v117
    v_add_f32 v38, v38, v110
    v_add_f32 v114, v114, v118
    v_add_f32 v39, v39, v111
    v_add_f32 v115, v115, v119
    v_add_f32 v36, v36, v112
    v_add_f32 v37, v37, v113
    v_add_f32 v38, v38, v114
    v_add_f32 v39, v39, v115
    v_cvt_pk_bf16_f32 v132, v32, v33
    v_cvt_pk_bf16_f32 v133, v34, v35
    v_cvt_pk_bf16_f32 v134, v36, v37
    v_cvt_pk_bf16_f32 v135, v38, v39
    s_nop 1
    v_permlane16_swap_b32 v132, v134
    v_permlane16_swap_b32 v133, v135
    buffer_store_dwordx4 v[132:135], v9, s[4:7], s47 offen
    s_add_u32 s47, s47, 36864
L3_done:
L1_end:
    s_endpgm
L1_redo:
    s_mov_b32 s59, 1
    s_waitcnt vmcnt(0) lgkmcnt(0)
    s_barrier
    s_load_dwordx4 s[32:35], s[0:1], 8
    s_lshl_b32 s47, s27, 5
    s_add_u32 s47, s47, s28
    s_lshl_b32 s47, s47, 19
    s_waitcnt lgkmcnt(0)
    s_add_u32 s12, s32, s47
    s_addc_u32 s13, s33, 0
    s_mov_b32 s14, 524288
    s_add_u32 s16, s34, s47
    s_addc_u32 s17, s35, 0
    s_mov_b32 s18, 524288
    v_add_u32 v246, 0, v8
    v_add_u32 v247, 1024, v8
    v_add_u32 v248, 2048, v8
    v_add_u32 v249, 3072, v8
    v_mov_b32 v7, 0
    s_add_u32 m0, s88, 0
    s_mov_b32 s46, 0
    buffer_load_dwordx4 v246, s[12:15], s46 offen nt lds
    s_add_u32 m0, s88, 1056
    s_mov_b32 s46, 0
    buffer_load_dwordx4 v247, s[12:15], s46 offen nt lds
    s_add_u32 m0, s88, 2112
    s_mov_b32 s46, 0
    buffer_load_dwordx4 v248, s[12:15], s46 offen nt lds
    s_add_u32 m0, s88, 3168
    s_mov_b32 s46, 0
    buffer_load_dwordx4 v249, s[12:15], s46 offen nt lds
    s_add_u32 m0, s88, 16896
    s_mov_b32 s46, 0
    buffer_load_dwordx4 v246, s[16:19], s46 offen nt lds
    s_add_u32 m0, s88, 17952
    s_mov_b32 s46, 0
    buffer_load_dwordx4 v247, s[16:19], s46 offen nt lds
    s_add_u32 m0, s88, 19008
    s_mov_b32 s46, 0
    buffer_load_dwordx4 v248, s[16:19], s46 offen nt lds
    s_add_u32 m0, s88, 20064
    s_mov_b32 s46, 0
    buffer_load_dwordx4 v249, s[16:19], s46 offen nt lds
    s_add_u32 m0, s88, 33792
    s_mov_b32 s46, 16384
    buffer_load_dwordx4 v246, s[12:15], s46 offen nt lds
    s_add_u32 m0, s88, 34848
    s_mov_b32 s46, 16384
    buffer_load_dwordx4 v247, s[12:15], s46 offen nt lds
    s_add_u32 m0, s88, 35904
    s_mov_b32 s46, 16384
    buffer_load_dwordx4 v248, s[12:15], s46 offen nt lds
    s_add_u32 m0, s88, 36960
    s_mov_b32 s46, 16384
    buffer_load_dwordx4 v249, s[12:15], s46 offen nt lds
    s_add_u32 m0, s88, 50688
    s_mov_b32 s46, 16384
    buffer_load_dwordx4 v246, s[16:19], s46 offen nt lds
    s_add_u32 m0, s88, 51744
    s_mov_b32 s46, 16384
    buffer_load_dwordx4 v247, s[16:19], s46 offen nt lds
    s_add_u32 m0, s88, 52800
    s_mov_b32 s46, 16384
    buffer_load_dwordx4 v248, s[16:19], s46 offen nt lds
    s_add_u32 m0, s88, 53856
    s_mov_b32 s46, 16384
    buffer_load_dwordx4 v249, s[16:19], s46 offen nt lds
    s_add_u32 m0, s88, 67584
    s_mov_b32 s46, 32768
    buffer_load_dwordx4 v246, s[12:15], s46 offen nt lds
    s_add_u32 m0, s88, 68640
    s_mov_b32 s46, 32768
    buffer_load_dwordx4 v247, s[12:15], s46 offen nt lds
    s_add_u32 m0, s88, 69696
    s_mov_b32 s46, 32768
    buffer_load_dwordx4 v248, s[12:15], s46 offen nt lds
    s_add_u32 m0, s88, 70752
    s_mov_b32 s46, 32768
    buffer_load_dwordx4 v249, s[12:15], s46 offen nt lds
    s_add_u32 m0, s88, 84480
    s_mov_b32 s46, 32768
    buffer_load_dwordx4 v246, s[16:19], s46 offen nt lds
    s_add_u32 m0, s88, 85536
    s_mov_b32 s46, 32768
    buffer_load_dwordx4 v247, s[16:19], s46 offen nt lds
    s_add_u32 m0, s88, 86592
    s_mov_b32 s46, 32768
    buffer_load_dwordx4 v248, s[16:19], s46 offen nt lds
    s_add_u32 m0, s88, 87648
    s_mov_b32 s46, 32768
    buffer_load_dwordx4 v249, s[16:19], s46 offen nt lds
    v_mov_b32 v96, 0xff800000
    v_mov_b32 v97, 0xff800000
    v_mov_b32 v98, 0xff800000
    v_mov_b32 v99, 0xff800000
    v_mov_b32 v100, 0xff800000
    v_lshlrev_b32 v9, 8, v13
    v_lshl_add_u32 v9, v12, 4, v9
    s_lshl_b32 s47, s25, 7
    v_add_u32 v9, s47, v9
    v_xor_b32 v10, 128, v9
    s_mov_b32 s47, 0
L1_mx:
    buffer_load_dwordx4 v[112:115], v9, s[12:15], s47 offen
    buffer_load_dwordx4 v[116:119], v9, s[12:15], s47 offen offset:64
    buffer_load_dwordx4 v[120:123], v10, s[12:15], s47 offen
    buffer_load_dwordx4 v[124:127], v10, s[12:15], s47 offen offset:64
    s_waitcnt vmcnt(0)
    v_mfma_f32_16x16x32_bf16 v[16:19], v[112:115], v[160:163], 0
    v_mfma_f32_16x16x32_bf16 v[20:23], v[112:115], v[176:179], 0
    v_mfma_f32_16x16x32_bf16 v[24:27], v[112:115], v[192:195], 0
    v_mfma_f32_16x16x32_bf16 v[28:31], v[112:115], v[208:211], 0
    v_mfma_f32_16x16x32_bf16 v[32:35], v[112:115], v[224:227], 0
    v_mfma_f32_16x16x32_bf16 v[16:19], v[116:119], v[164:167], v[16:19]
    v_mfma_f32_16x16x32_bf16 v[20:23], v[116:119], v[180:183], v[20:23]
    v_mfma_f32_16x16x32_bf16 v[24:27], v[116:119], v[196:199], v[24:27]
    v_mfma_f32_16x16x32_bf16 v[28:31], v[116:119], v[212:215], v[28:31]
    v_mfma_f32_16x16x32_bf16 v[32:35], v[116:119], v[228:231], v[32:35]
    v_mfma_f32_16x16x32_bf16 v[16:19], v[120:123], v[168:171], v[16:19]
    v_mfma_f32_16x16x32_bf16 v[20:23], v[120:123], v[184:187], v[20:23]
    v_mfma_f32_16x16x32_bf16 v[24:27], v[120:123], v[200:203], v[24:27]
    v_mfma_f32_16x16x32_bf16 v[28:31], v[120:123], v[216:219], v[28:31]
    v_mfma_f32_16x16x32_bf16 v[32:35], v[120:123], v[232:235], v[32:35]
    v_mfma_f32_16x16x32_bf16 v[16:19], v[124:127], v[172:175], v[16:19]
    v_mfma_f32_16x16x32_bf16 v[20:23], v[124:127], v[188:191], v[20:23]
    v_mfma_f32_16x16x32_bf16 v[24:27], v[124:127], v[204:207], v[24:27]
    v_mfma_f32_16x16x32_bf16 v[28:31], v[124:127], v[220:223], v[28:31]
    v_mfma_f32_16x16x32_bf16 v[32:35], v[124:127], v[236:239], v[32:35]
    s_nop 7
    v_max3_f32 v96, v96, v16, v17
    v_max3_f32 v96, v96, v18, v19
    v_max3_f32 v97, v97, v20, v21
    v_max3_f32 v97, v97, v22, v23
    v_max3_f32 v98, v98, v24, v25
    v_max3_f32 v98, v98, v26, v27
    v_max3_f32 v99, v99, v28, v29
    v_max3_f32 v99, v99, v30, v31
    v_max3_f32 v100, v100, v32, v33
    v_max3_f32 v100, v100, v34, v35
    s_add_u32 s47, s47, 4096
    s_cmp_lt_u32 s47, 524288
    s_cbranch_scc1 L1_mx
    v_mov_b32 v104, v96
    v_mov_b32 v105, v97
    v_mov_b32 v106, v98
    v_mov_b32 v107, v99
    v_mov_b32 v108, v100
    v_permlane32_swap_b32 v96, v104
    v_permlane32_swap_b32 v97, v105
    v_permlane32_swap_b32 v98, v106
    v_permlane32_swap_b32 v99, v107
    v_permlane32_swap_b32 v100, v108
    v_max_f32 v96, v96, v104
    v_max_f32 v97, v97, v105
    v_max_f32 v98, v98, v106
    v_max_f32 v99, v99, v107
    v_max_f32 v100, v100, v108
    v_mov_b32 v104, v96
    v_mov_b32 v105, v97
    v_mov_b32 v106, v98
    v_mov_b32 v107, v99
    v_mov_b32 v108, v100
    v_permlane16_swap_b32 v96, v104
    v_permlane16_swap_b32 v97, v105
    v_permlane16_swap_b32 v98, v106
    v_permlane16_swap_b32 v99, v107
    v_permlane16_swap_b32 v100, v108
    v_max_f32 v96, v96, v104
    v_max_f32 v97, v97, v105
    v_max_f32 v98, v98, v106
    v_max_f32 v99, v99, v107
    v_max_f32 v100, v100, v108
    v_sub_f32 v128, 0, v96
    v_sub_f32 v129, 0, v96
    v_sub_f32 v130, 0, v96
    v_sub_f32 v131, 0, v96
    v_sub_f32 v132, 0, v97
    v_sub_f32 v133, 0, v97
    v_sub_f32 v134, 0, v97
    v_sub_f32 v135, 0, v97
    v_sub_f32 v136, 0, v98
    v_sub_f32 v137, 0, v98
    v_sub_f32 v138, 0, v98
    v_sub_f32 v139, 0, v98
    v_sub_f32 v140, 0, v99
    v_sub_f32 v141, 0, v99
    v_sub_f32 v142, 0, v99
    v_sub_f32 v143, 0, v99
    v_sub_f32 v144, 0, v100
    v_sub_f32 v145, 0, v100
    v_sub_f32 v146, 0, v100
    v_sub_f32 v147, 0, v100
    v_accvgpr_write_b32 a0, 0
    v_accvgpr_write_b32 a1, 0
    v_accvgpr_write_b32 a2, 0
    v_accvgpr_write_b32 a3, 0
    v_accvgpr_write_b32 a4, 0
    v_accvgpr_write_b32 a5, 0
    v_accvgpr_write_b32 a6, 0
    v_accvgpr_write_b32 a7, 0
    v_accvgpr_write_b32 a8, 0
    v_accvgpr_write_b32 a9, 0
    v_accvgpr_write_b32 a10, 0
    v_accvgpr_write_b32 a11, 0
    v_accvgpr_write_b32 a12, 0
    v_accvgpr_write_b32 a13, 0
    v_accvgpr_write_b32 a14, 0
    v_accvgpr_write_b32 a15, 0
    v_accvgpr_write_b32 a16, 0
    v_accvgpr_write_b32 a17, 0
    v_accvgpr_write_b32 a18, 0
    v_accvgpr_write_b32 a19, 0
    v_accvgpr_write_b32 a20, 0
    v_accvgpr_write_b32 a21, 0
    v_accvgpr_write_b32 a22, 0
    v_accvgpr_write_b32 a23, 0
    v_accvgpr_write_b32 a24, 0
    v_accvgpr_write_b32 a25, 0
    v_accvgpr_write_b32 a26, 0
    v_accvgpr_write_b32 a27, 0
    v_accvgpr_write_b32 a28, 0
    v_accvgpr_write_b32 a29, 0
    v_accvgpr_write_b32 a30, 0
    v_accvgpr_write_b32 a31, 0
    v_accvgpr_write_b32 a32, 0
    v_accvgpr_write_b32 a33, 0
    v_accvgpr_write_b32 a34, 0
    v_accvgpr_write_b32 a35, 0
    v_accvgpr_write_b32 a36, 0
    v_accvgpr_write_b32 a37, 0
    v_accvgpr_write_b32 a38, 0
    v_accvgpr_write_b32 a39, 0
    v_accvgpr_write_b32 a40, 0
    v_accvgpr_write_b32 a41, 0
    v_accvgpr_write_b32 a42, 0
    v_accvgpr_write_b32 a43, 0
    v_accvgpr_write_b32 a44, 0
    v_accvgpr_write_b32 a45, 0
    v_accvgpr_write_b32 a46, 0
    v_accvgpr_write_b32 a47, 0
    v_accvgpr_write_b32 a48, 0
    v_accvgpr_write_b32 a49, 0
    v_accvgpr_write_b32 a50, 0
    v_accvgpr_write_b32 a51, 0
    v_accvgpr_write_b32 a52, 0
    v_accvgpr_write_b32 a53, 0
    v_accvgpr_write_b32 a54, 0
    v_accvgpr_write_b32 a55, 0
    v_accvgpr_write_b32 a56, 0
    v_accvgpr_write_b32 a57, 0
    v_accvgpr_write_b32 a58, 0
    v_accvgpr_write_b32 a59, 0
    v_accvgpr_write_b32 a60, 0
    v_accvgpr_write_b32 a61, 0
    v_accvgpr_write_b32 a62, 0
    v_accvgpr_write_b32 a63, 0
    v_accvgpr_write_b32 a64, 0
    v_accvgpr_write_b32 a65, 0
    v_accvgpr_write_b32 a66, 0
    v_accvgpr_write_b32 a67, 0
    v_accvgpr_write_b32 a68, 0
    v_accvgpr_write_b32 a69, 0
    v_accvgpr_write_b32 a70, 0
    v_accvgpr_write_b32 a71, 0
    v_accvgpr_write_b32 a72, 0
    v_accvgpr_write_b32 a73, 0
    v_accvgpr_write_b32 a74, 0
    v_accvgpr_write_b32 a75, 0
    v_accvgpr_write_b32 a76, 0
    v_accvgpr_write_b32 a77, 0
    v_accvgpr_write_b32 a78, 0
    v_accvgpr_write_b32 a79, 0
    v_accvgpr_write_b32 a80, 0
    v_accvgpr_write_b32 a81, 0
    v_accvgpr_write_b32 a82, 0
    v_accvgpr_write_b32 a83, 0
    v_accvgpr_write_b32 a84, 0
    v_accvgpr_write_b32 a85, 0
    v_accvgpr_write_b32 a86, 0
    v_accvgpr_write_b32 a87, 0
    v_accvgpr_write_b32 a88, 0
    v_accvgpr_write_b32 a89, 0
    v_accvgpr_write_b32 a90, 0
    v_accvgpr_write_b32 a91, 0
    v_accvgpr_write_b32 a92, 0
    v_accvgpr_write_b32 a93, 0
    v_accvgpr_write_b32 a94, 0
    v_accvgpr_write_b32 a95, 0
    v_accvgpr_write_b32 a96, 0
    v_accvgpr_write_b32 a97, 0
    v_accvgpr_write_b32 a98, 0
    v_accvgpr_write_b32 a99, 0
    v_accvgpr_write_b32 a100, 0
    v_accvgpr_write_b32 a101, 0
    v_accvgpr_write_b32 a102, 0
    v_accvgpr_write_b32 a103, 0
    v_accvgpr_write_b32 a104, 0
    v_accvgpr_write_b32 a105, 0
    v_accvgpr_write_b32 a106, 0
    v_accvgpr_write_b32 a107, 0
    v_accvgpr_write_b32 a108, 0
    v_accvgpr_write_b32 a109, 0
    v_accvgpr_write_b32 a110, 0
    v_accvgpr_write_b32 a111, 0
    v_accvgpr_write_b32 a112, 0
    v_accvgpr_write_b32 a113, 0
    v_accvgpr_write_b32 a114, 0
    v_accvgpr_write_b32 a115, 0
    v_accvgpr_write_b32 a116, 0
    v_accvgpr_write_b32 a117, 0
    v_accvgpr_write_b32 a118, 0
    v_accvgpr_write_b32 a119, 0
    v_accvgpr_write_b32 a120, 0
    v_accvgpr_write_b32 a121, 0
    v_accvgpr_write_b32 a122, 0
    v_accvgpr_write_b32 a123, 0
    v_accvgpr_write_b32 a124, 0
    v_accvgpr_write_b32 a125, 0
    v_accvgpr_write_b32 a126, 0
    v_accvgpr_write_b32 a127, 0
    v_accvgpr_write_b32 a128, 0
    v_accvgpr_write_b32 a129, 0
    v_accvgpr_write_b32 a130, 0
    v_accvgpr_write_b32 a131, 0
    v_accvgpr_write_b32 a132, 0
    v_accvgpr_write_b32 a133, 0
    v_accvgpr_write_b32 a134, 0
    v_accvgpr_write_b32 a135, 0
    v_accvgpr_write_b32 a136, 0
    v_accvgpr_write_b32 a137, 0
    v_accvgpr_write_b32 a138, 0
    v_accvgpr_write_b32 a139, 0
    v_accvgpr_write_b32 a140, 0
    v_accvgpr_write_b32 a141, 0
    v_accvgpr_write_b32 a142, 0
    v_accvgpr_write_b32 a143, 0
    v_accvgpr_write_b32 a144, 0
    v_accvgpr_write_b32 a145, 0
    v_accvgpr_write_b32 a146, 0
    v_accvgpr_write_b32 a147, 0
    v_accvgpr_write_b32 a148, 0
    v_accvgpr_write_b32 a149, 0
    v_accvgpr_write_b32 a150, 0
    v_accvgpr_write_b32 a151, 0
    v_accvgpr_write_b32 a152, 0
    v_accvgpr_write_b32 a153, 0
    v_accvgpr_write_b32 a154, 0
    v_accvgpr_write_b32 a155, 0
    v_accvgpr_write_b32 a156, 0
    v_accvgpr_write_b32 a157, 0
    v_accvgpr_write_b32 a158, 0
    v_accvgpr_write_b32 a159, 0
    v_accvgpr_write_b32 a160, 0
    v_accvgpr_write_b32 a161, 0
    v_accvgpr_write_b32 a162, 0
    v_accvgpr_write_b32 a163, 0
    v_accvgpr_write_b32 a164, 0
    v_accvgpr_write_b32 a165, 0
    v_accvgpr_write_b32 a166, 0
    v_accvgpr_write_b32 a167, 0
    v_accvgpr_write_b32 a168, 0
    v_accvgpr_write_b32 a169, 0
    v_accvgpr_write_b32 a170, 0
    v_accvgpr_write_b32 a171, 0
    v_accvgpr_write_b32 a172, 0
    v_accvgpr_write_b32 a173, 0
    v_accvgpr_write_b32 a174, 0
    v_accvgpr_write_b32 a175, 0
    v_accvgpr_write_b32 a176, 0
    v_accvgpr_write_b32 a177, 0
    v_accvgpr_write_b32 a178, 0
    v_accvgpr_write_b32 a179, 0
    v_add_u32 v148, 33792, v240
    v_add_u32 v149, 33792, v241
    v_mov_b32 v150, v242
    v_mov_b32 v151, v243
    s_mov_b32 s52, 49152
    s_add_u32 s50, s88, 101376
    s_mov_b32 s51, s88
    s_mov_b32 s53, 33792
    s_mov_b32 s54, 16896
    s_mov_b32 s49, 14
    s_mov_b32 s38, 0
    s_mov_b32 s60, 16384
    s_mov_b32 s61, 160
    s_mov_b32 s62, 0x7ffff
    s_barrier
    ds_read_b128 a[184:187], v240 offset:0
    ds_read_b128 a[188:191], v240 offset:64
    ds_read_b128 a[192:195], v241 offset:0
    ds_read_b128 a[196:199], v241 offset:64
    ds_read_b128 a[224:227], v240 offset:256
    ds_read_b128 a[228:231], v240 offset:320
    ds_read_b128 a[232:235], v241 offset:256
    ds_read_b128 a[236:239], v241 offset:320
    s_waitcnt lgkmcnt(0)
    v_mfma_f32_16x16x32_bf16 v[16:19], a[184:187], v[160:163], v[128:131]
    v_mfma_f32_16x16x32_bf16 v[24:27], a[184:187], v[176:179], v[132:135]
    v_mfma_f32_16x16x32_bf16 v[32:35], a[184:187], v[192:195], v[136:139]
    v_mfma_f32_16x16x32_bf16 v[40:43], a[184:187], v[208:211], v[140:143]
    v_mfma_f32_16x16x32_bf16 v[48:51], a[184:187], v[224:227], v[144:147]
    v_mfma_f32_16x16x32_bf16 v[16:19], a[188:191], v[164:167], v[16:19]
    v_mfma_f32_16x16x32_bf16 v[24:27], a[188:191], v[180:183], v[24:27]
    v_mfma_f32_16x16x32_bf16 v[32:35], a[188:191], v[196:199], v[32:35]
    v_mfma_f32_16x16x32_bf16 v[40:43], a[188:191], v[212:215], v[40:43]
    v_mfma_f32_16x16x32_bf16 v[48:51], a[188:191], v[228:231], v[48:51]
    v_mfma_f32_16x16x32_bf16 v[16:19], a[192:195], v[168:171], v[16:19]
    v_mfma_f32_16x16x32_bf16 v[24:27], a[192:195], v[184:187], v[24:27]
    v_mfma_f32_16x16x32_bf16 v[32:35], a[192:195], v[200:203], v[32:35]
    v_mfma_f32_16x16x32_bf16 v[40:43], a[192:195], v[216:219], v[40:43]
    v_mfma_f32_16x16x32_bf16 v[48:51], a[192:195], v[232:235], v[48:51]
    v_mfma_f32_16x16x32_bf16 v[16:19], a[196:199], v[172:175], v[16:19]
    v_mfma_f32_16x16x32_bf16 v[24:27], a[196:199], v[188:191], v[24:27]
    v_mfma_f32_16x16x32_bf16 v[32:35], a[196:199], v[204:207], v[32:35]
    v_mfma_f32_16x16x32_bf16 v[40:43], a[196:199], v[220:223], v[40:43]
    v_mfma_f32_16x16x32_bf16 v[48:51], a[196:199], v[236:239], v[48:51]
    v_mfma_f32_16x16x32_bf16 v[20:23], a[224:227], v[160:163], v[128:131]
    v_mfma_f32_16x16x32_bf16 v[28:31], a[224:227], v[176:179], v[132:135]
    v_mfma_f32_16x16x32_bf16 v[36:39], a[224:227], v[192:195], v[136:139]
    v_mfma_f32_16x16x32_bf16 v[44:47], a[224:227], v[208:211], v[140:143]
    v_mfma_f32_16x16x32_bf16 v[52:55], a[224:227], v[224:227], v[144:147]
    v_mfma_f32_16x16x32_bf16 v[20:23], a[228:231], v[164:167], v[20:23]
    v_mfma_f32_16x16x32_bf16 v[28:31], a[228:231], v[180:183], v[28:31]
    v_mfma_f32_16x16x32_bf16 v[36:39], a[228:231], v[196:199], v[36:39]
    v_mfma_f32_16x16x32_bf16 v[44:47], a[228:231], v[212:215], v[44:47]
    v_mfma_f32_16x16x32_bf16 v[52:55], a[228:231], v[228:231], v[52:55]
    v_mfma_f32_16x16x32_bf16 v[20:23], a[232:235], v[168:171], v[20:23]
    v_mfma_f32_16x16x32_bf16 v[28:31], a[232:235], v[184:187], v[28:31]
    v_mfma_f32_16x16x32_bf16 v[36:39], a[232:235], v[200:203], v[36:39]
    v_mfma_f32_16x16x32_bf16 v[44:47], a[232:235], v[216:219], v[44:47]
    v_mfma_f32_16x16x32_bf16 v[52:55], a[232:235], v[232:235], v[52:55]
    v_mfma_f32_16x16x32_bf16 v[20:23], a[236:239], v[172:175], v[20:23]
    v_mfma_f32_16x16x32_bf16 v[28:31], a[236:239], v[188:191], v[28:31]
    v_mfma_f32_16x16x32_bf16 v[36:39], a[236:239], v[204:207], v[36:39]
    v_mfma_f32_16x16x32_bf16 v[44:47], a[236:239], v[220:223], v[44:47]
    v_mfma_f32_16x16x32_bf16 v[52:55], a[236:239], v[236:239], v[52:55]
    ds_read_b128 a[192:195], v150 offset:0
    ds_read_b128 a[196:199], v150 offset:64
    ds_read_b128 a[200:203], v151 offset:0
    ds_read_b128 a[204:207], v151 offset:64
    ds_read_b128 a[208:211], v150 offset:256
    ds_read_b128 a[212:215], v150 offset:320
    ds_read_b128 a[216:219], v151 offset:256
    ds_read_b128 a[220:223], v151 offset:320
    s_nop 7
    v_exp_f32 v16, v16
    v_exp_f32 v17, v17
    v_exp_f32 v18, v18
    v_cvt_pk_bf16_f32 v16, v16, v17
    v_exp_f32 v19, v19
    v_exp_f32 v24, v24
    v_cvt_pk_bf16_f32 v17, v18, v19
    v_exp_f32 v25, v25
    v_exp_f32 v26, v26
    v_cvt_pk_bf16_f32 v24, v24, v25
    v_exp_f32 v27, v27
    v_exp_f32 v32, v32
    v_cvt_pk_bf16_f32 v25, v26, v27
    v_exp_f32 v33, v33
    v_exp_f32 v34, v34
    v_cvt_pk_bf16_f32 v32, v32, v33
    v_exp_f32 v35, v35
    v_exp_f32 v40, v40
    v_cvt_pk_bf16_f32 v33, v34, v35
    v_exp_f32 v41, v41
    v_exp_f32 v42, v42
    v_cvt_pk_bf16_f32 v40, v40, v41
    v_exp_f32 v43, v43
    v_exp_f32 v48, v48
    v_cvt_pk_bf16_f32 v41, v42, v43
    v_exp_f32 v49, v49
    v_exp_f32 v50, v50
    v_cvt_pk_bf16_f32 v48, v48, v49
    v_exp_f32 v51, v51
    s_nop 0
    v_cvt_pk_bf16_f32 v49, v50, v51
    s_branch L1_presm
L_code_end:
.section .rodata,"a"
.p2align 6
.amdhsa_kernel standalone__mha_block_cached__near_ridge_kernel
  .amdhsa_next_free_vgpr 512
  .amdhsa_next_free_sgpr 102
  .amdhsa_accum_offset 256
  .amdhsa_group_segment_fixed_size 0
  .amdhsa_kernarg_size 64
  .amdhsa_user_sgpr_count 2
  .amdhsa_user_sgpr_kernarg_segment_ptr 1
  .amdhsa_system_sgpr_workgroup_id_x 1
.end_amdhsa_kernel
```
